```python
import torch

def _softmax(x, axis=-1):
    return torch.softmax(x, dim=axis)
def _gelu(x):
    return torch.nn.functional.gelu(x, approximate="tanh")
def _silu(x):
    return torch.nn.functional.silu(x)
def _sigmoid(x):
    return torch.sigmoid(x)
def _layernorm(x, axis=-1, eps=1e-5):
    m = x.mean(dim=axis, keepdim=True)
    v = x.var(dim=axis, keepdim=True, unbiased=False)
    return (x - m) / torch.sqrt(v + eps)
def _scatter_add(tgt, idx, src, axis=0):
    return tgt.clone().index_add_(axis, idx, src)
def _segment_sum(src, seg, n):
    out = torch.zeros((n,) + src.shape[1:], dtype=src.dtype)
    return out.index_add_(0, seg, src)
def _pad(x, pw):
    flat = tuple(v for pair in reversed(pw) for v in pair)
    return torch.nn.functional.pad(x, flat)

kernel_name = 'recurrent_scan__ssm_conv_s5__mixer_s_mlp__prompt'

def setup_inputs():

    _w = (lambda a: (lambda t: t.to(torch.bfloat16) if t.is_floating_point() else t)(torch.as_tensor(a)))
    def _A_setup():
        B, S, D = 1, 2048, 512
        P = D
        Lambda_re = -0.5 * (lambda _x: torch.exp(torch.as_tensor(_x)))((lambda *s: torch.randn(*s, dtype=torch.bfloat16) * 0.2)(P))
        Lambda_im = (lambda *s: torch.randn(*s, dtype=torch.bfloat16) * 0.4)(P) * 1.0
        B_re = (lambda *s: torch.randn(*s, dtype=torch.bfloat16) * 0.2)(P, D) * (D ** -0.5)
        B_im = (lambda *s: torch.randn(*s, dtype=torch.bfloat16) * 0.2)(P, D) * (D ** -0.5)
        C_re = (lambda *s: torch.randn(*s, dtype=torch.bfloat16) * 0.2)(D, P) * (P ** -0.5)
        C_im = (lambda *s: torch.randn(*s, dtype=torch.bfloat16) * 0.2)(D, P) * (P ** -0.5)
        log_dt = (lambda *s: torch.randn(*s, dtype=torch.bfloat16) * 0.2)(P) * 0.3 - 2.0
        Dskip = (lambda *s: torch.randn(*s, dtype=torch.bfloat16) * 0.05)(D)
        return {
            "x": _w((lambda *s: torch.randn(*s, dtype=torch.bfloat16) * 0.05)(B, S, D)),
            "Lambda_re": _w(Lambda_re),
            "Lambda_im": _w(Lambda_im),
            "B_re": _w(B_re),
            "B_im": _w(B_im),
            "C_re": _w(C_re),
            "C_im": _w(C_im),
            "log_dt": _w(log_dt),
            "Dskip": _w(Dskip),
        }
    _A_in = _A_setup()

    def _B_setup():
        B, S, D, F = 1, 2048, 512, 1792
        return {
            "x":  _w((lambda *s: torch.randn(*s, dtype=torch.bfloat16) * 0.05)(B, S, D)),
            "w1": _w((lambda *s: torch.randn(*s, dtype=torch.bfloat16) * 3.2)(D, D) * (D ** -0.5)),
            "w2": _w((lambda *s: torch.randn(*s, dtype=torch.bfloat16) * 3.2)(D, D) * (D ** -0.5)),
            "w3": _w((lambda *s: torch.randn(*s, dtype=torch.bfloat16) * 3.2)(D, F) * (D ** -0.5)),
            "w4": _w((lambda *s: torch.randn(*s, dtype=torch.bfloat16) * 3.2)(F, D) * (F ** -0.5)),
        }
    _B_in = _B_setup()

    return {
        "A_x": _A_in["x"],
        "A_Lambda_re": _A_in["Lambda_re"],
        "A_Lambda_im": _A_in["Lambda_im"],
        "A_B_re": _A_in["B_re"],
        "A_B_im": _A_in["B_im"],
        "A_C_re": _A_in["C_re"],
        "A_C_im": _A_in["C_im"],
        "A_log_dt": _A_in["log_dt"],
        "A_Dskip": _A_in["Dskip"],
        "B_x": _B_in["x"],
        "B_w1": _B_in["w1"],
        "B_w2": _B_in["w2"],
        "B_w3": _B_in["w3"],
        "B_w4": _B_in["w4"],
    }

def reference(A_x, A_Lambda_re, A_Lambda_im, A_B_re, A_B_im, A_C_re, A_C_im, A_log_dt, A_Dskip, B_x, B_w1, B_w2, B_w3, B_w4):
    def _A_ref(x, Lambda_re, Lambda_im, B_re, B_im, C_re, C_im, log_dt, Dskip):
        Bsz, L, H = x.shape
        Lam = Lambda_re + 1j * Lambda_im
        Bmat = B_re + 1j * B_im
        Cmat = C_re + 1j * C_im
        dt = torch.exp(log_dt)
        Lam_bar = torch.exp(dt * Lam)
        B_bar = ((Lam_bar - 1.0) / Lam)[:, None] * Bmat
        Bu = torch.einsum("bld,pd->blp", x + 0j, B_bar)
        h = torch.zeros_like(Bu[:, 0, :])
        hs = []
        for t in range(L):
            h = Lam_bar[None, :] * h + Bu[:, t, :]
            hs.append(h)
        hseq = torch.stack(hs, 1)
        y = 2.0 * torch.einsum("blp,dp->bld", hseq, Cmat).real + x * Dskip[None, None, :]
        return y

    def _B_ref(x, w1, w2, w3, w4):
        B, S, D = x.shape
        h = _gelu(_layernorm(x, axis=-1) @ w1)
        c = D // 4
        g0 = _pad(h[:, :, 0*c:1*c], ((0, 0), (1, 0), (0, 0)))[:, :S, :]
        g1 = _pad(h[:, :, 1*c:2*c], ((0, 0), (0, 1), (0, 0)))[:, 1:, :]
        g2 = _pad(h[:, :, 2*c:3*c], ((0, 0), (2, 0), (0, 0)))[:, :S, :]
        g3 = _pad(h[:, :, 3*c:   ], ((0, 0), (0, 2), (0, 0)))[:, 2:, :]
        hs = torch.concatenate([g0, g1, g2, g3], axis=-1) @ w2
        x1 = x + hs
        h2 = _gelu(_layernorm(x1, axis=-1) @ w3) @ w4
        return x1 + h2

    x = A_x
    xn = _layernorm(x, axis=-1)
    s = _A_ref(xn, A_Lambda_re, A_Lambda_im, A_B_re, A_B_im, A_C_re, A_C_im, A_log_dt, A_Dskip)
    g = _silu(_B_ref(xn, B_w1, B_w2, B_w3, B_w4))
    return x + s * g
```

```asm
; @launch grid=(256,1,1) block=(512,1,1) lds=163840
.amdgcn_target "amdgcn-amd-amdhsa--gfx950"
.text
.globl recurrent_scan__ssm_conv_s5__mixer_s_mlp__prompt_kernel
.p2align 8
.type recurrent_scan__ssm_conv_s5__mixer_s_mlp__prompt_kernel,@function
recurrent_scan__ssm_conv_s5__mixer_s_mlp__prompt_kernel:
  s_cmp_ge_u32 s2, 256
  s_cbranch_scc1 L_exit
  s_load_dwordx16 s[4:19], s[0:1], 0
  s_load_dwordx16 s[20:35], s[0:1], 64
  s_load_dwordx2 s[36:37], s[0:1], 128
  v_lshrrev_b32 v2, 6, v0
  v_and_b32 v1, 63, v0
  v_readfirstlane_b32 s70, v2
  s_and_b32 s68, s2, 7
  s_lshl_b32 s68, s68, 1
  s_lshr_b32 s92, s2, 7
  s_add_u32 s68, s68, s92
  s_lshr_b32 s69, s2, 3
  s_and_b32 s69, s69, 15
  s_lshl_b32 s71, s68, 7
  s_and_b32 s73, s69, 1
  s_lshl_b32 s92, s73, 3
  s_add_u32 s92, s92, s70
  s_cmp_lg_u32 s92, 15
  s_cbranch_scc1 L_cw
  s_lshr_b32 s92, s2, 4
  s_getpc_b64 s[64:65]
L_pc:
  s_mov_b32 s66, L_exit-L_pc
  s_mov_b32 s67, 0x00020000
  s_lshl_b32 s92, s92, 13
  v_lshlrev_b32 v253, 7, v1
  buffer_load_dword v254, v253, s[64:67], s92 offen
  s_nop 1
L_cw:
  s_lshr_b32 s74, s69, 1
  s_xor_b32 s74, s74, 0
  s_lshl_b32 s75, s70, 10
  s_lshr_b32 s83, s70, 1
  s_and_b32 s84, s70, 1
  s_lshl_b32 s79, s74, 7
  s_lshl_b32 s86, s74, 16
  v_lshrrev_b32 v250, 3, v1
  v_and_b32 v249, 7, v1
  s_lshl_b32 s93, s84, 2
  v_lshrrev_b32 v246, 1, v250
  v_or_b32 v245, s93, v246
  v_xor_b32 v245, v245, v249
  v_lshlrev_b32 v245, 4, v245
  s_lshl_b32 s94, s70, 3
  v_add_u32 v248, s94, v250
  v_lshl_add_u32 v253, v248, 10, v245
  s_lshl_b32 s92, s69, 3
  s_add_u32 s92, s92, s71
  s_add_u32 s89, s92, s70
  s_lshl_b32 s92, s89, 10
  v_lshlrev_b32 v247, 4, v1
  s_mov_b32 s93, 18874368
  s_waitcnt lgkmcnt(0)
  s_mov_b32 s40, s4
  s_mov_b32 s41, s5
  s_mov_b32 s42, 2097152
  s_mov_b32 s43, 0x00020000
  s_lshr_b32 s23, s2, 5
  s_and_b32 s23, s23, 4
  s_add_u32 s22, s74, s23
  s_add_u32 s22, s22, s2
  s_lshl_b32 s22, s22, 7
  buffer_load_dwordx4 v[4:7], v247, s[40:43], s92 offen
  s_mov_b32 s44, s36
  s_mov_b32 s45, s37
  s_mov_b32 s46, 268435456
  s_mov_b32 s47, 0x00020000
  buffer_load_dword v251, off, s[44:47], s93 sc1
  s_cmp_eq_u32 s73, 0
  s_cbranch_scc1 L_pathM
  s_mov_b32 s48, s10
  s_mov_b32 s49, s11
  s_mov_b32 s50, 524288
  s_mov_b32 s51, 0x00020000
  s_mov_b32 s52, s12
  s_mov_b32 s53, s13
  s_mov_b32 s54, 524288
  s_mov_b32 s55, 0x00020000
  s_lshl_b32 s92, s71, 10
  v_add_u32 v247, s92, v253
  v_add_u32 v246, 0x10000, v247
  s_add_u32 m0, s75, 73728
  s_add_u32 s100, s22, 0
  s_and_b32 s100, s100, 0x380
  buffer_load_dwordx4 v247, s[40:43], s100 offen lds
  s_add_u32 m0, s75, 81920
  s_add_u32 s100, s22, 0
  s_and_b32 s100, s100, 0x380
  buffer_load_dwordx4 v246, s[40:43], s100 offen lds
  s_add_u32 m0, s75, 90112
  s_add_u32 s100, s22, 0
  s_and_b32 s100, s100, 0x380
  s_add_u32 s100, s100, s86
  buffer_load_dwordx4 v253, s[48:51], s100 offen lds
  s_add_u32 m0, s75, 98304
  s_add_u32 s100, s22, 0
  s_and_b32 s100, s100, 0x380
  s_add_u32 s100, s100, s86
  buffer_load_dwordx4 v253, s[52:55], s100 offen lds
  s_cmp_lg_u32 s70, 6
  s_cbranch_scc1 L_hs
  s_lshr_b32 s92, s2, 4
  s_mov_b32 s64, s24
  s_mov_b32 s65, s25
  s_mov_b32 s66, 524288
  s_mov_b32 s94, 65536
  s_mov_b32 s95, 2048
  s_mov_b32 s96, 1024
  s_mov_b32 s97, 384
  s_mov_b32 s98, 0
  s_cmp_ge_u32 s92, 8
  s_cselect_b32 s64, s26, s64
  s_cselect_b32 s65, s27, s65
  s_cselect_b32 s98, 8, s98
  s_cmp_ge_u32 s92, 16
  s_cselect_b32 s66, 0, s66
  s_mov_b32 s67, 0x00020000
  s_sub_u32 s98, s92, s98
  s_mul_i32 s98, s98, s94
  s_add_u32 s98, s98, s97
  v_lshrrev_b32 v244, 1, v1
  v_mul_u32_u24 v244, s95, v244
  v_and_b32 v243, 1, v1
  v_mad_u32_u24 v244, v243, s96, v244
  buffer_load_dword v245, v244, s[64:67], s98 offen
  s_nop 1
L_hs:
  s_cmp_ge_u32 s69, 13
  s_cbranch_scc1 L_pathS0
  s_branch L_pathS3
L_pathM:
  s_mov_b32 s48, s24
  s_mov_b32 s49, s25
  s_mov_b32 s50, 524288
  s_mov_b32 s51, 0x00020000
  s_lshr_b32 s92, s74, 2
  s_add_u32 s92, s92, 1
  s_sub_u32 s93, 0, s92
  s_bitcmp1_b32 s74, 1
  s_cselect_b32 s90, s92, s93
  s_add_u32 s92, s71, s90
  s_lshl_b32 s92, s92, 10
  v_add_u32 v247, s92, v253
  v_bfe_u32 v243, v250, 1, 1
  s_lshl_b32 s93, s84, 1
  v_or_b32 v243, s93, v243
  v_lshlrev_b32 v243, 1, v243
  v_xor_b32 v243, v243, v249
  v_lshlrev_b32 v243, 4, v243
  v_lshl_add_u32 v245, v248, 10, v243
  v_add_u32 v246, 0x10000, v247
  s_and_b32 s22, s22, 0x380
  s_lshl_b32 s80, s22, 9
  s_or_b32 s80, s80, s79
  s_add_u32 m0, s75, 49152
  s_xor_b32 s100, s80, 0
  buffer_load_dwordx4 v245, s[48:51], s100 offen lds
  s_add_u32 m0, s75, 57344
  s_xor_b32 s100, s22, 0
  buffer_load_dwordx4 v247, s[40:43], s100 offen lds
  s_mov_b32 s76, 0x3b000000
  s_mov_b32 s77, 0xbdd2d3e8
  s_mov_b32 s78, 0x3f803f80
  s_lshl_b32 s81, s68, 12
  s_add_u32 s81, s81, 17825792
  s_getreg_b32 s82, hwreg(HW_REG_XCC_ID)
  s_and_b32 s82, s82, 7
  s_min_u32 s85, s69, 13
  s_lshl_b32 s85, s85, 8
  v_lshlrev_b32 v239, 2, v1
  v_lshlrev_b32 v238, 4, v1
  s_lshr_b32 s92, s2, 5
  s_and_b32 s92, s92, 4
  s_and_b32 s93, s2, 7
  s_xor_b32 s92, s92, s93
  s_lshr_b32 s23, s92, 2
  s_xor_b32 s23, s23, s84
  s_lshr_b32 s93, s69, 2
  s_xor_b32 s34, s92, s93
  s_and_b32 s93, s69, 3
  s_xor_b32 s35, s93, s83
  s_and_b32 s93, s34, 3
  s_lshl_b32 s93, s93, 2
  s_or_b32 s35, s35, s93
  s_and_b32 s93, s74, 3
  s_xor_b32 s10, s92, s93
  s_lshr_b32 s11, s74, 2
  s_lshl_b32 s11, s11, 16
  s_and_b32 s12, s10, 3
  s_lshl_b32 s12, s12, 11
  v_bfe_u32 v241, v250, 1, 1
  v_lshlrev_b32 v241, 2, v241
  v_bfe_u32 v240, v250, 2, 1
  v_lshl_add_u32 v241, v240, 1, v241
  v_xor_b32 v241, v241, v249
  v_lshlrev_b32 v241, 4, v241
  v_lshl_add_u32 v252, v248, 10, v241
  v_mul_u32_u24 v240, 3584, v248
  v_add_u32 v236, v240, v241
  s_mov_b32 s52, s26
  s_mov_b32 s53, s27
  s_mov_b32 s54, 524288
  s_mov_b32 s55, 0x00020000
  s_mov_b32 s56, s14
  s_mov_b32 s57, s15
  s_mov_b32 s58, 524288
  s_mov_b32 s59, 0x00020000
  s_add_u32 s60, s28, s85
  s_addc_u32 s61, s29, 0
  s_sub_u32 s62, 1835008, s85
  s_mov_b32 s63, 0x00020000
  s_mov_b32 s14, 229376
  s_bitcmp1_b32 s34, 0
  s_cselect_b32 s14, 4294737920, s14
  s_mov_b32 s15, 458752
  s_bitcmp1_b32 s34, 1
  s_cselect_b32 s15, 4294508544, s15
  s_mov_b32 s11, 917504
  s_bitcmp1_b32 s34, 2
  s_cselect_b32 s11, 4294049792, s11
  s_mul_i32 s34, s34, 229376
  s_lshl_b32 s10, s10, 16
  s_or_b32 s10, s10, s79
  s_lshl_b32 s92, s71, 10
  s_lshl_b32 s93, s70, 13
  s_or_b32 s12, s12, s92
  s_or_b32 s12, s12, s93
  s_add_u32 m0, s75, 65536
  s_xor_b32 s100, s80, 65536
  buffer_load_dwordx4 v245, s[48:51], s100 offen lds
  s_add_u32 m0, s75, 73728
  s_xor_b32 s100, s22, 128
  buffer_load_dwordx4 v247, s[40:43], s100 offen lds
  v_lshrrev_b32 v242, 4, v1
  v_bfe_u32 v244, v1, 2, 2
  v_lshl_add_u32 v243, v242, 3, v244
  v_lshlrev_b32 v250, 7, v243
  v_lshrrev_b32 v244, 1, v244
  v_and_b32 v243, 1, v242
  v_lshl_add_u32 v244, v243, 1, v244
  v_lshlrev_b32 v244, 1, v244
  v_bfe_u32 v243, v1, 1, 1
  s_lshl_b32 s92, s84, 2
  v_add_u32 v243, s92, v243
  v_xor_b32 v243, v243, v244
  v_lshl_add_u32 v250, v243, 4, v250
  v_and_b32 v243, 1, v1
  v_lshl_add_u32 v250, v243, 3, v250
  v_xor_b32 v249, 32, v250
  v_and_b32 v244, 15, v1
  s_lshl_b32 s92, s83, 4
  v_add_u32 v244, s92, v244
  v_bfe_u32 v243, v244, 1, 3
  v_xor_b32 v243, v243, v242
  v_lshlrev_b32 v243, 4, v243
  v_lshl_add_u32 v248, v244, 7, v243
  v_xor_b32 v241, 64, v248
  s_add_u32 s92, s90, 2
  s_lshl_b32 s92, s92, 3
  s_add_u32 s92, s92, 156704
  v_lshl_add_u32 v232, v244, 3, s92
  v_lshlrev_b32 v231, 3, v244
  v_add_u32 v231, 155648, v231
  v_lshlrev_b32 v243, 4, v242
  v_lshl_add_u32 v230, v244, 10, v243
  s_lshl_b32 s92, s71, 10
  s_lshl_b32 s93, s84, 6
  s_add_u32 s92, s92, s93
  s_add_u32 s92, s92, s79
  v_add_u32 v230, s92, v230
  s_lshl_b32 s90, s89, 4
  s_add_u32 s90, s90, 17563648
  s_lshr_b32 s92, s71, 4
  s_add_u32 s92, s92, s83
  s_lshl_b32 s92, s92, 4
  s_lshl_b32 s93, s74, 1
  s_add_u32 s93, s93, s84
  s_add_u32 s92, s92, s93
  s_lshl_b32 s87, s92, 10
  s_lshl_b32 s92, s83, 4
  s_add_u32 s92, s92, s93
  s_lshl_b32 s92, s92, 2
  s_add_u32 s88, s92, s81
  s_lshl_b32 s93, s70, 5
  s_add_u32 s91, s93, s81
  v_bfe_u32 v244, v1, 2, 2
  v_lshl_add_u32 v243, v242, 2, v244
  v_lshlrev_b32 v240, 7, v243
  v_lshrrev_b32 v244, 1, v244
  v_lshlrev_b32 v244, 2, v244
  v_and_b32 v243, 1, v242
  v_lshl_add_u32 v244, v243, 1, v244
  v_bfe_u32 v243, v1, 1, 1
  s_lshl_b32 s92, s84, 2
  v_add_u32 v243, s92, v243
  v_xor_b32 v243, v243, v244
  v_lshl_add_u32 v240, v243, 4, v240
  v_and_b32 v243, 1, v1
  v_lshl_add_u32 v240, v243, 3, v240
  s_lshl_b32 s92, s23, 15
  s_add_u32 s92, s92, 49152
  v_add_u32 v240, s92, v240
  v_xor_b32 v235, 32, v240
  v_xor_b32 v234, 64, v240
  v_xor_b32 v233, 96, v240
  v_add_u32 v229, 65536, v250
  v_add_u32 v228, 131072, v250
  v_add_u32 v227, 65536, v249
  v_add_u32 v226, 131072, v249
  v_add_u32 v225, 65536, v248
  v_add_u32 v224, 131072, v248
  v_add_u32 v223, 65536, v241
  v_add_u32 v222, 131072, v241
  v_mov_b32 v160, s78
  v_mov_b32 v161, s78
  v_mov_b32 v162, s78
  v_mov_b32 v163, s78
  v_mov_b32 v244, 0xc0135761
  s_add_u32 m0, s75, 81920
  s_xor_b32 s100, s80, 131072
  buffer_load_dwordx4 v245, s[48:51], s100 offen lds
  s_add_u32 m0, s75, 90112
  s_xor_b32 s100, s22, 256
  buffer_load_dwordx4 v247, s[40:43], s100 offen lds
  v_lshrrev_b32 v218, 4, v1
  v_and_b32 v220, 15, v1
  v_and_b32 v219, 1, v218
  v_lshl_add_u32 v220, v219, 5, v220
  v_lshlrev_b32 v220, 4, v220
  v_lshrrev_b32 v219, 1, v218
  v_lshl_add_u32 v243, v219, 10, v220
  v_lshlrev_b32 v218, 28, v218
  v_lshl_add_u32 v221, v1, 3, v218
  s_lshl_b32 s92, s70, 11
  s_add_u32 s92, s92, 32768
  v_add_u32 v242, s92, v238
  s_lshr_b32 s92, s71, 5
  s_lshr_b32 s93, s70, 2
  s_add_u32 s92, s92, s93
  s_lshl_b32 s94, s74, 1
  s_add_u32 s94, s94, s84
  s_and_b32 s95, s83, 1
  s_lshl_b32 s92, s92, 4
  s_add_u32 s92, s92, s94
  s_lshl_b32 s92, s92, 1
  s_add_u32 s92, s92, s95
  s_lshl_b32 s37, s92, 7
  s_lshl_b32 s93, s93, 5
  s_lshl_b32 s95, s95, 4
  s_add_u32 s93, s93, s95
  s_add_u32 s93, s93, s94
  s_lshl_b32 s93, s93, 2
  s_add_u32 s93, s93, s81
  s_add_u32 s89, s93, 1024
  s_lshl_b32 s92, s37, 3
  s_and_b32 s92, s92, 0xfffff800
  s_and_b32 s93, s37, 128
  s_lshl_b32 s93, s93, 1
  s_add_u32 s92, s92, s93
  s_add_u32 s36, s92, 2097152
  s_add_u32 s37, s37, 17039360
  s_lshl_b32 s28, s83, 10
  s_lshl_b32 s13, s84, 12
  s_lshr_b32 s92, s2, 7
  s_lshl_b32 s3, s92, 1
  s_add_u32 s3, s3, s73
  s_lshl_b32 s3, s3, 1
  s_add_u32 s3, s3, s74
  s_add_u32 s3, s3, s2
  s_lshl_b32 s3, s3, 7
  s_and_b32 s3, s3, 0x380
  s_add_u32 s3, s3, s86
  s_mul_i32 s92, s92, 7
  s_mul_i32 s93, s73, 3
  s_add_u32 s92, s92, s93
  s_lshl_b32 s93, s74, 1
  s_add_u32 s92, s92, s93
  s_sub_u32 s93, s92, 14
  s_min_u32 s92, s92, s93
  s_and_b32 s93, s2, 7
  s_lshl_b32 s93, s93, 1
  s_add_u32 s92, s92, s93
  s_sub_u32 s93, s92, 14
  s_min_u32 s92, s92, s93
  s_sub_u32 s93, s92, 14
  s_min_u32 s92, s92, s93
  s_lshl_b32 s1, s92, 13
  s_lshl_b32 s0, s92, 17
  s_add_u32 s0, s0, s79
  s_lshr_b32 s92, s71, 5
  s_lshl_b32 s93, s73, 1
  s_add_u32 s93, s93, s84
  s_add_u32 s92, s92, s93
  s_mul_i32 s4, s92, 114688
  s_add_u32 s4, s4, 8388608
  s_add_u32 s4, s4, s28
  s_lshl_b32 s8, s92, 16
  s_lshl_b32 s94, s83, 11
  s_add_u32 s8, s8, s94
  s_add_u32 s8, s8, 4194304
  s_and_b32 s94, s3, 0x380
  s_lshl_b32 s94, s94, 6
  s_add_u32 s8, s8, s94
  s_lshl_b32 s93, s93, 1
  s_lshr_b32 s94, s70, 2
  s_add_u32 s93, s93, s94
  s_lshl_b32 s94, s93, 5
  s_add_u32 s94, s94, s81
  s_add_u32 s5, s94, 2048
  s_lshl_b32 s94, s93, 6
  s_add_u32 s94, s94, s81
  s_add_u32 s6, s94, 3072
  s_lshl_b32 s92, s70, 6
  s_lshr_b32 s93, s85, 6
  s_add_u32 s92, s92, s93
  s_add_u32 s92, s92, s81
  s_add_u32 s9, s92, 3072
  s_bfe_u32 s92, s35, 0x10001
  s_lshl_b32 s92, s92, 12
  s_and_b32 s93, s35, 1
  s_lshl_b32 s93, s93, 10
  s_or_b32 s92, s92, s93
  s_mov_b32 s24, 81920
  s_cmp_eq_u32 s23, 0
  s_cselect_b32 s93, 114688, 0
  s_cselect_b32 s24, 4294901760, s24
  s_add_u32 s25, s92, s93
  s_lshr_b32 s92, s71, 5
  s_add_u32 s92, s92, s83
  s_mul_i32 s18, s92, 114688
  s_lshl_b32 s93, s85, 5
  s_add_u32 s18, s18, s93
  s_lshl_b32 s93, s84, 11
  s_add_u32 s18, s18, s93
  s_add_u32 s18, s18, 8388608
  s_lshl_b32 s92, s92, 1
  s_add_u32 s92, s92, s84
  s_lshl_b32 s93, s92, 11
  s_add_u32 s7, s93, 17039360
  s_lshl_b32 s92, s92, 14
  s_add_u32 s19, s92, 2097152
  s_lshl_b32 s92, s35, 10
  s_add_u32 s19, s19, s92
  s_lshl_b32 s92, s75, 3
  s_add_u32 s93, s92, 114688
  s_sub_u32 s92, s92, 32768
  s_cmp_lt_u32 s70, 4
  s_cselect_b32 s29, s93, s92
  s_mov_b32 s26, 114688
  s_cmp_eq_u32 s83, 1
  s_cselect_b32 s26, 122880, s26
  s_cmp_eq_u32 s83, 2
  s_cselect_b32 s26, 0, s26
  s_cmp_eq_u32 s83, 3
  s_cselect_b32 s26, 8192, s26
  s_add_u32 s26, s26, s13
  s_mov_b32 s27, 49152
  s_cmp_eq_u32 s83, 1
  s_cselect_b32 s27, 57344, s27
  s_cmp_eq_u32 s83, 2
  s_cselect_b32 s27, 81920, s27
  s_cmp_eq_u32 s83, 3
  s_cselect_b32 s27, 90112, s27
  s_add_u32 s27, s27, s13
  v_mov_b32 v220, 0
  v_mov_b32 v219, 0
  s_waitcnt vmcnt(7)
  v_dot2c_f32_bf16 v220, s78, v4
  v_dot2c_f32_bf16 v219, v4, v4
  v_dot2c_f32_bf16 v220, s78, v5
  v_dot2c_f32_bf16 v219, v5, v5
  v_dot2c_f32_bf16 v220, s78, v6
  v_dot2c_f32_bf16 v219, v6, v6
  v_dot2c_f32_bf16 v220, s78, v7
  v_dot2c_f32_bf16 v219, v7, v7
  s_nop 1
  v_add_f32_dpp v220, v220, v220 quad_perm:[1,0,3,2] row_mask:0xf bank_mask:0xf
  v_add_f32_dpp v219, v219, v219 quad_perm:[1,0,3,2] row_mask:0xf bank_mask:0xf
  s_nop 0
  v_add_f32_dpp v220, v220, v220 quad_perm:[2,3,0,1] row_mask:0xf bank_mask:0xf
  v_add_f32_dpp v219, v219, v219 quad_perm:[2,3,0,1] row_mask:0xf bank_mask:0xf
  s_nop 0
  v_add_f32_dpp v220, v220, v220 row_half_mirror row_mask:0xf bank_mask:0xf
  v_add_f32_dpp v219, v219, v219 row_half_mirror row_mask:0xf bank_mask:0xf
  s_nop 0
  v_add_f32_dpp v220, v220, v220 row_mirror row_mask:0xf bank_mask:0xf
  v_add_f32_dpp v219, v219, v219 row_mirror row_mask:0xf bank_mask:0xf
  v_mov_b32 v200, v220
  v_mov_b32 v201, v219
  s_nop 0
  v_permlane16_swap_b32 v220, v200
  v_permlane16_swap_b32 v219, v201
  v_add_f32 v220, v220, v200
  v_add_f32 v219, v219, v201
  v_mov_b32 v200, v220
  v_mov_b32 v201, v219
  s_nop 0
  v_permlane32_swap_b32 v220, v200
  v_permlane32_swap_b32 v219, v201
  v_add_f32 v220, v220, v200
  v_add_f32 v219, v219, v201
  v_mul_f32 v200, 0x3b000000, v220
  v_mul_f32 v207, v200, v200
  v_fma_f32 v201, v219, s76, -v207
  v_max_f32 v201, 0, v201
  v_cvt_pk_bf16_f32 v202, v200, v200
  v_and_b32 v202, 0xffff0000, v202
  v_cvt_pk_bf16_f32 v207, v201, v201
  v_and_b32 v207, 0xffff0000, v207
  v_add_f32 v207, 0x3727c5ac, v207
  v_cvt_pk_bf16_f32 v207, v207, v207
  v_and_b32 v207, 0xffff0000, v207
  v_sqrt_f32 v207, v207
  s_nop 0
  v_cvt_pk_bf16_f32 v203, v207, v207
  v_and_b32 v203, 0xffff0000, v203
  v_rcp_f32 v204, v203
  v_sub_f32 v207, v200, v202
  v_mul_f32 v205, v207, v204
  v_mul_f32 v207, v201, v204
  v_mul_f32 v207, v207, v204
  v_cvt_pk_bf16_f32 v207, v207, v207
  v_and_b32 v207, 0xffff0000, v207
  v_add_f32 v207, 0x3727c5ac, v207
  v_cvt_pk_bf16_f32 v207, v207, v207
  v_and_b32 v207, 0xffff0000, v207
  v_sqrt_f32 v206, v207
  v_cvt_pk_bf16_f32 v208, v202, v203
  v_cvt_pk_bf16_f32 v210, v205, v206
  s_waitcnt vmcnt(6)
  v_readfirstlane_b32 s72, v251
  s_add_u32 s72, s72, 1
  s_lshl_b32 s92, s82, 29
  s_xor_b32 s92, s92, s72
  v_mov_b32 v209, s72
  v_mov_b32 v211, s92
  v_mov_b32 v237, s72
  s_mov_b64 exec, 1
  buffer_store_dwordx4 v[208:211], off, s[44:47], s90 sc1
  s_mov_b64 exec, -1
  s_add_u32 s90, s87, 65536
  s_waitcnt vmcnt(5)
  s_waitcnt lgkmcnt(0)
  s_barrier
  s_add_u32 m0, s75, 98304
  s_xor_b32 s100, s80, 196608
  buffer_load_dwordx4 v245, s[48:51], s100 offen lds
  s_add_u32 m0, s75, 106496
  s_xor_b32 s100, s22, 384
  buffer_load_dwordx4 v247, s[40:43], s100 offen lds
  ds_read_b64_tr_b16 v[8:9], v250 offset:49152
  ds_read_b64_tr_b16 v[10:11], v250 offset:49664
  ds_read_b64_tr_b16 v[12:13], v249 offset:49152
  ds_read_b64_tr_b16 v[14:15], v249 offset:49664
  ds_read_b128 v[168:171], v248 offset:57344
  ds_read_b64_tr_b16 v[16:17], v250 offset:53248
  ds_read_b64_tr_b16 v[18:19], v250 offset:53760
  ds_read_b64_tr_b16 v[20:21], v249 offset:53248
  ds_read_b64_tr_b16 v[22:23], v249 offset:53760
  ds_read_b128 v[172:175], v241 offset:57344
  s_waitcnt vmcnt(5)
  s_waitcnt lgkmcnt(0)
  s_barrier
  s_add_u32 m0, s75, 114688
  s_xor_b32 s100, s80, 262144
  buffer_load_dwordx4 v245, s[48:51], s100 offen lds
  s_add_u32 m0, s75, 122880
  s_xor_b32 s100, s22, 512
  buffer_load_dwordx4 v247, s[40:43], s100 offen lds
  ds_read_b64_tr_b16 v[24:25], v229
  ds_read_b64_tr_b16 v[26:27], v229 offset:512
  ds_read_b64_tr_b16 v[28:29], v227
  ds_read_b64_tr_b16 v[30:31], v227 offset:512
  ds_read_b128 v[176:179], v225 offset:8192
  ds_read_b64_tr_b16 v[32:33], v229 offset:4096
  ds_read_b64_tr_b16 v[34:35], v229 offset:4608
  ds_read_b64_tr_b16 v[36:37], v227 offset:4096
  ds_read_b64_tr_b16 v[38:39], v227 offset:4608
  ds_read_b128 v[180:183], v223 offset:8192
  v_mfma_f32_16x16x32_bf16 v[136:139], v[8:11], v[168:171], 0
  v_mfma_f32_16x16x32_bf16 v[140:143], v[12:15], v[168:171], 0
  v_mfma_f32_16x16x32_bf16 v[152:155], v[8:11], v[160:163], 0
  v_mfma_f32_16x16x32_bf16 v[156:159], v[12:15], v[160:163], 0
  v_mfma_f32_16x16x32_bf16 v[136:139], v[16:19], v[172:175], v[136:139]
  v_mfma_f32_16x16x32_bf16 v[140:143], v[20:23], v[172:175], v[140:143]
  v_mfma_f32_16x16x32_bf16 v[152:155], v[16:19], v[160:163], v[152:155]
  v_mfma_f32_16x16x32_bf16 v[156:159], v[20:23], v[160:163], v[156:159]
  s_waitcnt vmcnt(5)
  s_waitcnt lgkmcnt(0)
  s_barrier
  s_add_u32 m0, s75, 131072
  s_xor_b32 s100, s80, 327680
  buffer_load_dwordx4 v245, s[48:51], s100 offen lds
  s_add_u32 m0, s75, 139264
  s_xor_b32 s100, s22, 640
  buffer_load_dwordx4 v247, s[40:43], s100 offen lds
  ds_read_b64_tr_b16 v[40:41], v229 offset:16384
  ds_read_b64_tr_b16 v[42:43], v229 offset:16896
  ds_read_b64_tr_b16 v[44:45], v227 offset:16384
  ds_read_b64_tr_b16 v[46:47], v227 offset:16896
  ds_read_b128 v[168:171], v225 offset:24576
  ds_read_b64_tr_b16 v[48:49], v229 offset:20480
  ds_read_b64_tr_b16 v[50:51], v229 offset:20992
  ds_read_b64_tr_b16 v[52:53], v227 offset:20480
  ds_read_b64_tr_b16 v[54:55], v227 offset:20992
  ds_read_b128 v[172:175], v223 offset:24576
  v_mfma_f32_16x16x32_bf16 v[136:139], v[24:27], v[176:179], v[136:139]
  v_mfma_f32_16x16x32_bf16 v[140:143], v[28:31], v[176:179], v[140:143]
  v_mfma_f32_16x16x32_bf16 v[152:155], v[24:27], v[160:163], v[152:155]
  v_mfma_f32_16x16x32_bf16 v[156:159], v[28:31], v[160:163], v[156:159]
  v_mfma_f32_16x16x32_bf16 v[136:139], v[32:35], v[180:183], v[136:139]
  v_mfma_f32_16x16x32_bf16 v[140:143], v[36:39], v[180:183], v[140:143]
  v_mfma_f32_16x16x32_bf16 v[152:155], v[32:35], v[160:163], v[152:155]
  v_mfma_f32_16x16x32_bf16 v[156:159], v[36:39], v[160:163], v[156:159]
  s_waitcnt vmcnt(4)
  s_waitcnt lgkmcnt(0)
  s_barrier
  s_add_u32 m0, s75, 0
  s_xor_b32 s100, s80, 393216
  buffer_load_dwordx4 v245, s[48:51], s100 offen lds
  s_add_u32 m0, s75, 8192
  s_xor_b32 s100, s22, 768
  buffer_load_dwordx4 v247, s[40:43], s100 offen lds
  ds_read_b64_tr_b16 v[56:57], v229 offset:32768
  ds_read_b64_tr_b16 v[58:59], v229 offset:33280
  ds_read_b64_tr_b16 v[60:61], v227 offset:32768
  ds_read_b64_tr_b16 v[62:63], v227 offset:33280
  ds_read_b128 v[176:179], v225 offset:40960
  ds_read_b64_tr_b16 v[64:65], v229 offset:36864
  ds_read_b64_tr_b16 v[66:67], v229 offset:37376
  ds_read_b64_tr_b16 v[68:69], v227 offset:36864
  ds_read_b64_tr_b16 v[70:71], v227 offset:37376
  ds_read_b128 v[180:183], v223 offset:40960
  v_mfma_f32_16x16x32_bf16 v[136:139], v[40:43], v[168:171], v[136:139]
  v_mfma_f32_16x16x32_bf16 v[140:143], v[44:47], v[168:171], v[140:143]
  v_mfma_f32_16x16x32_bf16 v[152:155], v[40:43], v[160:163], v[152:155]
  v_mfma_f32_16x16x32_bf16 v[156:159], v[44:47], v[160:163], v[156:159]
  v_mfma_f32_16x16x32_bf16 v[136:139], v[48:51], v[172:175], v[136:139]
  v_mfma_f32_16x16x32_bf16 v[140:143], v[52:55], v[172:175], v[140:143]
  v_mfma_f32_16x16x32_bf16 v[152:155], v[48:51], v[160:163], v[152:155]
  v_mfma_f32_16x16x32_bf16 v[156:159], v[52:55], v[160:163], v[156:159]
  v_mov_b32 v251, 0
  s_cmp_ge_u32 s70, 3
  s_nop 5
  s_cbranch_scc1 L_si_M_1
  s_sub_u32 s92, s70, 0
  s_lshl_b32 s92, s92, 6
  v_add_u32 v220, s92, v1
  v_min_u32 v220, 131, v220
  s_sub_u32 s92, s71, 2
  v_add_u32 v219, s92, v220
  v_max_i32 v219, 0, v219
  v_min_i32 v219, 2047, v219
  v_lshlrev_b32 v251, 4, v219
  s_mov_b32 s92, 17563648
  buffer_load_dwordx4 v[200:203], v251, s[44:47], s92 offen sc1
  s_nop 0
L_si_M_1:
  s_waitcnt vmcnt(4)
  s_waitcnt lgkmcnt(0)
  s_barrier
  s_add_u32 m0, s75, 16384
  s_xor_b32 s100, s80, 458752
  buffer_load_dwordx4 v245, s[48:51], s100 offen lds
  s_add_u32 m0, s75, 24576
  s_xor_b32 s100, s22, 896
  buffer_load_dwordx4 v247, s[40:43], s100 offen lds
  ds_read_b64_tr_b16 v[72:73], v229 offset:49152
  ds_read_b64_tr_b16 v[74:75], v229 offset:49664
  ds_read_b64_tr_b16 v[76:77], v227 offset:49152
  ds_read_b64_tr_b16 v[78:79], v227 offset:49664
  ds_read_b128 v[168:171], v225 offset:57344
  ds_read_b64_tr_b16 v[80:81], v229 offset:53248
  ds_read_b64_tr_b16 v[82:83], v229 offset:53760
  ds_read_b64_tr_b16 v[84:85], v227 offset:53248
  ds_read_b64_tr_b16 v[86:87], v227 offset:53760
  ds_read_b128 v[172:175], v223 offset:57344
  v_mfma_f32_16x16x32_bf16 v[136:139], v[56:59], v[176:179], v[136:139]
  v_mfma_f32_16x16x32_bf16 v[140:143], v[60:63], v[176:179], v[140:143]
  v_mfma_f32_16x16x32_bf16 v[152:155], v[56:59], v[160:163], v[152:155]
  v_mfma_f32_16x16x32_bf16 v[156:159], v[60:63], v[160:163], v[156:159]
  v_mfma_f32_16x16x32_bf16 v[136:139], v[64:67], v[180:183], v[136:139]
  v_mfma_f32_16x16x32_bf16 v[140:143], v[68:71], v[180:183], v[140:143]
  v_mfma_f32_16x16x32_bf16 v[152:155], v[64:67], v[160:163], v[152:155]
  v_mfma_f32_16x16x32_bf16 v[156:159], v[68:71], v[160:163], v[156:159]
  s_waitcnt vmcnt(4)
  s_waitcnt lgkmcnt(0)
  s_barrier
  s_add_u32 m0, s75, 32768
  s_xor_b32 s100, s22, 0
  buffer_load_dwordx4 v246, s[40:43], s100 offen lds
  s_add_u32 m0, s75, 40960
  s_xor_b32 s100, s22, 128
  buffer_load_dwordx4 v246, s[40:43], s100 offen lds
  ds_read_b64_tr_b16 v[88:89], v228
  ds_read_b64_tr_b16 v[90:91], v228 offset:512
  ds_read_b64_tr_b16 v[92:93], v226
  ds_read_b64_tr_b16 v[94:95], v226 offset:512
  ds_read_b128 v[176:179], v224 offset:8192
  ds_read_b64_tr_b16 v[96:97], v228 offset:4096
  ds_read_b64_tr_b16 v[98:99], v228 offset:4608
  ds_read_b64_tr_b16 v[100:101], v226 offset:4096
  ds_read_b64_tr_b16 v[102:103], v226 offset:4608
  ds_read_b128 v[180:183], v222 offset:8192
  v_mfma_f32_16x16x32_bf16 v[136:139], v[72:75], v[168:171], v[136:139]
  v_mfma_f32_16x16x32_bf16 v[140:143], v[76:79], v[168:171], v[140:143]
  v_mfma_f32_16x16x32_bf16 v[152:155], v[72:75], v[160:163], v[152:155]
  v_mfma_f32_16x16x32_bf16 v[156:159], v[76:79], v[160:163], v[156:159]
  v_mfma_f32_16x16x32_bf16 v[136:139], v[80:83], v[172:175], v[136:139]
  v_mfma_f32_16x16x32_bf16 v[140:143], v[84:87], v[172:175], v[140:143]
  v_mfma_f32_16x16x32_bf16 v[152:155], v[80:83], v[160:163], v[152:155]
  v_mfma_f32_16x16x32_bf16 v[156:159], v[84:87], v[160:163], v[156:159]
  s_waitcnt vmcnt(4)
  s_waitcnt lgkmcnt(0)
  s_barrier
  s_add_u32 m0, s75, 147456
  s_xor_b32 s100, s22, 256
  buffer_load_dwordx4 v246, s[40:43], s100 offen lds
  s_add_u32 m0, s75, 114688
  s_xor_b32 s100, s22, 384
  buffer_load_dwordx4 v246, s[40:43], s100 offen lds
  ds_read_b64_tr_b16 v[104:105], v250
  ds_read_b64_tr_b16 v[106:107], v250 offset:512
  ds_read_b64_tr_b16 v[108:109], v249
  ds_read_b64_tr_b16 v[110:111], v249 offset:512
  ds_read_b128 v[168:171], v248 offset:8192
  ds_read_b64_tr_b16 v[112:113], v250 offset:4096
  ds_read_b64_tr_b16 v[114:115], v250 offset:4608
  ds_read_b64_tr_b16 v[116:117], v249 offset:4096
  ds_read_b64_tr_b16 v[118:119], v249 offset:4608
  ds_read_b128 v[172:175], v241 offset:8192
  v_mfma_f32_16x16x32_bf16 v[136:139], v[88:91], v[176:179], v[136:139]
  v_mfma_f32_16x16x32_bf16 v[140:143], v[92:95], v[176:179], v[140:143]
  v_mfma_f32_16x16x32_bf16 v[152:155], v[88:91], v[160:163], v[152:155]
  v_mfma_f32_16x16x32_bf16 v[156:159], v[92:95], v[160:163], v[156:159]
  v_mfma_f32_16x16x32_bf16 v[136:139], v[96:99], v[180:183], v[136:139]
  v_mfma_f32_16x16x32_bf16 v[140:143], v[100:103], v[180:183], v[140:143]
  v_mfma_f32_16x16x32_bf16 v[152:155], v[96:99], v[160:163], v[152:155]
  v_mfma_f32_16x16x32_bf16 v[156:159], v[100:103], v[160:163], v[156:159]
  s_cmp_ge_u32 s70, 3
  s_nop 6
  s_cbranch_scc1 L_sc_M_2
  s_waitcnt vmcnt(6)
  v_mov_b32 v210, v201
  s_mov_b32 s93, 200000
  s_mov_b32 s92, 17563648
  s_nop 0
L_sl_M_3:
  v_xor_b32 v210, s72, v201
  v_xor_b32 v211, s72, v203
  v_lshlrev_b32 v208, 3, v211
  v_or_b32 v210, v210, v208
  v_cmp_ne_u32 vcc, 0, v210
  s_nop 4
  s_cbranch_vccz L_sd_M_4
  buffer_load_dwordx4 v[200:203], v251, s[44:47], s92 offen sc1
  s_waitcnt vmcnt(0)
  s_sub_u32 s93, s93, 1
  s_cmp_lg_u32 s93, 0
  s_cbranch_scc1 L_sl_M_3
L_sd_M_4:
  v_lshrrev_b32 v211, 29, v211
  v_subrev_u32 v210, 2, v220
  v_cmp_gt_u32 vcc, 128, v210
  v_cmp_ne_u32 s[94:95], s82, v211
  s_and_b64 vcc, vcc, s[94:95]
  s_cselect_b32 s94, 1, 0
  s_lshl_b32 s95, s70, 2
  s_add_u32 s95, s95, 162912
  v_mov_b32 v210, s94
  v_mov_b32 v211, s95
  ds_write_b32 v211, v210
  s_sub_u32 s92, s71, 2
  v_add_u32 v210, s92, v220
  v_cmp_gt_u32 vcc, 2048, v210
  s_nop 1
  v_cndmask_b32 v219, 0, 1.0, vcc
  v_lshlrev_b32 v204, 16, v200
  v_and_b32 v205, 0xffff0000, v200
  v_lshlrev_b32 v206, 16, v202
  v_and_b32 v207, 0xffff0000, v202
  v_rcp_f32 v208, v205
  v_rcp_f32 v209, v207
  v_mul_f32 v204, v204, v219
  v_mul_f32 v206, v206, v219
  v_mov_b32 v2, v208
  v_mul_f32 v3, v204, v208
  v_mul_f32 v212, v208, v209
  v_fma_f32 v210, v206, v205, v204
  v_mul_f32 v213, v210, v212
  v_mov_b32 v214, v204
  v_mov_b32 v215, v208
  v_lshlrev_b32 v211, 3, v220
  v_add_u32 v211, 155648, v211
  ds_write_b64 v211, v[2:3] offset:0
  ds_write_b64 v211, v[212:213] offset:1056
  ds_write_b64 v211, v[214:215] offset:2112
L_sc_M_2:
  s_waitcnt vmcnt(4)
  s_waitcnt lgkmcnt(0)
  s_barrier
  s_add_u32 m0, s75, 122880
  s_xor_b32 s100, s22, 512
  buffer_load_dwordx4 v246, s[40:43], s100 offen lds
  s_add_u32 m0, s75, 131072
  s_xor_b32 s100, s22, 640
  buffer_load_dwordx4 v246, s[40:43], s100 offen lds
  s_mov_b32 s98, 65536
  buffer_load_dwordx4 v[200:203], v230, s[40:43], 0 offen
  buffer_load_dwordx4 v[204:207], v230, s[40:43], s98 offen
  ds_read_b64_tr_b16 v[120:121], v250 offset:16384
  ds_read_b64_tr_b16 v[122:123], v250 offset:16896
  ds_read_b64_tr_b16 v[124:125], v249 offset:16384
  ds_read_b64_tr_b16 v[126:127], v249 offset:16896
  ds_read_b128 v[176:179], v248 offset:24576
  ds_read_b64_tr_b16 v[128:129], v250 offset:20480
  ds_read_b64_tr_b16 v[130:131], v250 offset:20992
  ds_read_b64_tr_b16 v[132:133], v249 offset:20480
  ds_read_b64_tr_b16 v[134:135], v249 offset:20992
  ds_read_b128 v[180:183], v241 offset:24576
  ds_read_b64 v[164:165], v232
  ds_read_b64 v[166:167], v232 offset:512
  v_mov_b32 v7, 162912
  ds_read_b96 v[4:6], v7
  v_mfma_f32_16x16x32_bf16 v[136:139], v[104:107], v[168:171], v[136:139]
  v_mfma_f32_16x16x32_bf16 v[140:143], v[108:111], v[168:171], v[140:143]
  v_mfma_f32_16x16x32_bf16 v[152:155], v[104:107], v[160:163], v[152:155]
  v_mfma_f32_16x16x32_bf16 v[156:159], v[108:111], v[160:163], v[156:159]
  v_mfma_f32_16x16x32_bf16 v[136:139], v[112:115], v[172:175], v[136:139]
  v_mfma_f32_16x16x32_bf16 v[140:143], v[116:119], v[172:175], v[140:143]
  v_mfma_f32_16x16x32_bf16 v[152:155], v[112:115], v[160:163], v[152:155]
  v_mfma_f32_16x16x32_bf16 v[156:159], v[116:119], v[160:163], v[156:159]
  s_waitcnt lgkmcnt(8)
  v_mfma_f32_16x16x32_bf16 v[136:139], v[120:123], v[176:179], v[136:139]
  v_mfma_f32_16x16x32_bf16 v[140:143], v[124:127], v[176:179], v[140:143]
  v_mfma_f32_16x16x32_bf16 v[152:155], v[120:123], v[160:163], v[152:155]
  v_mfma_f32_16x16x32_bf16 v[156:159], v[124:127], v[160:163], v[156:159]
  s_waitcnt lgkmcnt(3)
  v_mfma_f32_16x16x32_bf16 v[136:139], v[128:131], v[180:183], v[136:139]
  v_mfma_f32_16x16x32_bf16 v[140:143], v[132:135], v[180:183], v[140:143]
  v_mfma_f32_16x16x32_bf16 v[152:155], v[128:131], v[160:163], v[152:155]
  v_mfma_f32_16x16x32_bf16 v[156:159], v[132:135], v[160:163], v[156:159]
  s_waitcnt lgkmcnt(0)
  v_or3_b32 v4, v4, v5, v6
  s_nop 0
  v_readfirstlane_b32 s80, v4
  s_nop 2
  v_mul_f32 v192, v165, v152
  v_mul_f32 v193, v165, v153
  v_mul_f32 v194, v165, v154
  v_mul_f32 v195, v165, v155
  v_mul_f32 v196, v165, v156
  v_mul_f32 v197, v165, v157
  v_mul_f32 v198, v165, v158
  v_mul_f32 v199, v165, v159
  v_fma_f32 v136, v164, v136, -v192
  v_fma_f32 v137, v164, v137, -v193
  v_fma_f32 v138, v164, v138, -v194
  v_fma_f32 v139, v164, v139, -v195
  v_fma_f32 v140, v164, v140, -v196
  v_fma_f32 v141, v164, v141, -v197
  v_fma_f32 v142, v164, v142, -v198
  v_fma_f32 v143, v164, v143, -v199
  s_waitcnt vmcnt(6)
  s_waitcnt lgkmcnt(0)
  s_barrier
  s_add_u32 m0, s75, 139264
  s_xor_b32 s100, s22, 768
  buffer_load_dwordx4 v246, s[40:43], s100 offen lds
  s_add_u32 m0, s75, 0
  s_xor_b32 s100, s22, 896
  buffer_load_dwordx4 v246, s[40:43], s100 offen lds
  ds_read_b128 v[168:171], v248 offset:32768
  ds_read_b128 v[172:175], v241 offset:32768
  ds_read_b128 v[176:179], v248 offset:40960
  ds_read_b128 v[180:183], v241 offset:40960
  s_waitcnt lgkmcnt(3)
  v_mfma_f32_16x16x32_bf16 v[144:147], v[8:11], v[168:171], 0
  v_mul_f32 v192, v136, v136
  v_mul_f32 v193, v137, v137
  v_mul_f32 v194, v138, v138
  v_mul_f32 v195, v139, v139
  v_mul_f32 v196, v140, v140
  v_mul_f32 v197, v141, v141
  v_mfma_f32_16x16x32_bf16 v[148:151], v[12:15], v[168:171], 0
  v_mul_f32 v198, v142, v142
  v_mul_f32 v199, v143, v143
  v_fma_f32 v192, v192, s77, v244
  v_fma_f32 v193, v193, s77, v244
  v_fma_f32 v194, v194, s77, v244
  v_fma_f32 v195, v195, s77, v244
  s_waitcnt lgkmcnt(2)
  v_mfma_f32_16x16x32_bf16 v[144:147], v[16:19], v[172:175], v[144:147]
  v_fma_f32 v196, v196, s77, v244
  v_fma_f32 v197, v197, s77, v244
  v_fma_f32 v198, v198, s77, v244
  v_fma_f32 v199, v199, s77, v244
  v_mul_f32 v192, v192, v136
  v_mul_f32 v193, v193, v137
  v_mfma_f32_16x16x32_bf16 v[148:151], v[20:23], v[172:175], v[148:151]
  v_mul_f32 v194, v194, v138
  v_mul_f32 v195, v195, v139
  v_mul_f32 v196, v196, v140
  v_mul_f32 v197, v197, v141
  v_mul_f32 v198, v198, v142
  v_mul_f32 v199, v199, v143
  s_waitcnt vmcnt(6)
  s_waitcnt lgkmcnt(0)
  s_barrier
  ds_read_b128 v[184:187], v224 offset:16384
  ds_read_b128 v[188:191], v222 offset:16384
  ds_read_b128 v[168:171], v225 offset:49152
  ds_read_b128 v[172:175], v223 offset:49152
  v_mfma_f32_16x16x32_bf16 v[144:147], v[24:27], v[176:179], v[144:147]
  v_exp_f32 v192, v192
  v_exp_f32 v193, v193
  v_exp_f32 v194, v194
  v_mfma_f32_16x16x32_bf16 v[148:151], v[28:31], v[176:179], v[148:151]
  v_exp_f32 v195, v195
  v_exp_f32 v196, v196
  v_exp_f32 v197, v197
  s_add_u32 m0, s75, 49152
  s_xor_b32 s100, s10, 0
  buffer_load_dwordx4 v252, s[52:55], s100 offen lds
  v_mfma_f32_16x16x32_bf16 v[144:147], v[32:35], v[180:183], v[144:147]
  v_exp_f32 v198, v198
  v_exp_f32 v199, v199
  v_add_f32 v192, 1.0, v192
  v_add_f32 v193, 1.0, v193
  v_mfma_f32_16x16x32_bf16 v[148:151], v[36:39], v[180:183], v[148:151]
  v_add_f32 v194, 1.0, v194
  v_add_f32 v195, 1.0, v195
  v_add_f32 v196, 1.0, v196
  v_add_f32 v197, 1.0, v197
  v_add_f32 v198, 1.0, v198
  v_add_f32 v199, 1.0, v199
  s_waitcnt lgkmcnt(3)
  v_mfma_f32_16x16x32_bf16 v[144:147], v[40:43], v[184:187], v[144:147]
  v_rcp_f32 v192, v192
  v_rcp_f32 v193, v193
  v_rcp_f32 v194, v194
  v_mfma_f32_16x16x32_bf16 v[148:151], v[44:47], v[184:187], v[148:151]
  v_rcp_f32 v195, v195
  v_rcp_f32 v196, v196
  v_rcp_f32 v197, v197
  s_add_u32 m0, s75, 57344
  s_xor_b32 s100, s10, 65536
  buffer_load_dwordx4 v252, s[52:55], s100 offen lds
  s_waitcnt lgkmcnt(2)
  v_mfma_f32_16x16x32_bf16 v[144:147], v[48:51], v[188:191], v[144:147]
  v_rcp_f32 v198, v198
  v_rcp_f32 v199, v199
  v_mul_f32 v136, v136, v192
  v_mul_f32 v137, v137, v193
  v_mfma_f32_16x16x32_bf16 v[148:151], v[52:55], v[188:191], v[148:151]
  v_mul_f32 v138, v138, v194
  v_mul_f32 v139, v139, v195
  v_mul_f32 v140, v140, v196
  v_mul_f32 v141, v141, v197
  v_mul_f32 v142, v142, v198
  v_mul_f32 v143, v143, v199
  v_cvt_pk_bf16_f32 v192, v136, v137
  v_cvt_pk_bf16_f32 v193, v138, v139
  v_cvt_pk_bf16_f32 v194, v140, v141
  v_cvt_pk_bf16_f32 v195, v142, v143
  buffer_store_dwordx4 v[192:195], v238, s[44:47], s87 offen sc1
  s_waitcnt vmcnt(7)
  s_waitcnt lgkmcnt(0)
  s_barrier
  ds_read_b128 v[176:179], v225 offset:57344
  ds_read_b128 v[180:183], v223 offset:57344
  ds_read_b128 v[184:187], v224
  ds_read_b128 v[188:191], v222
  v_mfma_f32_16x16x32_bf16 v[144:147], v[56:59], v[168:171], v[144:147]
  v_mfma_f32_16x16x32_bf16 v[148:151], v[60:63], v[168:171], v[148:151]
  s_add_u32 m0, s75, 65536
  s_xor_b32 s100, s10, 131072
  buffer_load_dwordx4 v252, s[52:55], s100 offen lds
  v_mfma_f32_16x16x32_bf16 v[144:147], v[64:67], v[172:175], v[144:147]
  v_mfma_f32_16x16x32_bf16 v[148:151], v[68:71], v[172:175], v[148:151]
  s_add_u32 m0, s75, 73728
  s_xor_b32 s100, s10, 196608
  buffer_load_dwordx4 v252, s[52:55], s100 offen lds
  s_waitcnt lgkmcnt(3)
  v_mfma_f32_16x16x32_bf16 v[144:147], v[72:75], v[176:179], v[144:147]
  v_mfma_f32_16x16x32_bf16 v[148:151], v[76:79], v[176:179], v[148:151]
  s_add_u32 m0, s75, 81920
  s_xor_b32 s100, s10, 262144
  buffer_load_dwordx4 v252, s[52:55], s100 offen lds
  s_waitcnt lgkmcnt(2)
  v_mfma_f32_16x16x32_bf16 v[144:147], v[80:83], v[180:183], v[144:147]
  v_mfma_f32_16x16x32_bf16 v[148:151], v[84:87], v[180:183], v[148:151]
  s_add_u32 m0, s75, 90112
  s_xor_b32 s100, s10, 327680
  buffer_load_dwordx4 v252, s[52:55], s100 offen lds
  s_waitcnt vmcnt(7)
  s_waitcnt lgkmcnt(0)
  s_barrier
  ds_read_b128 v[168:171], v224 offset:8192
  ds_read_b128 v[172:175], v222 offset:8192
  ds_read_b128 v[176:179], v248
  ds_read_b128 v[180:183], v241
  v_mfma_f32_16x16x32_bf16 v[144:147], v[88:91], v[184:187], v[144:147]
  v_mfma_f32_16x16x32_bf16 v[148:151], v[92:95], v[184:187], v[148:151]
  s_add_u32 m0, s75, 98304
  s_xor_b32 s100, s10, 393216
  buffer_load_dwordx4 v252, s[52:55], s100 offen lds
  v_mfma_f32_16x16x32_bf16 v[144:147], v[96:99], v[188:191], v[144:147]
  v_mfma_f32_16x16x32_bf16 v[148:151], v[100:103], v[188:191], v[148:151]
  s_add_u32 m0, s75, 106496
  s_xor_b32 s100, s10, 458752
  buffer_load_dwordx4 v252, s[52:55], s100 offen lds
  s_waitcnt lgkmcnt(3)
  v_mfma_f32_16x16x32_bf16 v[144:147], v[104:107], v[168:171], v[144:147]
  v_mfma_f32_16x16x32_bf16 v[148:151], v[108:111], v[168:171], v[148:151]
  s_waitcnt lgkmcnt(2)
  v_mfma_f32_16x16x32_bf16 v[144:147], v[112:115], v[172:175], v[144:147]
  v_mfma_f32_16x16x32_bf16 v[148:151], v[116:119], v[172:175], v[148:151]
  s_waitcnt lgkmcnt(1)
  v_mfma_f32_16x16x32_bf16 v[144:147], v[120:123], v[176:179], v[144:147]
  v_mfma_f32_16x16x32_bf16 v[148:151], v[124:127], v[176:179], v[148:151]
  s_waitcnt lgkmcnt(0)
  v_mfma_f32_16x16x32_bf16 v[144:147], v[128:131], v[180:183], v[144:147]
  v_mfma_f32_16x16x32_bf16 v[148:151], v[132:135], v[180:183], v[148:151]
  v_mul_f32 v192, v167, v152
  v_mul_f32 v193, v167, v153
  v_mul_f32 v194, v167, v154
  v_mul_f32 v195, v167, v155
  v_mul_f32 v196, v167, v156
  v_mul_f32 v197, v167, v157
  v_mul_f32 v198, v167, v158
  v_mul_f32 v199, v167, v159
  v_fma_f32 v144, v166, v144, -v192
  v_fma_f32 v145, v166, v145, -v193
  v_fma_f32 v146, v166, v146, -v194
  v_fma_f32 v147, v166, v147, -v195
  v_fma_f32 v148, v166, v148, -v196
  v_fma_f32 v149, v166, v149, -v197
  v_fma_f32 v150, v166, v150, -v198
  v_fma_f32 v151, v166, v151, -v199
  v_mul_f32 v192, v144, v144
  v_mul_f32 v193, v145, v145
  v_mul_f32 v194, v146, v146
  v_mul_f32 v195, v147, v147
  v_mul_f32 v196, v148, v148
  v_mul_f32 v197, v149, v149
  v_mul_f32 v198, v150, v150
  v_mul_f32 v199, v151, v151
  s_waitcnt vmcnt(6)
  s_mov_b64 exec, 1
  s_cmp_eq_u32 s80, 0
  s_cbranch_scc1 L_du_M_1_f
  buffer_store_dword v237, off, s[44:47], s88 sc1
  s_branch L_du_M_1_d
L_du_M_1_f:
  buffer_store_dword v237, off, s[44:47], s88
L_du_M_1_d:
  s_mov_b64 exec, -1
  v_fma_f32 v192, v192, s77, v244
  v_fma_f32 v193, v193, s77, v244
  v_fma_f32 v194, v194, s77, v244
  v_fma_f32 v195, v195, s77, v244
  v_fma_f32 v196, v196, s77, v244
  v_fma_f32 v197, v197, s77, v244
  v_fma_f32 v198, v198, s77, v244
  v_fma_f32 v199, v199, s77, v244
  v_mul_f32 v192, v192, v144
  v_mul_f32 v193, v193, v145
  v_mul_f32 v194, v194, v146
  v_mul_f32 v195, v195, v147
  v_mul_f32 v196, v196, v148
  v_mul_f32 v197, v197, v149
  v_mul_f32 v198, v198, v150
  v_mul_f32 v199, v199, v151
  v_exp_f32 v192, v192
  v_exp_f32 v193, v193
  v_exp_f32 v194, v194
  v_exp_f32 v195, v195
  v_exp_f32 v196, v196
  v_exp_f32 v197, v197
  v_exp_f32 v198, v198
  v_exp_f32 v199, v199
  v_add_f32 v192, 1.0, v192
  v_add_f32 v193, 1.0, v193
  v_add_f32 v194, 1.0, v194
  v_add_f32 v195, 1.0, v195
  v_add_f32 v196, 1.0, v196
  v_add_f32 v197, 1.0, v197
  v_add_f32 v198, 1.0, v198
  v_add_f32 v199, 1.0, v199
  v_rcp_f32 v192, v192
  v_rcp_f32 v193, v193
  v_rcp_f32 v194, v194
  v_rcp_f32 v195, v195
  v_rcp_f32 v196, v196
  v_rcp_f32 v197, v197
  v_rcp_f32 v198, v198
  v_rcp_f32 v199, v199
  v_mul_f32 v144, v144, v192
  v_mul_f32 v145, v145, v193
  v_mul_f32 v146, v146, v194
  v_mul_f32 v147, v147, v195
  v_mul_f32 v148, v148, v196
  v_mul_f32 v149, v149, v197
  v_mul_f32 v150, v150, v198
  v_mul_f32 v151, v151, v199
  v_cvt_pk_bf16_f32 v196, v144, v145
  v_cvt_pk_bf16_f32 v197, v146, v147
  v_cvt_pk_bf16_f32 v198, v148, v149
  v_cvt_pk_bf16_f32 v199, v150, v151
  buffer_store_dwordx4 v[196:199], v238, s[44:47], s90 offen sc1
  s_mov_b64 exec, 0xff
  buffer_load_dword v251, v239, s[44:47], s91 offen sc1
  s_mov_b64 exec, -1
  s_add_u32 m0, s75, 8192
  s_add_u32 s34, s34, s14
  s_add_u32 s34, s34, s11
  buffer_load_dwordx4 v236, s[60:63], s34 offen lds
  s_add_u32 m0, s75, 16384
  s_sub_u32 s34, s34, s14
  s_add_u32 s34, s34, s15
  buffer_load_dwordx4 v236, s[60:63], s34 offen lds
  s_add_u32 m0, s75, 24576
  s_add_u32 s34, s34, s14
  buffer_load_dwordx4 v236, s[60:63], s34 offen lds
  s_add_u32 m0, s75, 114688
  s_sub_u32 s34, s34, s14
  s_sub_u32 s34, s34, s15
  s_sub_u32 s34, s34, s11
  buffer_load_dwordx4 v236, s[60:63], s34 offen lds
  s_add_u32 m0, s75, 122880
  s_add_u32 s34, s34, s14
  buffer_load_dwordx4 v236, s[60:63], s34 offen lds
  v_mov_b32 v254, 0
  s_mov_b32 s52, s30
  s_mov_b32 s53, s31
  s_mov_b32 s54, 1835008
  s_mov_b32 s48, s16
  s_mov_b32 s49, s17
  s_waitcnt vmcnt(6)
  s_mov_b64 exec, 1
  s_cmp_eq_u32 s80, 0
  s_cbranch_scc1 L_du_M_2_f
  buffer_store_dword v237, off, s[44:47], s88 offset:256 sc1
  s_branch L_du_M_2_d
L_du_M_2_f:
  buffer_store_dword v237, off, s[44:47], s88 offset:256
L_du_M_2_d:
  s_mov_b64 exec, -1
  s_barrier
  ds_read_b64_tr_b16 v[8:9], v240 offset:0
  ds_read_b64_tr_b16 v[10:11], v240 offset:2048
  ds_read_b64_tr_b16 v[12:13], v235 offset:0
  ds_read_b64_tr_b16 v[14:15], v235 offset:2048
  ds_read_b64_tr_b16 v[16:17], v234 offset:0
  ds_read_b64_tr_b16 v[18:19], v234 offset:2048
  ds_read_b64_tr_b16 v[20:21], v233 offset:0
  ds_read_b64_tr_b16 v[22:23], v233 offset:2048
  ds_read_b64_tr_b16 v[24:25], v240 offset:4096
  ds_read_b64_tr_b16 v[26:27], v240 offset:6144
  ds_read_b64_tr_b16 v[28:29], v235 offset:4096
  ds_read_b64_tr_b16 v[30:31], v235 offset:6144
  ds_read_b64_tr_b16 v[32:33], v234 offset:4096
  ds_read_b64_tr_b16 v[34:35], v234 offset:6144
  ds_read_b64_tr_b16 v[36:37], v233 offset:4096
  ds_read_b64_tr_b16 v[38:39], v233 offset:6144
  ds_read_b64_tr_b16 v[40:41], v240 offset:8192
  ds_read_b64_tr_b16 v[42:43], v240 offset:10240
  ds_read_b64_tr_b16 v[44:45], v235 offset:8192
  ds_read_b64_tr_b16 v[46:47], v235 offset:10240
  ds_read_b64_tr_b16 v[48:49], v234 offset:8192
  ds_read_b64_tr_b16 v[50:51], v234 offset:10240
  ds_read_b64_tr_b16 v[52:53], v233 offset:8192
  ds_read_b64_tr_b16 v[54:55], v233 offset:10240
  ds_read_b64_tr_b16 v[56:57], v240 offset:12288
  ds_read_b64_tr_b16 v[58:59], v240 offset:14336
  ds_read_b64_tr_b16 v[60:61], v235 offset:12288
  ds_read_b64_tr_b16 v[62:63], v235 offset:14336
  ds_read_b64_tr_b16 v[64:65], v234 offset:12288
  ds_read_b64_tr_b16 v[66:67], v234 offset:14336
  ds_read_b64_tr_b16 v[68:69], v233 offset:12288
  ds_read_b64_tr_b16 v[70:71], v233 offset:14336
  s_waitcnt vmcnt(6)
  v_mov_b32 v251, v251
  s_mov_b32 s101, 200000
  s_mov_b64 exec, 0xff
  s_nop 0
L_pl_M_3005:
  v_cmp_ne_u32 vcc, s72, v251
  s_nop 4
  s_cbranch_vccz L_pd_M_3006
  buffer_load_dword v251, v239, s[44:47], s91 offen sc1
  s_waitcnt vmcnt(0)
  s_sub_u32 s101, s101, 1
  s_cmp_lg_u32 s101, 0
  s_cbranch_scc1 L_pl_M_3005
L_pd_M_3006:
  s_mov_b64 exec, -1
  s_xor_b32 s93, s12, 0
  buffer_load_dwordx4 v[136:139], v238, s[44:47], s93 offen offset:0 sc1
  buffer_load_dwordx4 v[140:143], v238, s[44:47], s93 offen offset:1024 sc1
  s_xor_b32 s93, s12, 2048
  buffer_load_dwordx4 v[144:147], v238, s[44:47], s93 offen offset:0 sc1
  buffer_load_dwordx4 v[148:151], v238, s[44:47], s93 offen offset:1024 sc1
  s_xor_b32 s93, s12, 4096
  buffer_load_dwordx4 v[152:155], v238, s[44:47], s93 offen offset:0 sc1
  buffer_load_dwordx4 v[156:159], v238, s[44:47], s93 offen offset:1024 sc1
  s_xor_b32 s93, s12, 6144
  buffer_load_dwordx4 v[160:163], v238, s[44:47], s93 offen offset:0 sc1
  buffer_load_dwordx4 v[164:167], v238, s[44:47], s93 offen offset:1024 sc1
  s_mov_b64 exec, 0xff
  buffer_load_dword v254, v239, s[44:47], s91 offen offset:256 sc1
  s_mov_b64 exec, -1
  ds_read_b64_tr_b16 v[72:73], v240 offset:16384
  ds_read_b64_tr_b16 v[74:75], v240 offset:18432
  ds_read_b64_tr_b16 v[76:77], v235 offset:16384
  ds_read_b64_tr_b16 v[78:79], v235 offset:18432
  ds_read_b64_tr_b16 v[80:81], v234 offset:16384
  ds_read_b64_tr_b16 v[82:83], v234 offset:18432
  ds_read_b64_tr_b16 v[84:85], v233 offset:16384
  ds_read_b64_tr_b16 v[86:87], v233 offset:18432
  ds_read_b64_tr_b16 v[88:89], v240 offset:20480
  ds_read_b64_tr_b16 v[90:91], v240 offset:22528
  ds_read_b64_tr_b16 v[92:93], v235 offset:20480
  ds_read_b64_tr_b16 v[94:95], v235 offset:22528
  ds_read_b64_tr_b16 v[96:97], v234 offset:20480
  ds_read_b64_tr_b16 v[98:99], v234 offset:22528
  ds_read_b64_tr_b16 v[100:101], v233 offset:20480
  ds_read_b64_tr_b16 v[102:103], v233 offset:22528
  ds_read_b64_tr_b16 v[104:105], v240 offset:24576
  ds_read_b64_tr_b16 v[106:107], v240 offset:26624
  ds_read_b64_tr_b16 v[108:109], v235 offset:24576
  ds_read_b64_tr_b16 v[110:111], v235 offset:26624
  ds_read_b64_tr_b16 v[112:113], v234 offset:24576
  ds_read_b64_tr_b16 v[114:115], v234 offset:26624
  ds_read_b64_tr_b16 v[116:117], v233 offset:24576
  ds_read_b64_tr_b16 v[118:119], v233 offset:26624
  ds_read_b64_tr_b16 v[120:121], v240 offset:28672
  ds_read_b64_tr_b16 v[122:123], v240 offset:30720
  ds_read_b64_tr_b16 v[124:125], v235 offset:28672
  ds_read_b64_tr_b16 v[126:127], v235 offset:30720
  ds_read_b64_tr_b16 v[128:129], v234 offset:28672
  ds_read_b64_tr_b16 v[130:131], v234 offset:30720
  ds_read_b64_tr_b16 v[132:133], v233 offset:28672
  ds_read_b64_tr_b16 v[134:135], v233 offset:30720
  s_waitcnt vmcnt(8) lgkmcnt(15)
  v_mfma_f32_16x16x32_bf16 v[212:215], v[16:19], v[136:139], 0
  v_permlane16_swap_b32 v204, v206
  v_permlane16_swap_b32 v205, v207
  v_permlane16_swap_b32 v200, v202
  v_permlane16_swap_b32 v201, v203
  s_waitcnt lgkmcnt(15)
  v_mfma_f32_16x16x32_bf16 v[216:219], v[20:23], v[136:139], 0
  v_permlane32_swap_b32 v204, v206
  v_permlane32_swap_b32 v205, v207
  v_permlane32_swap_b32 v200, v202
  v_permlane32_swap_b32 v201, v203
  v_mfma_f32_16x16x32_bf16 v[4:7], v[8:11], v[136:139], 0
  ds_read_b64 v[244:245], v231 offset:2128
  ds_read_b64 v[246:247], v231 offset:2640
  v_lshlrev_b32 v241, 16, v204
  v_and_b32 v240, 0xffff0000, v204
  v_mfma_f32_16x16x32_bf16 v[208:211], v[12:15], v[136:139], 0
  s_waitcnt lgkmcnt(0)
  v_sub_f32 v241, v241, v246
  v_sub_f32 v240, v240, v246
  v_cvt_pk_bf16_f32 v204, v241, v240
  v_lshlrev_b32 v241, 16, v204
  s_waitcnt vmcnt(7)
  v_mfma_f32_16x16x32_bf16 v[212:215], v[32:35], v[140:143], v[212:215]
  v_and_b32 v240, 0xffff0000, v204
  v_mul_f32 v241, v241, v247
  v_mul_f32 v240, v240, v247
  v_cvt_pk_bf16_f32 v204, v241, v240
  v_mfma_f32_16x16x32_bf16 v[216:219], v[36:39], v[140:143], v[216:219]
  v_lshlrev_b32 v241, 16, v205
  v_and_b32 v240, 0xffff0000, v205
  v_sub_f32 v241, v241, v246
  v_sub_f32 v240, v240, v246
  v_mfma_f32_16x16x32_bf16 v[4:7], v[24:27], v[140:143], v[4:7]
  v_cvt_pk_bf16_f32 v205, v241, v240
  v_lshlrev_b32 v241, 16, v205
  v_and_b32 v240, 0xffff0000, v205
  v_mul_f32 v241, v241, v247
  v_mfma_f32_16x16x32_bf16 v[208:211], v[28:31], v[140:143], v[208:211]
  v_mul_f32 v240, v240, v247
  v_cvt_pk_bf16_f32 v205, v241, v240
  v_lshlrev_b32 v241, 16, v206
  v_and_b32 v240, 0xffff0000, v206
  s_waitcnt vmcnt(6)
  v_mfma_f32_16x16x32_bf16 v[212:215], v[48:51], v[144:147], v[212:215]
  v_sub_f32 v241, v241, v246
  v_sub_f32 v240, v240, v246
  v_cvt_pk_bf16_f32 v206, v241, v240
  v_lshlrev_b32 v241, 16, v206
  v_mfma_f32_16x16x32_bf16 v[216:219], v[52:55], v[144:147], v[216:219]
  v_and_b32 v240, 0xffff0000, v206
  v_mul_f32 v241, v241, v247
  v_mul_f32 v240, v240, v247
  v_cvt_pk_bf16_f32 v206, v241, v240
  v_mfma_f32_16x16x32_bf16 v[4:7], v[40:43], v[144:147], v[4:7]
  v_lshlrev_b32 v241, 16, v207
  v_and_b32 v240, 0xffff0000, v207
  v_sub_f32 v241, v241, v246
  v_sub_f32 v240, v240, v246
  v_mfma_f32_16x16x32_bf16 v[208:211], v[44:47], v[144:147], v[208:211]
  v_cvt_pk_bf16_f32 v207, v241, v240
  v_lshlrev_b32 v241, 16, v207
  v_and_b32 v240, 0xffff0000, v207
  v_mul_f32 v241, v241, v247
  s_waitcnt vmcnt(5)
  v_mfma_f32_16x16x32_bf16 v[212:215], v[64:67], v[148:151], v[212:215]
  v_mul_f32 v240, v240, v247
  v_cvt_pk_bf16_f32 v207, v241, v240
  v_lshlrev_b32 v224, 16, v204
  v_and_b32 v225, 0xffff0000, v204
  v_mfma_f32_16x16x32_bf16 v[216:219], v[68:71], v[148:151], v[216:219]
  v_lshlrev_b32 v226, 16, v205
  v_and_b32 v227, 0xffff0000, v205
  v_lshlrev_b32 v232, 16, v206
  v_and_b32 v233, 0xffff0000, v206
  v_mfma_f32_16x16x32_bf16 v[4:7], v[56:59], v[148:151], v[4:7]
  v_lshlrev_b32 v234, 16, v207
  v_and_b32 v235, 0xffff0000, v207
  v_lshlrev_b32 v241, 16, v200
  v_and_b32 v240, 0xffff0000, v200
  v_mfma_f32_16x16x32_bf16 v[208:211], v[60:63], v[148:151], v[208:211]
  v_sub_f32 v241, v241, v244
  v_sub_f32 v240, v240, v244
  v_cvt_pk_bf16_f32 v200, v241, v240
  v_lshlrev_b32 v241, 16, v200
  s_waitcnt vmcnt(4)
  v_mfma_f32_16x16x32_bf16 v[212:215], v[80:83], v[152:155], v[212:215]
  v_and_b32 v240, 0xffff0000, v200
  v_mul_f32 v241, v241, v245
  v_mul_f32 v240, v240, v245
  v_cvt_pk_bf16_f32 v200, v241, v240
  v_mfma_f32_16x16x32_bf16 v[216:219], v[84:87], v[152:155], v[216:219]
  v_lshlrev_b32 v241, 16, v201
  v_and_b32 v240, 0xffff0000, v201
  v_sub_f32 v241, v241, v244
  v_sub_f32 v240, v240, v244
  v_mfma_f32_16x16x32_bf16 v[4:7], v[72:75], v[152:155], v[4:7]
  v_cvt_pk_bf16_f32 v201, v241, v240
  v_lshlrev_b32 v241, 16, v201
  v_and_b32 v240, 0xffff0000, v201
  v_mul_f32 v241, v241, v245
  v_mfma_f32_16x16x32_bf16 v[208:211], v[76:79], v[152:155], v[208:211]
  v_mul_f32 v240, v240, v245
  v_cvt_pk_bf16_f32 v201, v241, v240
  v_lshlrev_b32 v241, 16, v202
  v_and_b32 v240, 0xffff0000, v202
  s_waitcnt vmcnt(0)
  v_mov_b32 v254, v254
  s_mov_b32 s101, 200000
  s_mov_b64 exec, 0xff
  s_nop 0
L_pl_M_5007:
  v_cmp_ne_u32 vcc, s72, v254
  s_nop 4
  s_cbranch_vccz L_pd_M_5008
  buffer_load_dword v254, v239, s[44:47], s91 offen offset:256 sc1
  s_waitcnt vmcnt(0)
  s_sub_u32 s101, s101, 1
  s_cmp_lg_u32 s101, 0
  s_cbranch_scc1 L_pl_M_5007
L_pd_M_5008:
  s_mov_b64 exec, -1
  s_xor_b32 s93, s12, 65536
  buffer_load_dwordx4 v[168:171], v238, s[44:47], s93 offen offset:0 sc1
  buffer_load_dwordx4 v[172:175], v238, s[44:47], s93 offen offset:1024 sc1
  s_xor_b32 s93, s12, 67584
  buffer_load_dwordx4 v[176:179], v238, s[44:47], s93 offen offset:0 sc1
  buffer_load_dwordx4 v[180:183], v238, s[44:47], s93 offen offset:1024 sc1
  s_xor_b32 s93, s12, 69632
  buffer_load_dwordx4 v[184:187], v238, s[44:47], s93 offen offset:0 sc1
  buffer_load_dwordx4 v[188:191], v238, s[44:47], s93 offen offset:1024 sc1
  s_xor_b32 s93, s12, 71680
  buffer_load_dwordx4 v[192:195], v238, s[44:47], s93 offen offset:0 sc1
  buffer_load_dwordx4 v[196:199], v238, s[44:47], s93 offen offset:1024 sc1
  v_mfma_f32_16x16x32_bf16 v[212:215], v[96:99], v[156:159], v[212:215]
  v_sub_f32 v241, v241, v244
  v_sub_f32 v240, v240, v244
  v_cvt_pk_bf16_f32 v202, v241, v240
  v_lshlrev_b32 v241, 16, v202
  v_mfma_f32_16x16x32_bf16 v[216:219], v[100:103], v[156:159], v[216:219]
  v_and_b32 v240, 0xffff0000, v202
  v_mul_f32 v241, v241, v245
  v_mul_f32 v240, v240, v245
  v_cvt_pk_bf16_f32 v202, v241, v240
  v_mfma_f32_16x16x32_bf16 v[4:7], v[88:91], v[156:159], v[4:7]
  v_lshlrev_b32 v241, 16, v203
  v_and_b32 v240, 0xffff0000, v203
  v_sub_f32 v241, v241, v244
  v_sub_f32 v240, v240, v244
  v_mfma_f32_16x16x32_bf16 v[208:211], v[92:95], v[156:159], v[208:211]
  v_cvt_pk_bf16_f32 v203, v241, v240
  v_lshlrev_b32 v241, 16, v203
  v_and_b32 v240, 0xffff0000, v203
  v_mul_f32 v241, v241, v245
  s_add_u32 m0, s75, 131072
  s_sub_u32 s34, s34, s14
  s_add_u32 s34, s34, s15
  buffer_load_dwordx4 v236, s[60:63], s34 offen lds
  v_mfma_f32_16x16x32_bf16 v[212:215], v[112:115], v[160:163], v[212:215]
  v_mul_f32 v240, v240, v245
  v_cvt_pk_bf16_f32 v203, v241, v240
  v_mfma_f32_16x16x32_bf16 v[216:219], v[116:119], v[160:163], v[216:219]
  v_mfma_f32_16x16x32_bf16 v[4:7], v[104:107], v[160:163], v[4:7]
  v_mfma_f32_16x16x32_bf16 v[208:211], v[108:111], v[160:163], v[208:211]
  s_add_u32 m0, s75, 139264
  s_add_u32 s34, s34, s14
  buffer_load_dwordx4 v236, s[60:63], s34 offen lds
  v_mfma_f32_16x16x32_bf16 v[212:215], v[128:131], v[164:167], v[212:215]
  v_mfma_f32_16x16x32_bf16 v[216:219], v[132:135], v[164:167], v[216:219]
  v_mfma_f32_16x16x32_bf16 v[4:7], v[120:123], v[164:167], v[4:7]
  v_mfma_f32_16x16x32_bf16 v[208:211], v[124:127], v[164:167], v[208:211]
  s_add_u32 m0, s75, 0
  s_sub_u32 s34, s34, s14
  s_sub_u32 s34, s34, s15
  s_add_u32 s34, s34, s11
  buffer_load_dwordx4 v236, s[60:63], s34 offen lds
  ds_write_b128 v242, v[212:215] offset:0
  ds_write_b128 v242, v[216:219] offset:1024
  v_xor_b32 v242, 2048, v242
  s_waitcnt lgkmcnt(0)
  s_barrier
  s_add_u32 m0, s75, 49024
  s_sub_u32 s34, s34, s11
  buffer_load_dwordx4 v236, s[60:63], s34 offen offset:128 lds
  ds_read_b128 v[212:215], v242 offset:0
  ds_read_b128 v[216:219], v242 offset:1024
  v_lshlrev_b32 v254, 16, v200
  v_and_b32 v241, 0xffff0000, v200
  v_add_f32 v4, v4, v254
  v_add_f32 v5, v5, v241
  v_lshlrev_b32 v254, 16, v201
  v_and_b32 v241, 0xffff0000, v201
  v_add_f32 v6, v6, v254
  v_add_f32 v7, v7, v241
  v_lshlrev_b32 v254, 16, v202
  v_and_b32 v241, 0xffff0000, v202
  v_add_f32 v208, v208, v254
  v_add_f32 v209, v209, v241
  v_lshlrev_b32 v254, 16, v203
  v_and_b32 v241, 0xffff0000, v203
  v_add_f32 v210, v210, v254
  v_add_f32 v211, v211, v241
  s_waitcnt lgkmcnt(1)
  v_add_f32 v4, v4, v212
  v_add_f32 v5, v5, v213
  s_waitcnt vmcnt(11)
  v_mfma_f32_16x16x32_bf16 v[244:247], v[16:19], v[168:171], 0
  v_add_f32 v6, v6, v214
  v_add_f32 v7, v7, v215
  s_waitcnt lgkmcnt(0)
  v_add_f32 v208, v208, v216
  v_mfma_f32_16x16x32_bf16 v[248:251], v[20:23], v[168:171], 0
  v_add_f32 v209, v209, v217
  v_add_f32 v210, v210, v218
  v_add_f32 v211, v211, v219
  v_mfma_f32_16x16x32_bf16 v[224:227], v[8:11], v[168:171], v[224:227]
  v_cvt_pk_bf16_f32 v200, v4, v5
  v_cvt_pk_bf16_f32 v201, v6, v7
  v_cvt_pk_bf16_f32 v202, v208, v209
  v_mfma_f32_16x16x32_bf16 v[232:235], v[12:15], v[168:171], v[232:235]
  v_cvt_pk_bf16_f32 v203, v210, v211
  buffer_store_dwordx4 v[200:203], v243, s[44:47], s36 offen sc1
  v_mov_b32 v212, 0
  s_add_u32 m0, s75, 57216
  s_add_u32 s34, s34, s14
  buffer_load_dwordx4 v236, s[60:63], s34 offen offset:128 lds
  s_waitcnt vmcnt(12)
  v_mfma_f32_16x16x32_bf16 v[244:247], v[32:35], v[172:175], v[244:247]
  v_mov_b32 v213, 0
  v_dot2c_f32_bf16 v212, s78, v200
  v_dot2c_f32_bf16 v213, v200, v200
  v_mfma_f32_16x16x32_bf16 v[248:251], v[36:39], v[172:175], v[248:251]
  v_dot2c_f32_bf16 v212, s78, v201
  v_dot2c_f32_bf16 v213, v201, v201
  v_dot2c_f32_bf16 v212, s78, v202
  v_mfma_f32_16x16x32_bf16 v[224:227], v[24:27], v[172:175], v[224:227]
  v_dot2c_f32_bf16 v213, v202, v202
  v_dot2c_f32_bf16 v212, s78, v203
  v_dot2c_f32_bf16 v213, v203, v203
  v_mfma_f32_16x16x32_bf16 v[232:235], v[28:31], v[172:175], v[232:235]
  s_nop 1
  v_permlane32_swap_b32 v212, v213
  v_add_f32 v212, v212, v213
  v_mov_b32 v213, v212
  s_add_u32 m0, s75, 73600
  s_add_u32 s34, s34, s15
  buffer_load_dwordx4 v236, s[60:63], s34 offen offset:128 lds
  s_waitcnt vmcnt(12)
  v_mfma_f32_16x16x32_bf16 v[244:247], v[48:51], v[176:179], v[244:247]
  v_permlane16_swap_b32 v212, v213
  v_add_f32 v212, v212, v213
  v_mov_b32 v213, v212
  v_mfma_f32_16x16x32_bf16 v[248:251], v[52:55], v[176:179], v[248:251]
  s_nop 0
  v_permlane32_swap_b32 v212, v213
  buffer_store_dwordx2 v[212:213], v221, s[44:47], s37 offen sc1
  s_add_u32 s36, s36, 65536
  v_mfma_f32_16x16x32_bf16 v[224:227], v[40:43], v[176:179], v[224:227]
  s_add_u32 s37, s37, 8192
  v_mfma_f32_16x16x32_bf16 v[232:235], v[44:47], v[176:179], v[232:235]
  s_add_u32 m0, s75, 65408
  s_sub_u32 s34, s34, s14
  buffer_load_dwordx4 v236, s[60:63], s34 offen offset:128 lds
  s_waitcnt vmcnt(13)
  v_mfma_f32_16x16x32_bf16 v[244:247], v[64:67], v[180:183], v[244:247]
  v_mfma_f32_16x16x32_bf16 v[248:251], v[68:71], v[180:183], v[248:251]
  v_mfma_f32_16x16x32_bf16 v[224:227], v[56:59], v[180:183], v[224:227]
  v_mfma_f32_16x16x32_bf16 v[232:235], v[60:63], v[180:183], v[232:235]
  s_add_u32 m0, s75, 98176
  s_add_u32 s34, s34, s11
  buffer_load_dwordx4 v236, s[60:63], s34 offen offset:128 lds
  s_waitcnt vmcnt(13)
  v_mfma_f32_16x16x32_bf16 v[244:247], v[80:83], v[184:187], v[244:247]
  v_mfma_f32_16x16x32_bf16 v[248:251], v[84:87], v[184:187], v[248:251]
  v_mfma_f32_16x16x32_bf16 v[224:227], v[72:75], v[184:187], v[224:227]
  v_mfma_f32_16x16x32_bf16 v[232:235], v[76:79], v[184:187], v[232:235]
  s_add_u32 m0, s75, 106368
  s_add_u32 s34, s34, s14
  buffer_load_dwordx4 v236, s[60:63], s34 offen offset:128 lds
  s_waitcnt vmcnt(13)
  v_mfma_f32_16x16x32_bf16 v[244:247], v[96:99], v[188:191], v[244:247]
  v_mfma_f32_16x16x32_bf16 v[248:251], v[100:103], v[188:191], v[248:251]
  v_mfma_f32_16x16x32_bf16 v[224:227], v[88:91], v[188:191], v[224:227]
  v_mfma_f32_16x16x32_bf16 v[232:235], v[92:95], v[188:191], v[232:235]
  s_add_u32 m0, s75, 89984
  s_sub_u32 s34, s34, s15
  buffer_load_dwordx4 v236, s[60:63], s34 offen offset:128 lds
  s_waitcnt vmcnt(13)
  v_mfma_f32_16x16x32_bf16 v[244:247], v[112:115], v[192:195], v[244:247]
  v_mfma_f32_16x16x32_bf16 v[248:251], v[116:119], v[192:195], v[248:251]
  v_mfma_f32_16x16x32_bf16 v[224:227], v[104:107], v[192:195], v[224:227]
  v_mfma_f32_16x16x32_bf16 v[232:235], v[108:111], v[192:195], v[232:235]
  s_add_u32 m0, s75, 81792
  s_sub_u32 s34, s34, s14
  buffer_load_dwordx4 v236, s[60:63], s34 offen offset:128 lds
  s_waitcnt vmcnt(13)
  v_mfma_f32_16x16x32_bf16 v[244:247], v[128:131], v[196:199], v[244:247]
  v_mfma_f32_16x16x32_bf16 v[248:251], v[132:135], v[196:199], v[248:251]
  v_mfma_f32_16x16x32_bf16 v[224:227], v[120:123], v[196:199], v[224:227]
  v_mfma_f32_16x16x32_bf16 v[232:235], v[124:127], v[196:199], v[232:235]
  s_nop 4
  ds_write_b128 v242, v[244:247] offset:0
  ds_write_b128 v242, v[248:251] offset:1024
  v_xor_b32 v242, 2048, v242
  s_waitcnt lgkmcnt(0)
  s_barrier
  ds_read_b128 v[244:247], v242 offset:0
  ds_read_b128 v[248:251], v242 offset:1024
  s_waitcnt lgkmcnt(1)
  v_add_f32 v224, v224, v244
  v_add_f32 v225, v225, v245
  v_add_f32 v226, v226, v246
  v_add_f32 v227, v227, v247
  s_waitcnt lgkmcnt(0)
  v_add_f32 v232, v232, v248
  v_add_f32 v233, v233, v249
  v_add_f32 v234, v234, v250
  v_add_f32 v235, v235, v251
  v_cvt_pk_bf16_f32 v204, v224, v225
  v_cvt_pk_bf16_f32 v205, v226, v227
  v_cvt_pk_bf16_f32 v206, v232, v233
  v_cvt_pk_bf16_f32 v207, v234, v235
  buffer_store_dwordx4 v[204:207], v243, s[44:47], s36 offen sc1
  v_mov_b32 v244, 0
  v_mov_b32 v245, 0
  v_dot2c_f32_bf16 v244, s78, v204
  v_dot2c_f32_bf16 v245, v204, v204
  v_dot2c_f32_bf16 v244, s78, v205
  v_dot2c_f32_bf16 v245, v205, v205
  v_dot2c_f32_bf16 v244, s78, v206
  v_dot2c_f32_bf16 v245, v206, v206
  v_dot2c_f32_bf16 v244, s78, v207
  v_dot2c_f32_bf16 v245, v207, v207
  s_nop 2
  v_permlane32_swap_b32 v244, v245
  v_add_f32 v244, v244, v245
  v_mov_b32 v245, v244
  s_nop 1
  v_permlane16_swap_b32 v244, v245
  v_add_f32 v244, v244, v245
  v_mov_b32 v245, v244
  s_nop 1
  v_permlane32_swap_b32 v244, v245
  buffer_store_dwordx2 v[244:245], v221, s[44:47], s37 offen sc1
  v_lshrrev_b32 v228, 5, v1
  v_bfe_u32 v230, v1, 2, 2
  v_lshl_add_u32 v229, v228, 2, v230
  v_lshlrev_b32 v243, 7, v229
  v_lshrrev_b32 v230, 1, v230
  v_lshlrev_b32 v230, 2, v230
  v_lshl_add_u32 v230, v228, 1, v230
  v_bfe_u32 v229, v1, 4, 1
  v_bfe_u32 v228, v1, 1, 1
  v_lshl_add_u32 v229, v229, 1, v228
  v_xor_b32 v229, v229, v230
  v_lshl_add_u32 v243, v229, 4, v243
  v_and_b32 v229, 1, v1
  v_lshl_add_u32 v243, v229, 3, v243
  v_lshl_add_u32 v228, s83, 11, v243
  v_xor_b32 v227, 64, v228
  v_and_b32 v224, 31, v1
  v_bfe_u32 v222, v1, 1, 3
  s_lshl_b32 s92, s83, 1
  v_xor_b32 v223, s92, v222
  v_lshlrev_b32 v223, 4, v223
  v_lshl_add_u32 v230, v224, 7, v223
  v_lshrrev_b32 v223, 5, v1
  v_lshl_add_u32 v230, v223, 13, v230
  v_xor_b32 v229, 16, v230
  v_xor_b32 v223, v223, v222
  v_lshlrev_b32 v223, 4, v223
  v_lshl_add_u32 v226, v224, 7, v223
  v_add_u32 v226, s13, v226
  v_lshrrev_b32 v224, 3, v1
  v_lshl_add_u32 v224, s83, 3, v224
  v_bfe_u32 v223, v224, 1, 3
  v_xor_b32 v223, v223, v1
  v_and_b32 v223, 7, v223
  v_lshlrev_b32 v223, 4, v223
  v_lshl_add_u32 v225, v224, 7, v223
  v_add_u32 v225, s13, v225
  v_add_u32 v224, 65536, v230
  v_add_u32 v223, 131072, v230
  v_add_u32 v222, 65536, v229
  v_add_u32 v221, 131072, v229
  v_add_u32 v220, 65536, v228
  v_add_u32 v219, 131072, v228
  v_add_u32 v218, 65536, v227
  v_add_u32 v217, 131072, v227
  v_add_u32 v216, 65536, v225
  v_add_u32 v215, 131072, v225
  s_lshl_b32 s92, s84, 6
  v_xor_b32 v254, s92, v243
  v_add_u32 v254, s25, v254
  v_xor_b32 v248, 64, v254
  v_lshl_add_u32 v241, s75, 3, v243
  v_add_u32 v243, s29, v243
  v_xor_b32 v242, 64, v243
  v_xor_b32 v240, 64, v241
  v_and_b32 v231, 31, v1
  v_lshrrev_b32 v68, 5, v1
  v_lshlrev_b32 v68, 10, v68
  v_lshl_add_u32 v244, v231, 3, v68
  s_lshl_b32 s92, s70, 8
  s_add_u32 s92, s92, 155648
  v_lshl_add_u32 v233, v231, 3, s92
  s_lshl_b32 s92, s84, 7
  s_add_u32 s92, s92, 158816
  v_lshl_add_u32 v231, v231, 2, s92
  v_lshrrev_b32 v232, 4, v1
  v_and_b32 v68, 1, v1
  v_lshl_add_u32 v232, v68, 2, v232
  s_lshl_b32 s92, s70, 9
  s_add_u32 s92, s92, 158816
  v_lshl_add_u32 v232, v232, 4, s92
  v_add_u32 v235, s26, v238
  v_add_u32 v234, s27, v238
  v_xor_b32 v251, 1024, v254
  v_xor_b32 v250, 4096, v254
  v_xor_b32 v249, 5120, v254
  v_xor_b32 v247, 1024, v248
  v_xor_b32 v246, 4096, v248
  v_xor_b32 v245, 5120, v248
  v_lshrrev_b32 v214, 4, v1
  v_xor_b32 v214, v214, v1
  v_and_b32 v214, 1, v214
  v_cmp_eq_u32 vcc, 0, v214
  v_mov_b32 v214, s78
  s_nop 0
  v_cndmask_b32 v76, 0, v214, vcc
  v_cndmask_b32 v77, 0, v214, vcc
  v_cndmask_b32 v78, 0, v214, vcc
  v_cndmask_b32 v79, 0, v214, vcc
  s_waitcnt vmcnt(0)
  s_mov_b64 exec, 1
  s_cmp_eq_u32 s80, 0
  s_cbranch_scc1 L_du_M_3_f
  buffer_store_dword v237, off, s[44:47], s89 sc1
  s_branch L_du_M_3_d
L_du_M_3_f:
  buffer_store_dword v237, off, s[44:47], s89
L_du_M_3_d:
  s_mov_b64 exec, -1
  s_mov_b32 s64, s20
  s_mov_b32 s65, s21
  s_mov_b32 s66, 1024
  s_mov_b32 s67, 0x00020000
  v_lshrrev_b32 v214, 3, v1
  v_and_b32 v211, 7, v1
  v_lshlrev_b32 v213, 3, v211
  buffer_load_dwordx2 v[84:85], v213, s[64:67], s79 offen
  buffer_load_dwordx2 v[86:87], v213, s[64:67], s79 offen offset:64
  v_lshl_add_u32 v212, v214, 10, v213
  s_lshl_b32 s92, s73, 6
  s_lshl_b32 s93, s84, 5
  s_add_u32 s92, s92, s93
  s_lshl_b32 s93, s83, 3
  s_add_u32 s92, s92, s93
  s_add_u32 s93, s92, s71
  s_lshl_b32 s93, s93, 10
  s_add_u32 s88, s93, s79
  buffer_load_dwordx2 v[80:81], v212, s[40:43], s88 offen
  buffer_load_dwordx2 v[82:83], v212, s[40:43], s88 offen offset:64
  s_lshl_b32 s92, s92, 3
  s_add_u32 s92, s92, 157776
  v_lshl_add_u32 v213, v214, 3, s92
  ds_read_b64 v[2:3], v213
  v_lshlrev_b32 v214, 4, v214
  v_and_b32 v213, 1, v211
  v_lshl_add_u32 v214, v213, 9, v214
  v_bfe_u32 v213, v211, 1, 1
  v_lshl_add_u32 v214, v213, 10, v214
  v_lshrrev_b32 v213, 2, v211
  v_lshl_add_u32 v211, v213, 3, v214
  s_lshr_b32 s92, s71, 5
  s_lshl_b32 s93, s73, 1
  s_add_u32 s92, s92, s93
  s_add_u32 s92, s92, s84
  s_lshl_b32 s92, s92, 15
  s_lshl_b32 s93, s79, 5
  s_add_u32 s92, s92, s93
  s_lshl_b32 s93, s83, 7
  s_add_u32 s92, s92, s93
  s_add_u32 s69, s92, 2097152
  v_lshlrev_b32 v212, 1, v212
  s_lshl_b32 s88, s88, 1
  s_mov_b32 s64, s32
  s_mov_b32 s65, s33
  s_mov_b32 s66, 4194304
  s_mov_b32 s67, 0x00020000
  s_waitcnt lgkmcnt(0)
  s_barrier
  s_and_b32 s92, s83, 1
  s_lshl_b32 s92, s92, 7
  s_add_u32 s92, s92, s81
  s_add_u32 s89, s92, 1024
  s_mov_b64 exec, 0xffffffff
  buffer_load_dword v214, v239, s[44:47], s89 offen sc1
  s_mov_b64 exec, -1
  ds_read_b64_tr_b16 v[88:89], v243 offset:0
  ds_read_b64_tr_b16 v[90:91], v243 offset:2048
  ds_read_b64_tr_b16 v[92:93], v243 offset:1024
  ds_read_b64_tr_b16 v[94:95], v243 offset:3072
  ds_read_b64_tr_b16 v[96:97], v243 offset:4096
  ds_read_b64_tr_b16 v[98:99], v243 offset:6144
  ds_read_b64_tr_b16 v[100:101], v243 offset:5120
  ds_read_b64_tr_b16 v[102:103], v243 offset:7168
  ds_read_b64_tr_b16 v[104:105], v242 offset:0
  ds_read_b64_tr_b16 v[106:107], v242 offset:2048
  ds_read_b64_tr_b16 v[108:109], v242 offset:1024
  ds_read_b64_tr_b16 v[110:111], v242 offset:3072
  ds_read_b64_tr_b16 v[112:113], v242 offset:4096
  ds_read_b64_tr_b16 v[114:115], v242 offset:6144
  ds_read_b64_tr_b16 v[116:117], v242 offset:5120
  ds_read_b64_tr_b16 v[118:119], v242 offset:7168
  ds_read_b64_tr_b16 v[120:121], v241 offset:49152
  ds_read_b64_tr_b16 v[122:123], v241 offset:51200
  ds_read_b64_tr_b16 v[124:125], v241 offset:50176
  ds_read_b64_tr_b16 v[126:127], v241 offset:52224
  ds_read_b64_tr_b16 v[128:129], v241 offset:53248
  ds_read_b64_tr_b16 v[130:131], v241 offset:55296
  ds_read_b64_tr_b16 v[132:133], v241 offset:54272
  ds_read_b64_tr_b16 v[134:135], v241 offset:56320
  ds_read_b64_tr_b16 v[136:137], v240 offset:49152
  ds_read_b64_tr_b16 v[138:139], v240 offset:51200
  ds_read_b64_tr_b16 v[140:141], v240 offset:50176
  ds_read_b64_tr_b16 v[142:143], v240 offset:52224
  ds_read_b64_tr_b16 v[144:145], v240 offset:53248
  ds_read_b64_tr_b16 v[146:147], v240 offset:55296
  ds_read_b64_tr_b16 v[148:149], v240 offset:54272
  ds_read_b64_tr_b16 v[150:151], v240 offset:56320
  s_waitcnt lgkmcnt(15)
  v_mfma_f32_16x16x32_bf16 v[152:155], v[88:91], v[76:79], 0
  s_waitcnt lgkmcnt(15)
  v_mfma_f32_16x16x32_bf16 v[152:155], v[92:95], v[76:79], v[152:155]
  s_waitcnt lgkmcnt(15)
  v_mfma_f32_16x16x32_bf16 v[152:155], v[96:99], v[76:79], v[152:155]
  s_waitcnt lgkmcnt(15)
  v_mfma_f32_16x16x32_bf16 v[152:155], v[100:103], v[76:79], v[152:155]
  s_waitcnt lgkmcnt(15)
  v_mfma_f32_16x16x32_bf16 v[156:159], v[104:107], v[76:79], 0
  s_waitcnt lgkmcnt(15)
  v_mfma_f32_16x16x32_bf16 v[156:159], v[108:111], v[76:79], v[156:159]
  s_waitcnt lgkmcnt(15)
  v_mfma_f32_16x16x32_bf16 v[156:159], v[112:115], v[76:79], v[156:159]
  s_waitcnt lgkmcnt(15)
  v_mfma_f32_16x16x32_bf16 v[156:159], v[116:119], v[76:79], v[156:159]
  s_waitcnt lgkmcnt(14)
  v_mfma_f32_16x16x32_bf16 v[160:163], v[120:123], v[76:79], 0
  s_waitcnt lgkmcnt(12)
  v_mfma_f32_16x16x32_bf16 v[160:163], v[124:127], v[76:79], v[160:163]
  s_waitcnt lgkmcnt(10)
  v_mfma_f32_16x16x32_bf16 v[160:163], v[128:131], v[76:79], v[160:163]
  s_waitcnt lgkmcnt(8)
  v_mfma_f32_16x16x32_bf16 v[160:163], v[132:135], v[76:79], v[160:163]
  s_waitcnt lgkmcnt(6)
  v_mfma_f32_16x16x32_bf16 v[164:167], v[136:139], v[76:79], 0
  s_waitcnt lgkmcnt(4)
  v_mfma_f32_16x16x32_bf16 v[164:167], v[140:143], v[76:79], v[164:167]
  s_waitcnt lgkmcnt(2)
  v_mfma_f32_16x16x32_bf16 v[164:167], v[144:147], v[76:79], v[164:167]
  s_waitcnt lgkmcnt(0)
  v_mfma_f32_16x16x32_bf16 v[164:167], v[148:151], v[76:79], v[164:167]
  s_mov_b32 exec_lo, 0x30003
  s_mov_b32 exec_hi, 0x30003
  ds_write_b128 v232, v[152:155] offset:0
  ds_write_b128 v232, v[156:159] offset:128
  ds_write_b128 v232, v[160:163] offset:256
  s_nop 2
  ds_write_b128 v232, v[164:167] offset:384
  s_mov_b64 exec, -1
  s_waitcnt vmcnt(0)
  v_mov_b32 v214, v214
  s_mov_b32 s101, 200000
  s_mov_b64 exec, 0xffffffff
  s_nop 0
L_pl_M_7009:
  v_cmp_ne_u32 vcc, s72, v214
  s_nop 4
  s_cbranch_vccz L_pd_M_7010
  buffer_load_dword v214, v239, s[44:47], s89 offen sc1
  s_waitcnt vmcnt(0)
  s_sub_u32 s101, s101, 1
  s_cmp_lg_u32 s101, 0
  s_cbranch_scc1 L_pl_M_7009
L_pd_M_7010:
  s_mov_b64 exec, -1
  s_xor_b32 s99, s19, 0
  buffer_load_dwordx4 v[4:7], v238, s[44:47], s99 offen sc1
  s_xor_b32 s99, s19, 1024
  buffer_load_dwordx4 v[8:11], v238, s[44:47], s99 offen sc1
  s_xor_b32 s99, s19, 2048
  buffer_load_dwordx4 v[12:15], v238, s[44:47], s99 offen sc1
  buffer_load_dwordx2 v[68:69], v244, s[44:47], s7 offen offset:0 sc1
  buffer_load_dwordx2 v[70:71], v244, s[44:47], s7 offen offset:256 sc1
  buffer_load_dwordx2 v[72:73], v244, s[44:47], s7 offen offset:512 sc1
  buffer_load_dwordx2 v[74:75], v244, s[44:47], s7 offen offset:768 sc1
  s_xor_b32 s99, s19, 3072
  buffer_load_dwordx4 v[16:19], v238, s[44:47], s99 offen sc1
  s_xor_b32 s99, s19, 4096
  buffer_load_dwordx4 v[20:23], v238, s[44:47], s99 offen sc1
  ds_read_b64_tr_b16 v[164:165], v248 offset:0
  ds_read_b64_tr_b16 v[166:167], v248 offset:2048
  ds_read_b64_tr_b16 v[168:169], v247 offset:0
  ds_read_b64_tr_b16 v[170:171], v247 offset:2048
  ds_read_b64_tr_b16 v[152:153], v254 offset:0
  ds_read_b64_tr_b16 v[154:155], v254 offset:2048
  ds_read_b64_tr_b16 v[156:157], v251 offset:0
  ds_read_b64_tr_b16 v[158:159], v251 offset:2048
  ds_read_b64_tr_b16 v[172:173], v246 offset:0
  ds_read_b64_tr_b16 v[174:175], v246 offset:2048
  s_xor_b32 s99, s19, 5120
  buffer_load_dwordx4 v[24:27], v238, s[44:47], s99 offen sc1
  s_waitcnt vmcnt(9) lgkmcnt(8)
  v_mfma_f32_32x32x16_bf16 v[104:119], v[164:167], v[4:7], 0
  s_lshl_b32 s97, s4, 4
  s_sub_u32 s74, s79, s97
  s_add_u32 s10, s1, s4
  v_mov_b32 v244, v238
  s_add_u32 s97, s1, 8192
  s_sub_u32 s98, s97, 114688
  s_min_u32 s97, s97, s98
  s_add_u32 s11, s97, s4
  s_add_u32 s97, s1, 16384
  ds_read_b64_tr_b16 v[164:165], v245 offset:0
  ds_read_b64_tr_b16 v[166:167], v245 offset:2048
  s_xor_b32 s99, s19, 6144
  buffer_load_dwordx4 v[28:31], v238, s[44:47], s99 offen sc1
  s_waitcnt vmcnt(9) lgkmcnt(8)
  v_mfma_f32_32x32x16_bf16 v[104:119], v[168:171], v[8:11], v[104:119]
  s_sub_u32 s98, s97, 114688
  s_min_u32 s97, s97, s98
  s_add_u32 s12, s97, s4
  s_add_u32 s97, s1, 24576
  s_sub_u32 s98, s97, 114688
  s_min_u32 s97, s97, s98
  s_add_u32 s14, s97, s4
  s_add_u32 s97, s1, 32768
  s_sub_u32 s98, s97, 114688
  ds_read_b64_tr_b16 v[168:169], v248 offset:8192
  ds_read_b64_tr_b16 v[170:171], v248 offset:10240
  s_xor_b32 s99, s19, 7168
  buffer_load_dwordx4 v[32:35], v238, s[44:47], s99 offen sc1
  s_waitcnt vmcnt(9) lgkmcnt(4)
  v_mfma_f32_32x32x16_bf16 v[104:119], v[172:175], v[12:15], v[104:119]
  s_min_u32 s97, s97, s98
  s_add_u32 s15, s97, s4
  s_add_u32 s97, s1, 40960
  s_sub_u32 s98, s97, 114688
  s_min_u32 s97, s97, s98
  s_add_u32 s16, s97, s4
  s_add_u32 s97, s1, 49152
  s_sub_u32 s98, s97, 114688
  s_min_u32 s97, s97, s98
  ds_read_b64_tr_b16 v[160:161], v250 offset:0
  ds_read_b64_tr_b16 v[162:163], v250 offset:2048
  v_mfma_f32_32x32x16_bf16 v[88:103], v[152:155], v[4:7], 0
  s_add_u32 s17, s97, s4
  s_add_u32 s97, s1, 57344
  s_sub_u32 s98, s97, 114688
  s_min_u32 s97, s97, s98
  s_add_u32 s30, s97, s4
  s_add_u32 s97, s1, 65536
  s_sub_u32 s98, s97, 114688
  s_min_u32 s97, s97, s98
  s_add_u32 s31, s97, s4
  ds_read_b64_tr_b16 v[172:173], v247 offset:8192
  ds_read_b64_tr_b16 v[174:175], v247 offset:10240
  s_xor_b32 s99, s19, 8192
  buffer_load_dwordx4 v[36:39], v238, s[44:47], s99 offen sc1
  s_waitcnt vmcnt(5) lgkmcnt(6)
  v_mfma_f32_32x32x16_bf16 v[104:119], v[164:167], v[16:19], v[104:119]
  s_add_u32 s97, s1, 73728
  s_sub_u32 s98, s97, 114688
  s_min_u32 s97, s97, s98
  s_add_u32 s89, s97, s4
  s_add_u32 s97, s1, 81920
  s_sub_u32 s98, s97, 114688
  s_min_u32 s97, s97, s98
  s_add_u32 s90, s97, s4
  s_add_u32 s97, s1, 90112
  ds_read_b64_tr_b16 v[152:153], v249 offset:0
  ds_read_b64_tr_b16 v[154:155], v249 offset:2048
  v_mfma_f32_32x32x16_bf16 v[88:103], v[156:159], v[8:11], v[88:103]
  s_sub_u32 s98, s97, 114688
  s_min_u32 s97, s97, s98
  s_add_u32 s91, s97, s4
  s_add_u32 s97, s1, 98304
  s_sub_u32 s98, s97, 114688
  s_min_u32 s97, s97, s98
  s_add_u32 s87, s97, s4
  s_add_u32 s97, s1, 106496
  s_sub_u32 s98, s97, 114688
  ds_read_b64_tr_b16 v[164:165], v246 offset:8192
  ds_read_b64_tr_b16 v[166:167], v246 offset:10240
  s_xor_b32 s99, s19, 9216
  buffer_load_dwordx4 v[40:43], v238, s[44:47], s99 offen sc1
  s_waitcnt vmcnt(5) lgkmcnt(8)
  v_mfma_f32_32x32x16_bf16 v[104:119], v[168:171], v[20:23], v[104:119]
  s_min_u32 s97, s97, s98
  s_add_u32 s82, s97, s4
  v_lshlrev_b32 v243, 16, v80
  v_and_b32 v242, 0xffff0000, v80
  v_sub_f32 v243, v243, v2
  v_sub_f32 v242, v242, v2
  v_cvt_pk_bf16_f32 v192, v243, v242
  v_lshlrev_b32 v243, 16, v192
  v_and_b32 v242, 0xffff0000, v192
  ds_read_b64_tr_b16 v[156:157], v254 offset:8192
  ds_read_b64_tr_b16 v[158:159], v254 offset:10240
  s_waitcnt lgkmcnt(8)
  v_mfma_f32_32x32x16_bf16 v[88:103], v[160:163], v[12:15], v[88:103]
  v_mul_f32 v243, v243, v3
  v_mul_f32 v242, v242, v3
  v_cvt_pk_bf16_f32 v192, v243, v242
  v_lshlrev_b32 v243, 16, v81
  v_and_b32 v242, 0xffff0000, v81
  v_sub_f32 v243, v243, v2
  v_sub_f32 v242, v242, v2
  v_cvt_pk_bf16_f32 v193, v243, v242
  v_lshlrev_b32 v243, 16, v193
  ds_read_b64_tr_b16 v[168:169], v245 offset:8192
  ds_read_b64_tr_b16 v[170:171], v245 offset:10240
  s_xor_b32 s99, s19, 10240
  buffer_load_dwordx4 v[44:47], v238, s[44:47], s99 offen sc1
  s_waitcnt vmcnt(5) lgkmcnt(8)
  v_mfma_f32_32x32x16_bf16 v[104:119], v[172:175], v[24:27], v[104:119]
  v_and_b32 v242, 0xffff0000, v193
  v_mul_f32 v243, v243, v3
  v_mul_f32 v242, v242, v3
  v_cvt_pk_bf16_f32 v193, v243, v242
  v_lshlrev_b32 v243, 16, v82
  v_and_b32 v242, 0xffff0000, v82
  v_sub_f32 v243, v243, v2
  v_sub_f32 v242, v242, v2
  v_cvt_pk_bf16_f32 v194, v243, v242
  ds_read_b64_tr_b16 v[160:161], v251 offset:8192
  ds_read_b64_tr_b16 v[162:163], v251 offset:10240
  s_waitcnt lgkmcnt(8)
  v_mfma_f32_32x32x16_bf16 v[88:103], v[152:155], v[16:19], v[88:103]
  v_lshlrev_b32 v243, 16, v194
  v_and_b32 v242, 0xffff0000, v194
  v_mul_f32 v243, v243, v3
  v_mul_f32 v242, v242, v3
  v_cvt_pk_bf16_f32 v194, v243, v242
  v_lshlrev_b32 v243, 16, v83
  v_and_b32 v242, 0xffff0000, v83
  v_sub_f32 v243, v243, v2
  v_sub_f32 v242, v242, v2
  v_add_f32 v68, v68, v70
  v_add_f32 v69, v69, v71
  v_add_f32 v72, v72, v74
  v_add_f32 v73, v73, v75
  v_add_f32 v68, v68, v72
  v_add_f32 v69, v69, v73
  v_mov_b32 v70, v68
  v_mov_b32 v71, v69
  s_nop 0
  v_permlane32_swap_b32 v68, v70
  v_permlane32_swap_b32 v69, v71
  v_add_f32 v68, v68, v70
  v_add_f32 v69, v69, v71
  ds_write_b64 v233, v[68:69]
  v_xor_b32 v233, 256, v233
  ds_read_b64_tr_b16 v[172:173], v248 offset:16384
  ds_read_b64_tr_b16 v[174:175], v248 offset:18432
  s_xor_b32 s99, s19, 11264
  buffer_load_dwordx4 v[48:51], v238, s[44:47], s99 offen sc1
  s_waitcnt vmcnt(5) lgkmcnt(9)
  v_mfma_f32_32x32x16_bf16 v[104:119], v[164:167], v[28:31], v[104:119]
  v_cvt_pk_bf16_f32 v195, v243, v242
  v_lshlrev_b32 v243, 16, v195
  v_and_b32 v242, 0xffff0000, v195
  v_mul_f32 v243, v243, v3
  v_mul_f32 v242, v242, v3
  v_cvt_pk_bf16_f32 v195, v243, v242
  v_lshlrev_b32 v241, 16, v192
  v_and_b32 v240, 0xffff0000, v192
  v_lshlrev_b32 v184, 16, v84
  ds_read_b64_tr_b16 v[152:153], v250 offset:8192
  ds_read_b64_tr_b16 v[154:155], v250 offset:10240
  s_waitcnt lgkmcnt(9)
  v_mfma_f32_32x32x16_bf16 v[88:103], v[156:159], v[20:23], v[88:103]
  v_and_b32 v185, 0xffff0000, v84
  v_mul_f32 v241, v241, v184
  v_mul_f32 v240, v240, v185
  v_cvt_pk_bf16_f32 v185, v241, v240
  v_lshlrev_b32 v184, 16, v185
  v_and_b32 v185, 0xffff0000, v185
  v_lshlrev_b32 v241, 16, v193
  v_and_b32 v240, 0xffff0000, v193
  v_lshlrev_b32 v186, 16, v85
  ds_read_b64_tr_b16 v[164:165], v247 offset:16384
  ds_read_b64_tr_b16 v[166:167], v247 offset:18432
  s_xor_b32 s99, s19, 12288
  buffer_load_dwordx4 v[52:55], v238, s[44:47], s99 offen sc1
  s_waitcnt vmcnt(5) lgkmcnt(9)
  v_mfma_f32_32x32x16_bf16 v[104:119], v[168:171], v[32:35], v[104:119]
  v_and_b32 v187, 0xffff0000, v85
  v_mul_f32 v241, v241, v186
  v_mul_f32 v240, v240, v187
  v_cvt_pk_bf16_f32 v187, v241, v240
  v_lshlrev_b32 v186, 16, v187
  v_and_b32 v187, 0xffff0000, v187
  v_lshlrev_b32 v241, 16, v194
  v_and_b32 v240, 0xffff0000, v194
  v_lshlrev_b32 v188, 16, v86
  ds_read_b64_tr_b16 v[156:157], v249 offset:8192
  ds_read_b64_tr_b16 v[158:159], v249 offset:10240
  s_waitcnt lgkmcnt(9)
  v_mfma_f32_32x32x16_bf16 v[88:103], v[160:163], v[24:27], v[88:103]
  v_and_b32 v189, 0xffff0000, v86
  v_mul_f32 v241, v241, v188
  v_mul_f32 v240, v240, v189
  v_cvt_pk_bf16_f32 v189, v241, v240
  v_lshlrev_b32 v188, 16, v189
  v_and_b32 v189, 0xffff0000, v189
  v_lshlrev_b32 v241, 16, v195
  v_and_b32 v240, 0xffff0000, v195
  v_lshlrev_b32 v190, 16, v87
  ds_read_b64_tr_b16 v[168:169], v246 offset:16384
  ds_read_b64_tr_b16 v[170:171], v246 offset:18432
  s_xor_b32 s99, s19, 13312
  buffer_load_dwordx4 v[56:59], v238, s[44:47], s99 offen sc1
  s_waitcnt vmcnt(5) lgkmcnt(8)
  v_mfma_f32_32x32x16_bf16 v[104:119], v[172:175], v[36:39], v[104:119]
  v_and_b32 v191, 0xffff0000, v87
  v_mul_f32 v241, v241, v190
  v_mul_f32 v240, v240, v191
  v_cvt_pk_bf16_f32 v191, v241, v240
  v_lshlrev_b32 v190, 16, v191
  v_and_b32 v191, 0xffff0000, v191
  ds_read_b64_tr_b16 v[160:161], v254 offset:16384
  ds_read_b64_tr_b16 v[162:163], v254 offset:18432
  s_waitcnt lgkmcnt(8)
  v_mfma_f32_32x32x16_bf16 v[88:103], v[152:155], v[28:31], v[88:103]
  ds_read_b64_tr_b16 v[172:173], v245 offset:16384
  ds_read_b64_tr_b16 v[174:175], v245 offset:18432
  s_xor_b32 s99, s19, 14336
  buffer_load_dwordx4 v[60:63], v238, s[44:47], s99 offen sc1
  s_waitcnt vmcnt(5) lgkmcnt(8)
  v_mfma_f32_32x32x16_bf16 v[104:119], v[164:167], v[40:43], v[104:119]
  ds_read_b64_tr_b16 v[152:153], v251 offset:16384
  ds_read_b64_tr_b16 v[154:155], v251 offset:18432
  s_waitcnt lgkmcnt(8)
  v_mfma_f32_32x32x16_bf16 v[88:103], v[156:159], v[32:35], v[88:103]
  s_barrier
  ds_read_b64_tr_b16 v[164:165], v248 offset:24576
  ds_read_b64_tr_b16 v[166:167], v248 offset:26624
  s_xor_b32 s99, s19, 15360
  buffer_load_dwordx4 v[64:67], v238, s[44:47], s99 offen sc1
  s_waitcnt vmcnt(5) lgkmcnt(8)
  v_mfma_f32_32x32x16_bf16 v[104:119], v[168:171], v[44:47], v[104:119]
  ds_read_b64 v[70:71], v233
  s_waitcnt lgkmcnt(0)
  v_add_f32 v68, v68, v70
  v_add_f32 v69, v69, v71
  v_mul_f32 v72, 0x3b000000, v68
  v_mul_f32 v73, v72, v72
  v_fma_f32 v73, v69, s76, -v73
  v_max_f32 v73, 0, v73
  ds_read_b64_tr_b16 v[156:157], v250 offset:16384
  ds_read_b64_tr_b16 v[158:159], v250 offset:18432
  v_mfma_f32_32x32x16_bf16 v[88:103], v[160:163], v[36:39], v[88:103]
  v_cvt_pk_bf16_f32 v180, -v72, -v72
  v_cvt_pk_bf16_f32 v73, v73, v73
  v_and_b32 v73, 0xffff0000, v73
  v_add_f32 v73, 0x3727c5ac, v73
  v_mov_b32 v181, v180
  v_cvt_pk_bf16_f32 v73, v73, v73
  v_and_b32 v73, 0xffff0000, v73
  ds_read_b64_tr_b16 v[168:169], v247 offset:24576
  ds_read_b64_tr_b16 v[170:171], v247 offset:26624
  s_add_u32 m0, s75, 32768
  s_xor_b32 s100, s3, 0
  buffer_load_dwordx4 v253, s[56:59], s100 offen lds
  s_waitcnt vmcnt(5)
  v_mfma_f32_32x32x16_bf16 v[104:119], v[172:175], v[48:51], v[104:119]
  v_sqrt_f32 v73, v73
  s_nop 0
  v_cvt_pk_bf16_f32 v178, v73, v73
  v_and_b32 v178, 0xffff0000, v178
  v_rcp_f32 v72, v178
  s_nop 0
  v_mul_f32 v177, 0xc0135761, v72
  ds_read_b64_tr_b16 v[160:161], v249 offset:16384
  ds_read_b64_tr_b16 v[162:163], v249 offset:18432
  v_mfma_f32_32x32x16_bf16 v[88:103], v[152:155], v[40:43], v[88:103]
  v_mul_f32 v73, v72, v72
  v_mul_f32 v73, 0x3d372713, v73
  v_mul_f32 v176, v73, v177
  ds_read2st64_b32 v[120:121], v231 offset0:0 offset1:2
  ds_read2st64_b32 v[122:123], v231 offset0:4 offset1:6
  ds_read2st64_b32 v[124:125], v231 offset0:8 offset1:10
  ds_read2st64_b32 v[126:127], v231 offset0:12 offset1:14
  ds_read_b64_tr_b16 v[172:173], v246 offset:24576
  ds_read_b64_tr_b16 v[174:175], v246 offset:26624
  s_add_u32 m0, s75, 40960
  s_xor_b32 s100, s3, 0
  buffer_load_dwordx4 v253, s[48:51], s100 offen lds
  s_waitcnt vmcnt(5)
  v_mfma_f32_32x32x16_bf16 v[104:119], v[164:167], v[52:55], v[104:119]
  ds_read2st64_b32 v[128:129], v231 offset0:1 offset1:3
  ds_read2st64_b32 v[130:131], v231 offset0:5 offset1:7
  ds_read2st64_b32 v[132:133], v231 offset0:9 offset1:11
  ds_read2st64_b32 v[134:135], v231 offset0:13 offset1:15
  v_cmp_gt_u32 vcc, 32, v1
  s_waitcnt lgkmcnt(9)
  v_add_f32 v120, v120, v121
  s_waitcnt lgkmcnt(8)
  v_add_f32 v122, v122, v123
  ds_read_b64_tr_b16 v[152:153], v254 offset:24576
  ds_read_b64_tr_b16 v[154:155], v254 offset:26624
  v_mfma_f32_32x32x16_bf16 v[88:103], v[156:159], v[44:47], v[88:103]
  s_waitcnt lgkmcnt(9)
  v_add_f32 v124, v124, v125
  s_waitcnt lgkmcnt(8)
  v_add_f32 v126, v126, v127
  v_add_f32 v120, v120, v122
  v_add_f32 v124, v124, v126
  v_add_f32 v120, v120, v124
  v_cndmask_b32 v120, 0, v120, vcc
  v_cvt_pk_bf16_f32 v121, v120, v120
  ds_read_b64_tr_b16 v[164:165], v245 offset:24576
  ds_read_b64_tr_b16 v[166:167], v245 offset:26624
  s_add_u32 m0, s75, 147456
  s_mov_b32 s100, s0
  buffer_load_dwordx4 v252, s[52:55], s100 offen lds
  s_waitcnt vmcnt(5)
  v_mfma_f32_32x32x16_bf16 v[104:119], v[168:171], v[56:59], v[104:119]
  v_and_b32 v121, 0xffff0000, v121
  v_sub_f32 v120, v120, v121
  v_cvt_pk_bf16_f32 v122, v120, v120
  v_and_b32 v122, 0xffff0000, v122
  v_sub_f32 v120, v120, v122
  v_cvt_pk_bf16_f32 v76, v121, v122
  v_cvt_pk_bf16_f32 v77, v120, 0
  ds_read_b64_tr_b16 v[156:157], v251 offset:24576
  ds_read_b64_tr_b16 v[158:159], v251 offset:26624
  v_mfma_f32_32x32x16_bf16 v[88:103], v[160:163], v[48:51], v[88:103]
  s_waitcnt lgkmcnt(9)
  v_add_f32 v128, v128, v129
  s_waitcnt lgkmcnt(8)
  v_add_f32 v130, v130, v131
  s_waitcnt lgkmcnt(7)
  v_add_f32 v132, v132, v133
  s_waitcnt lgkmcnt(6)
  v_add_f32 v134, v134, v135
  v_add_f32 v128, v128, v130
  v_add_f32 v132, v132, v134
  v_add_f32 v128, v128, v132
  v_add_u32 v248, s24, v248
  v_add_u32 v247, s24, v247
  v_add_u32 v246, s24, v246
  v_add_u32 v245, s24, v245
  ds_read_b64_tr_b16 v[168:169], v248 offset:0
  ds_read_b64_tr_b16 v[170:171], v248 offset:2048
  s_waitcnt vmcnt(4)
  v_mfma_f32_32x32x16_bf16 v[104:119], v[172:175], v[60:63], v[104:119]
  v_cndmask_b32 v128, 0, v128, vcc
  v_cvt_pk_bf16_f32 v129, v128, v128
  v_and_b32 v129, 0xffff0000, v129
  v_sub_f32 v128, v128, v129
  v_cvt_pk_bf16_f32 v130, v128, v128
  v_and_b32 v130, 0xffff0000, v130
  v_sub_f32 v128, v128, v130
  ds_read_b64_tr_b16 v[160:161], v250 offset:24576
  ds_read_b64_tr_b16 v[162:163], v250 offset:26624
  s_waitcnt lgkmcnt(8)
  v_mfma_f32_32x32x16_bf16 v[88:103], v[152:155], v[52:55], v[88:103]
  v_cvt_pk_bf16_f32 v78, v129, v130
  v_cvt_pk_bf16_f32 v79, v128, 0
  ds_read_b64_tr_b16 v[172:173], v247 offset:0
  ds_read_b64_tr_b16 v[174:175], v247 offset:2048
  s_waitcnt vmcnt(3) lgkmcnt(8)
  v_mfma_f32_32x32x16_bf16 v[104:119], v[164:167], v[64:67], v[104:119]
  v_mfma_f32_32x32x8_bf16 v[88:103], v[76:77], v[180:181], v[88:103]
  ds_read_b64_tr_b16 v[152:153], v249 offset:24576
  ds_read_b64_tr_b16 v[154:155], v249 offset:26624
  s_waitcnt lgkmcnt(8)
  v_mfma_f32_32x32x16_bf16 v[88:103], v[156:159], v[56:59], v[88:103]
  s_nop 6
  ds_write_b128 v235, v[104:107] offset:0
  ds_write_b128 v235, v[108:111] offset:1024
  ds_write_b128 v235, v[112:115] offset:2048
  ds_write_b128 v235, v[116:119] offset:3072
  s_mov_b64 exec, 0xff
  buffer_load_dword v243, v239, s[44:47], s5 offen sc1
  s_mov_b64 exec, -1
  ds_read_b64_tr_b16 v[164:165], v246 offset:0
  ds_read_b64_tr_b16 v[166:167], v246 offset:2048
  s_waitcnt lgkmcnt(12)
  v_mfma_f32_32x32x16_bf16 v[136:151], v[168:171], v[4:7], 0
  v_add_u32 v254, s24, v254
  v_add_u32 v251, s24, v251
  v_add_u32 v250, s24, v250
  v_add_u32 v249, s24, v249
  ds_read_b64_tr_b16 v[156:157], v254 offset:0
  ds_read_b64_tr_b16 v[158:159], v254 offset:2048
  s_waitcnt lgkmcnt(12)
  v_mfma_f32_32x32x16_bf16 v[88:103], v[160:163], v[60:63], v[88:103]
  ds_read_b64_tr_b16 v[168:169], v245 offset:0
  ds_read_b64_tr_b16 v[170:171], v245 offset:2048
  s_waitcnt lgkmcnt(12)
  v_mfma_f32_32x32x16_bf16 v[136:151], v[172:175], v[8:11], v[136:151]
  ds_read_b64_tr_b16 v[160:161], v251 offset:0
  ds_read_b64_tr_b16 v[162:163], v251 offset:2048
  s_waitcnt lgkmcnt(12)
  v_mfma_f32_32x32x16_bf16 v[88:103], v[152:155], v[64:67], v[88:103]
  s_waitcnt lgkmcnt(0)
  s_barrier
  ds_read_b64_tr_b16 v[172:173], v248 offset:8192
  ds_read_b64_tr_b16 v[174:175], v248 offset:10240
  v_mfma_f32_32x32x16_bf16 v[136:151], v[164:167], v[12:15], v[136:151]
  v_xor_b32 v235, 4096, v235
  ds_read_b128 v[104:107], v235 offset:0
  ds_read_b128 v[108:111], v235 offset:1024
  ds_read_b128 v[112:115], v235 offset:2048
  ds_read_b128 v[116:119], v235 offset:3072
  s_waitcnt lgkmcnt(3)
  s_nop 0
  v_add_f32 v88, v88, v104
  v_add_f32 v89, v89, v105
  ds_read_b64_tr_b16 v[152:153], v250 offset:0
  ds_read_b64_tr_b16 v[154:155], v250 offset:2048
  v_mfma_f32_32x32x8_bf16 v[120:135], v[78:79], v[180:181], 0
  v_add_f32 v90, v90, v106
  v_add_f32 v91, v91, v107
  s_waitcnt lgkmcnt(4)
  v_add_f32 v92, v92, v108
  v_add_f32 v93, v93, v109
  v_add_f32 v94, v94, v110
  v_add_f32 v95, v95, v111
  v_mul_f32 v104, v88, v88
  v_mfma_f32_32x32x16_bf16 v[120:135], v[156:159], v[4:7], v[120:135]
  v_mul_f32 v105, v89, v89
  v_mul_f32 v106, v90, v90
  v_mul_f32 v107, v91, v91
  v_mul_f32 v108, v92, v92
  v_mul_f32 v109, v93, v93
  v_mul_f32 v110, v94, v94
  v_mul_f32 v111, v95, v95
  s_add_u32 m0, s75, 16384
  s_xor_b32 s100, s3, 128
  buffer_load_dwordx4 v253, s[56:59], s100 offen lds
  s_add_u32 m0, s75, 24576
  s_xor_b32 s100, s3, 128
  buffer_load_dwordx4 v253, s[48:51], s100 offen lds
  ds_read_b64_tr_b16 v[164:165], v247 offset:8192
  ds_read_b64_tr_b16 v[166:167], v247 offset:10240
  v_mfma_f32_32x32x16_bf16 v[136:151], v[168:171], v[16:19], v[136:151]
  v_fma_f32 v104, v104, v176, v177
  v_fma_f32 v105, v105, v176, v177
  v_fma_f32 v106, v106, v176, v177
  v_fma_f32 v107, v107, v176, v177
  v_fma_f32 v108, v108, v176, v177
  v_fma_f32 v109, v109, v176, v177
  v_fma_f32 v110, v110, v176, v177
  ds_read_b64_tr_b16 v[156:157], v249 offset:0
  ds_read_b64_tr_b16 v[158:159], v249 offset:2048
  v_mfma_f32_32x32x16_bf16 v[120:135], v[160:163], v[8:11], v[120:135]
  v_fma_f32 v111, v111, v176, v177
  v_mul_f32 v104, v104, v88
  v_mul_f32 v105, v105, v89
  v_mul_f32 v106, v106, v90
  v_mul_f32 v107, v107, v91
  v_mul_f32 v108, v108, v92
  v_mul_f32 v109, v109, v93
  s_waitcnt vmcnt(2)
  v_mov_b32 v243, v243
  s_mov_b32 s101, 200000
  s_mov_b64 exec, 0xff
  s_nop 0
L_pl_M_13011:
  v_cmp_ne_u32 vcc, s72, v243
  s_nop 4
  s_cbranch_vccz L_pd_M_13012
  buffer_load_dword v243, v239, s[44:47], s5 offen sc1
  s_waitcnt vmcnt(0)
  s_sub_u32 s101, s101, 1
  s_cmp_lg_u32 s101, 0
  s_cbranch_scc1 L_pl_M_13011
L_pd_M_13012:
  s_mov_b64 exec, -1
  s_add_u32 m0, s75, 131072
  s_xor_b32 s100, s3, 256
  buffer_load_dwordx4 v253, s[56:59], s100 offen lds
  s_add_u32 m0, s75, 139264
  s_xor_b32 s100, s3, 256
  buffer_load_dwordx4 v253, s[48:51], s100 offen lds
  ds_read_b64_tr_b16 v[168:169], v246 offset:8192
  ds_read_b64_tr_b16 v[170:171], v246 offset:10240
  v_mfma_f32_32x32x16_bf16 v[136:151], v[172:175], v[20:23], v[136:151]
  v_mul_f32 v110, v110, v94
  v_mul_f32 v111, v111, v95
  v_exp_f32 v104, v104
  v_exp_f32 v105, v105
  v_exp_f32 v106, v106
  ds_read_b64_tr_b16 v[160:161], v254 offset:8192
  ds_read_b64_tr_b16 v[162:163], v254 offset:10240
  s_waitcnt lgkmcnt(8)
  v_mfma_f32_32x32x16_bf16 v[120:135], v[152:155], v[12:15], v[120:135]
  v_exp_f32 v107, v107
  v_exp_f32 v108, v108
  v_exp_f32 v109, v109
  v_exp_f32 v110, v110
  s_xor_b32 s100, s8, 0
  buffer_load_dwordx4 v[4:7], v238, s[44:47], s100 offen offset:0 sc1
  ds_read_b64_tr_b16 v[172:173], v245 offset:8192
  ds_read_b64_tr_b16 v[174:175], v245 offset:10240
  s_waitcnt lgkmcnt(8)
  v_mfma_f32_32x32x16_bf16 v[136:151], v[164:167], v[24:27], v[136:151]
  v_exp_f32 v111, v111
  v_fma_f32 v104, v104, v178, v178
  v_fma_f32 v105, v105, v178, v178
  v_fma_f32 v106, v106, v178, v178
  v_fma_f32 v107, v107, v178, v178
  v_fma_f32 v108, v108, v178, v178
  ds_read_b64_tr_b16 v[152:153], v251 offset:8192
  ds_read_b64_tr_b16 v[154:155], v251 offset:10240
  s_waitcnt lgkmcnt(8)
  v_mfma_f32_32x32x16_bf16 v[120:135], v[156:159], v[16:19], v[120:135]
  v_fma_f32 v109, v109, v178, v178
  v_fma_f32 v110, v110, v178, v178
  v_fma_f32 v111, v111, v178, v178
  v_rcp_f32 v104, v104
  v_rcp_f32 v105, v105
  s_xor_b32 s100, s8, 0
  buffer_load_dwordx4 v[8:11], v238, s[44:47], s100 offen offset:1024 sc1
  ds_read_b64_tr_b16 v[164:165], v248 offset:16384
  ds_read_b64_tr_b16 v[166:167], v248 offset:18432
  s_waitcnt lgkmcnt(8)
  v_mfma_f32_32x32x16_bf16 v[136:151], v[168:171], v[28:31], v[136:151]
  v_rcp_f32 v106, v106
  v_rcp_f32 v107, v107
  v_rcp_f32 v108, v108
  v_rcp_f32 v109, v109
  ds_read_b64_tr_b16 v[156:157], v250 offset:8192
  ds_read_b64_tr_b16 v[158:159], v250 offset:10240
  s_waitcnt lgkmcnt(8)
  v_mfma_f32_32x32x16_bf16 v[120:135], v[160:163], v[20:23], v[120:135]
  v_rcp_f32 v110, v110
  v_rcp_f32 v111, v111
  v_mul_f32 v88, v88, v104
  v_mul_f32 v89, v89, v105
  v_mul_f32 v90, v90, v106
  s_xor_b32 s100, s8, 8192
  buffer_load_dwordx4 v[12:15], v238, s[44:47], s100 offen offset:0 sc1
  ds_read_b64_tr_b16 v[168:169], v247 offset:16384
  ds_read_b64_tr_b16 v[170:171], v247 offset:18432
  s_waitcnt lgkmcnt(8)
  v_mfma_f32_32x32x16_bf16 v[136:151], v[172:175], v[32:35], v[136:151]
  v_mul_f32 v91, v91, v107
  v_mul_f32 v92, v92, v108
  v_mul_f32 v93, v93, v109
  v_mul_f32 v94, v94, v110
  v_mul_f32 v95, v95, v111
  v_cvt_pk_bf16_f32 v104, v88, v89
  v_cvt_pk_bf16_f32 v105, v90, v91
  ds_read_b64_tr_b16 v[160:161], v249 offset:8192
  ds_read_b64_tr_b16 v[162:163], v249 offset:10240
  s_waitcnt lgkmcnt(8)
  v_mfma_f32_32x32x16_bf16 v[120:135], v[152:155], v[24:27], v[120:135]
  v_cvt_pk_bf16_f32 v106, v92, v93
  v_cvt_pk_bf16_f32 v107, v94, v95
  buffer_store_dwordx4 v[104:107], v238, s[44:47], s18 offen offset:0 sc1
  v_add_f32 v96, v96, v112
  v_add_f32 v97, v97, v113
  v_add_f32 v98, v98, v114
  v_add_f32 v99, v99, v115
  s_xor_b32 s100, s8, 8192
  buffer_load_dwordx4 v[16:19], v238, s[44:47], s100 offen offset:1024 sc1
  ds_read_b64_tr_b16 v[172:173], v246 offset:16384
  ds_read_b64_tr_b16 v[174:175], v246 offset:18432
  s_waitcnt lgkmcnt(8)
  v_mfma_f32_32x32x16_bf16 v[136:151], v[164:167], v[36:39], v[136:151]
  v_add_f32 v100, v100, v116
  v_add_f32 v101, v101, v117
  v_add_f32 v102, v102, v118
  v_add_f32 v103, v103, v119
  v_mul_f32 v112, v96, v96
  v_mul_f32 v113, v97, v97
  v_mul_f32 v114, v98, v98
  ds_read_b64_tr_b16 v[152:153], v254 offset:16384
  ds_read_b64_tr_b16 v[154:155], v254 offset:18432
  s_waitcnt lgkmcnt(8)
  v_mfma_f32_32x32x16_bf16 v[120:135], v[156:159], v[28:31], v[120:135]
  v_mul_f32 v115, v99, v99
  v_mul_f32 v116, v100, v100
  v_mul_f32 v117, v101, v101
  v_mul_f32 v118, v102, v102
  v_mul_f32 v119, v103, v103
  v_fma_f32 v112, v112, v176, v177
  v_fma_f32 v113, v113, v176, v177
  s_xor_b32 s100, s8, 16384
  buffer_load_dwordx4 v[20:23], v238, s[44:47], s100 offen offset:0 sc1
  ds_read_b64_tr_b16 v[164:165], v245 offset:16384
  ds_read_b64_tr_b16 v[166:167], v245 offset:18432
  s_waitcnt lgkmcnt(8)
  v_mfma_f32_32x32x16_bf16 v[136:151], v[168:171], v[40:43], v[136:151]
  v_fma_f32 v114, v114, v176, v177
  v_fma_f32 v115, v115, v176, v177
  v_fma_f32 v116, v116, v176, v177
  v_fma_f32 v117, v117, v176, v177
  v_fma_f32 v118, v118, v176, v177
  v_fma_f32 v119, v119, v176, v177
  v_mul_f32 v112, v112, v96
  ds_read_b64_tr_b16 v[156:157], v251 offset:16384
  ds_read_b64_tr_b16 v[158:159], v251 offset:18432
  s_waitcnt lgkmcnt(8)
  v_mfma_f32_32x32x16_bf16 v[120:135], v[160:163], v[32:35], v[120:135]
  v_mul_f32 v113, v113, v97
  v_mul_f32 v114, v114, v98
  v_mul_f32 v115, v115, v99
  v_mul_f32 v116, v116, v100
  v_mul_f32 v117, v117, v101
  v_mul_f32 v118, v118, v102
  v_mul_f32 v119, v119, v103
  s_xor_b32 s100, s8, 16384
  buffer_load_dwordx4 v[24:27], v238, s[44:47], s100 offen offset:1024 sc1
  s_barrier
  ds_read_b64_tr_b16 v[168:169], v248 offset:24576
  ds_read_b64_tr_b16 v[170:171], v248 offset:26624
  s_waitcnt lgkmcnt(8)
  v_mfma_f32_32x32x16_bf16 v[136:151], v[172:175], v[44:47], v[136:151]
  v_exp_f32 v112, v112
  v_exp_f32 v113, v113
  v_exp_f32 v114, v114
  v_exp_f32 v115, v115
  ds_read_b64_tr_b16 v[160:161], v250 offset:16384
  ds_read_b64_tr_b16 v[162:163], v250 offset:18432
  s_waitcnt lgkmcnt(8)
  v_mfma_f32_32x32x16_bf16 v[120:135], v[152:155], v[36:39], v[120:135]
  v_exp_f32 v116, v116
  v_exp_f32 v117, v117
  v_exp_f32 v118, v118
  v_exp_f32 v119, v119
  s_add_u32 m0, s75, 0
  s_xor_b32 s100, s3, 384
  buffer_load_dwordx4 v253, s[56:59], s100 offen lds
  ds_read_b64_tr_b16 v[172:173], v247 offset:24576
  ds_read_b64_tr_b16 v[174:175], v247 offset:26624
  s_waitcnt lgkmcnt(8)
  v_mfma_f32_32x32x16_bf16 v[136:151], v[164:167], v[48:51], v[136:151]
  v_fma_f32 v112, v112, v178, v178
  v_fma_f32 v113, v113, v178, v178
  v_fma_f32 v114, v114, v178, v178
  v_fma_f32 v115, v115, v178, v178
  v_fma_f32 v116, v116, v178, v178
  v_fma_f32 v117, v117, v178, v178
  v_fma_f32 v118, v118, v178, v178
  ds_read_b64_tr_b16 v[152:153], v249 offset:16384
  ds_read_b64_tr_b16 v[154:155], v249 offset:18432
  s_waitcnt lgkmcnt(8)
  v_mfma_f32_32x32x16_bf16 v[120:135], v[156:159], v[40:43], v[120:135]
  v_fma_f32 v119, v119, v178, v178
  v_rcp_f32 v112, v112
  v_rcp_f32 v113, v113
  v_rcp_f32 v114, v114
  s_add_u32 m0, s75, 8192
  s_xor_b32 s100, s3, 384
  buffer_load_dwordx4 v253, s[48:51], s100 offen lds
  ds_read_b64_tr_b16 v[164:165], v246 offset:24576
  ds_read_b64_tr_b16 v[166:167], v246 offset:26624
  s_waitcnt lgkmcnt(8)
  v_mfma_f32_32x32x16_bf16 v[136:151], v[168:171], v[52:55], v[136:151]
  v_rcp_f32 v115, v115
  v_rcp_f32 v116, v116
  v_rcp_f32 v117, v117
  v_rcp_f32 v118, v118
  ds_read_b64_tr_b16 v[156:157], v254 offset:24576
  ds_read_b64_tr_b16 v[158:159], v254 offset:26624
  s_waitcnt lgkmcnt(8)
  v_mfma_f32_32x32x16_bf16 v[120:135], v[160:163], v[44:47], v[120:135]
  v_rcp_f32 v119, v119
  v_mul_f32 v96, v96, v112
  v_mul_f32 v97, v97, v113
  v_mul_f32 v98, v98, v114
  v_mul_f32 v99, v99, v115
  v_mul_f32 v100, v100, v116
  s_add_u32 m0, s75, 114688
  s_xor_b32 s100, s3, 512
  buffer_load_dwordx4 v253, s[56:59], s100 offen lds
  ds_read_b64_tr_b16 v[168:169], v245 offset:24576
  ds_read_b64_tr_b16 v[170:171], v245 offset:26624
  s_waitcnt lgkmcnt(8)
  v_mfma_f32_32x32x16_bf16 v[136:151], v[172:175], v[56:59], v[136:151]
  v_mul_f32 v101, v101, v117
  v_mul_f32 v102, v102, v118
  v_mul_f32 v103, v103, v119
  v_cvt_pk_bf16_f32 v112, v96, v97
  v_cvt_pk_bf16_f32 v113, v98, v99
  v_cvt_pk_bf16_f32 v114, v100, v101
  v_cvt_pk_bf16_f32 v115, v102, v103
  ds_read_b64_tr_b16 v[160:161], v251 offset:24576
  ds_read_b64_tr_b16 v[162:163], v251 offset:26624
  s_waitcnt lgkmcnt(8)
  v_mfma_f32_32x32x16_bf16 v[120:135], v[152:155], v[48:51], v[120:135]
  buffer_store_dwordx4 v[112:115], v238, s[44:47], s18 offen offset:1024 sc1
  s_add_u32 s18, s18, 4096
  s_add_u32 m0, s75, 122880
  s_xor_b32 s100, s3, 512
  buffer_load_dwordx4 v253, s[48:51], s100 offen lds
  s_waitcnt lgkmcnt(6)
  v_mfma_f32_32x32x16_bf16 v[136:151], v[164:167], v[60:63], v[136:151]
  ds_read_b64_tr_b16 v[152:153], v250 offset:24576
  ds_read_b64_tr_b16 v[154:155], v250 offset:26624
  s_waitcnt lgkmcnt(6)
  v_mfma_f32_32x32x16_bf16 v[120:135], v[156:159], v[52:55], v[120:135]
  s_xor_b32 s100, s8, 24576
  buffer_load_dwordx4 v[28:31], v238, s[44:47], s100 offen offset:0 sc1
  s_waitcnt lgkmcnt(4)
  v_mfma_f32_32x32x16_bf16 v[136:151], v[168:171], v[64:67], v[136:151]
  ds_read_b64_tr_b16 v[156:157], v249 offset:24576
  ds_read_b64_tr_b16 v[158:159], v249 offset:26624
  s_waitcnt lgkmcnt(4)
  v_mfma_f32_32x32x16_bf16 v[120:135], v[160:163], v[56:59], v[120:135]
  s_nop 7
  ds_write_b128 v234, v[136:139] offset:0
  ds_write_b128 v234, v[140:143] offset:1024
  ds_write_b128 v234, v[144:147] offset:2048
  ds_write_b128 v234, v[148:151] offset:3072
  s_xor_b32 s100, s8, 24576
  buffer_load_dwordx4 v[32:35], v238, s[44:47], s100 offen offset:1024 sc1
  s_waitcnt lgkmcnt(6)
  v_mfma_f32_32x32x16_bf16 v[120:135], v[152:155], v[60:63], v[120:135]
  s_xor_b32 s100, s8, 32768
  buffer_load_dwordx4 v[36:39], v238, s[44:47], s100 offen offset:0 sc1
  s_waitcnt lgkmcnt(4)
  v_mfma_f32_32x32x16_bf16 v[120:135], v[156:159], v[64:67], v[120:135]
  s_xor_b32 s100, s8, 32768
  buffer_load_dwordx4 v[40:43], v238, s[44:47], s100 offen offset:1024 sc1
  s_waitcnt vmcnt(18)
  s_waitcnt vmcnt(16)
  s_waitcnt lgkmcnt(0)
  s_barrier
  v_xor_b32 v234, 4096, v234
  ds_read_b128 v[136:139], v234 offset:0
  ds_read_b128 v[140:143], v234 offset:1024
  ds_read_b128 v[144:147], v234 offset:2048
  ds_read_b128 v[148:151], v234 offset:3072
  ds_read_b128 v[68:71], v230 offset:32768
  ds_read_b128 v[72:75], v230 offset:36864
  s_waitcnt vmcnt(5)
  s_mov_b64 exec, 1
  s_cmp_eq_u32 s80, 0
  s_cbranch_scc1 L_du_M_4_f
  buffer_store_dword v237, off, s[44:47], s9 sc1
  s_branch L_du_M_4_d
L_du_M_4_f:
  buffer_store_dword v237, off, s[44:47], s9
L_du_M_4_d:
  s_mov_b64 exec, -1
  s_add_u32 s9, s9, 512
  s_add_u32 m0, s75, 65536
  s_xor_b32 s100, s3, 640
  buffer_load_dwordx4 v253, s[56:59], s100 offen lds
  s_add_u32 m0, s75, 73728
  s_xor_b32 s100, s3, 640
  buffer_load_dwordx4 v253, s[48:51], s100 offen lds
  ds_read_b128 v[152:155], v229 offset:32768
  ds_read_b128 v[156:159], v229 offset:36864
  s_add_u32 m0, s75, 98304
  s_xor_b32 s100, s3, 768
  buffer_load_dwordx4 v253, s[56:59], s100 offen lds
  s_waitcnt lgkmcnt(3)
  v_mfma_f32_32x32x16_bf16 v[84:99], v[68:71], v[4:7], 0
  v_add_f32 v120, v120, v136
  v_add_f32 v121, v121, v137
  v_add_f32 v122, v122, v138
  v_add_f32 v123, v123, v139
  v_add_f32 v124, v124, v140
  v_add_f32 v125, v125, v141
  v_add_f32 v126, v126, v142
  v_add_f32 v127, v127, v143
  v_mul_f32 v136, v120, v120
  v_mul_f32 v137, v121, v121
  v_mul_f32 v138, v122, v122
  v_mul_f32 v139, v123, v123
  v_mul_f32 v140, v124, v124
  v_mul_f32 v141, v125, v125
  s_waitcnt lgkmcnt(2)
  v_mfma_f32_32x32x16_bf16 v[100:115], v[72:75], v[4:7], 0
  v_mul_f32 v142, v126, v126
  v_mul_f32 v143, v127, v127
  v_fma_f32 v136, v136, v176, v177
  v_fma_f32 v137, v137, v176, v177
  v_fma_f32 v138, v138, v176, v177
  v_fma_f32 v139, v139, v176, v177
  v_fma_f32 v140, v140, v176, v177
  v_fma_f32 v141, v141, v176, v177
  v_fma_f32 v142, v142, v176, v177
  v_fma_f32 v143, v143, v176, v177
  v_mul_f32 v136, v136, v120
  v_mul_f32 v137, v137, v121
  v_mul_f32 v138, v138, v122
  v_mul_f32 v139, v139, v123
  s_add_u32 m0, s75, 106496
  s_xor_b32 s100, s3, 768
  buffer_load_dwordx4 v253, s[48:51], s100 offen lds
  ds_read_b128 v[160:163], v230 offset:16384
  ds_read_b128 v[164:167], v230 offset:20480
  s_xor_b32 s100, s8, 40960
  buffer_load_dwordx4 v[44:47], v238, s[44:47], s100 offen offset:0 sc1
  s_waitcnt lgkmcnt(3)
  v_mfma_f32_32x32x16_bf16 v[84:99], v[152:155], v[8:11], v[84:99]
  v_mul_f32 v140, v140, v124
  v_mul_f32 v141, v141, v125
  v_mul_f32 v142, v142, v126
  v_mul_f32 v143, v143, v127
  v_exp_f32 v136, v136
  v_exp_f32 v137, v137
  v_exp_f32 v138, v138
  v_exp_f32 v139, v139
  v_exp_f32 v140, v140
  s_waitcnt lgkmcnt(2)
  v_mfma_f32_32x32x16_bf16 v[100:115], v[156:159], v[8:11], v[100:115]
  v_exp_f32 v141, v141
  v_exp_f32 v142, v142
  v_exp_f32 v143, v143
  v_fma_f32 v136, v136, v178, v178
  v_fma_f32 v137, v137, v178, v178
  v_fma_f32 v138, v138, v178, v178
  v_fma_f32 v139, v139, v178, v178
  v_fma_f32 v140, v140, v178, v178
  v_fma_f32 v141, v141, v178, v178
  v_fma_f32 v142, v142, v178, v178
  v_fma_f32 v143, v143, v178, v178
  s_xor_b32 s100, s8, 40960
  buffer_load_dwordx4 v[48:51], v238, s[44:47], s100 offen offset:1024 sc1
  ds_read_b128 v[68:71], v229 offset:16384
  ds_read_b128 v[72:75], v229 offset:20480
  s_xor_b32 s100, s8, 49152
  buffer_load_dwordx4 v[52:55], v238, s[44:47], s100 offen offset:0 sc1
  s_waitcnt lgkmcnt(3)
  v_mfma_f32_32x32x16_bf16 v[84:99], v[160:163], v[12:15], v[84:99]
  v_rcp_f32 v136, v136
  v_rcp_f32 v137, v137
  v_rcp_f32 v138, v138
  v_rcp_f32 v139, v139
  v_rcp_f32 v140, v140
  v_rcp_f32 v141, v141
  v_rcp_f32 v142, v142
  s_waitcnt lgkmcnt(2)
  v_mfma_f32_32x32x16_bf16 v[100:115], v[164:167], v[12:15], v[100:115]
  v_rcp_f32 v143, v143
  v_mul_f32 v120, v120, v136
  v_mul_f32 v121, v121, v137
  v_mul_f32 v122, v122, v138
  v_mul_f32 v123, v123, v139
  v_mul_f32 v124, v124, v140
  v_mul_f32 v125, v125, v141
  v_mul_f32 v126, v126, v142
  v_mul_f32 v127, v127, v143
  v_cvt_pk_bf16_f32 v136, v120, v121
  v_cvt_pk_bf16_f32 v137, v122, v123
  v_cvt_pk_bf16_f32 v138, v124, v125
  v_cvt_pk_bf16_f32 v139, v126, v127
  s_xor_b32 s100, s8, 49152
  buffer_load_dwordx4 v[56:59], v238, s[44:47], s100 offen offset:1024 sc1
  ds_read_b128 v[152:155], v223
  ds_read_b128 v[156:159], v223 offset:4096
  s_xor_b32 s100, s8, 57344
  buffer_load_dwordx4 v[60:63], v238, s[44:47], s100 offen offset:0 sc1
  s_waitcnt lgkmcnt(3)
  v_mfma_f32_32x32x16_bf16 v[84:99], v[68:71], v[16:19], v[84:99]
  buffer_store_dwordx4 v[136:139], v238, s[44:47], s18 offen offset:0 sc1
  v_add_f32 v128, v128, v144
  v_add_f32 v129, v129, v145
  v_add_f32 v130, v130, v146
  v_add_f32 v131, v131, v147
  v_add_f32 v132, v132, v148
  v_add_f32 v133, v133, v149
  v_add_f32 v134, v134, v150
  v_add_f32 v135, v135, v151
  v_mul_f32 v144, v128, v128
  v_mul_f32 v145, v129, v129
  v_mul_f32 v146, v130, v130
  v_mul_f32 v147, v131, v131
  v_mul_f32 v148, v132, v132
  s_waitcnt lgkmcnt(2)
  v_mfma_f32_32x32x16_bf16 v[100:115], v[72:75], v[16:19], v[100:115]
  v_mul_f32 v149, v133, v133
  v_mul_f32 v150, v134, v134
  v_mul_f32 v151, v135, v135
  v_fma_f32 v144, v144, v176, v177
  v_fma_f32 v145, v145, v176, v177
  v_fma_f32 v146, v146, v176, v177
  v_fma_f32 v147, v147, v176, v177
  v_fma_f32 v148, v148, v176, v177
  v_fma_f32 v149, v149, v176, v177
  v_fma_f32 v150, v150, v176, v177
  v_fma_f32 v151, v151, v176, v177
  v_mul_f32 v144, v144, v128
  v_mul_f32 v145, v145, v129
  v_mul_f32 v146, v146, v130
  s_xor_b32 s100, s8, 57344
  buffer_load_dwordx4 v[64:67], v238, s[44:47], s100 offen offset:1024 sc1
  ds_read_b128 v[160:163], v221
  ds_read_b128 v[164:167], v221 offset:4096
  s_waitcnt lgkmcnt(3)
  v_mfma_f32_32x32x16_bf16 v[84:99], v[152:155], v[20:23], v[84:99]
  v_mul_f32 v147, v147, v131
  v_mul_f32 v148, v148, v132
  v_mul_f32 v149, v149, v133
  v_mul_f32 v150, v150, v134
  v_mul_f32 v151, v151, v135
  v_exp_f32 v144, v144
  v_exp_f32 v145, v145
  v_exp_f32 v146, v146
  v_exp_f32 v147, v147
  v_exp_f32 v148, v148
  s_waitcnt lgkmcnt(2)
  v_mfma_f32_32x32x16_bf16 v[100:115], v[156:159], v[20:23], v[100:115]
  v_exp_f32 v149, v149
  v_exp_f32 v150, v150
  v_exp_f32 v151, v151
  v_fma_f32 v144, v144, v178, v178
  v_fma_f32 v145, v145, v178, v178
  v_fma_f32 v146, v146, v178, v178
  v_fma_f32 v147, v147, v178, v178
  v_fma_f32 v148, v148, v178, v178
  v_fma_f32 v149, v149, v178, v178
  v_fma_f32 v150, v150, v178, v178
  v_fma_f32 v151, v151, v178, v178
  v_rcp_f32 v144, v144
  v_rcp_f32 v145, v145
  v_rcp_f32 v146, v146
  v_rcp_f32 v147, v147
  v_rcp_f32 v148, v148
  v_rcp_f32 v149, v149
  v_rcp_f32 v150, v150
  v_rcp_f32 v151, v151
  v_mul_f32 v128, v128, v144
  v_mul_f32 v129, v129, v145
  v_mul_f32 v130, v130, v146
  v_mul_f32 v131, v131, v147
  v_mul_f32 v132, v132, v148
  v_mul_f32 v133, v133, v149
  v_mul_f32 v134, v134, v150
  v_mul_f32 v135, v135, v151
  v_cvt_pk_bf16_f32 v144, v128, v129
  v_cvt_pk_bf16_f32 v145, v130, v131
  v_cvt_pk_bf16_f32 v146, v132, v133
  v_cvt_pk_bf16_f32 v147, v134, v135
  buffer_store_dwordx4 v[144:147], v238, s[44:47], s18 offen offset:1024 sc1
  s_waitcnt vmcnt(17)
  s_waitcnt lgkmcnt(0)
  s_barrier
  ds_read_b128 v[68:71], v230
  ds_read_b128 v[72:75], v230 offset:4096
  s_mov_b64 exec, 0x3fff
  buffer_load_dword v254, v239, s[44:47], s6 offen sc1
  s_mov_b64 exec, -1
  s_add_u32 m0, s75, 16384
  s_xor_b32 s100, s3, 896
  buffer_load_dwordx4 v253, s[56:59], s100 offen lds
  v_mfma_f32_32x32x16_bf16 v[84:99], v[160:163], v[24:27], v[84:99]
  v_mfma_f32_32x32x16_bf16 v[100:115], v[164:167], v[24:27], v[100:115]
  ds_read_b128 v[152:155], v229
  ds_read_b128 v[156:159], v229 offset:4096
  s_add_u32 m0, s75, 24576
  s_xor_b32 s100, s3, 896
  buffer_load_dwordx4 v253, s[48:51], s100 offen lds
  s_waitcnt vmcnt(19) lgkmcnt(3)
  v_mfma_f32_32x32x16_bf16 v[84:99], v[68:71], v[28:31], v[84:99]
  s_waitcnt lgkmcnt(2)
  v_mfma_f32_32x32x16_bf16 v[100:115], v[72:75], v[28:31], v[100:115]
  ds_read_b128 v[160:163], v224 offset:49152
  ds_read_b128 v[164:167], v224 offset:53248
  s_add_u32 m0, s75, 32768
  s_lshl4_add_u32 s100, s11, s74
  buffer_load_dwordx4 v252, s[52:55], s100 offen lds
  s_waitcnt vmcnt(19) lgkmcnt(3)
  v_mfma_f32_32x32x16_bf16 v[84:99], v[152:155], v[32:35], v[84:99]
  s_waitcnt lgkmcnt(2)
  v_mfma_f32_32x32x16_bf16 v[100:115], v[156:159], v[32:35], v[100:115]
  ds_read_b128 v[68:71], v222 offset:49152
  ds_read_b128 v[72:75], v222 offset:53248
  s_waitcnt vmcnt(4)
  s_mov_b64 exec, 1
  s_cmp_eq_u32 s80, 0
  s_cbranch_scc1 L_du_M_5_f
  buffer_store_dword v237, off, s[44:47], s9 sc1
  s_branch L_du_M_5_d
L_du_M_5_f:
  buffer_store_dword v237, off, s[44:47], s9
L_du_M_5_d:
  s_mov_b64 exec, -1
  s_add_u32 m0, s75, 40960
  s_lshl4_add_u32 s100, s12, s74
  buffer_load_dwordx4 v252, s[52:55], s100 offen lds
  s_waitcnt lgkmcnt(3)
  v_mfma_f32_32x32x16_bf16 v[84:99], v[160:163], v[36:39], v[84:99]
  s_waitcnt lgkmcnt(2)
  v_mfma_f32_32x32x16_bf16 v[100:115], v[164:167], v[36:39], v[100:115]
  s_waitcnt vmcnt(3)
  s_waitcnt lgkmcnt(0)
  s_barrier
  ds_read_b128 v[152:155], v224
  ds_read_b128 v[156:159], v224 offset:4096
  s_add_u32 m0, s75, 0
  s_lshl4_add_u32 s100, s14, s74
  buffer_load_dwordx4 v252, s[52:55], s100 offen lds
  v_mfma_f32_32x32x16_bf16 v[84:99], v[68:71], v[40:43], v[84:99]
  v_mfma_f32_32x32x16_bf16 v[100:115], v[72:75], v[40:43], v[100:115]
  ds_read_b128 v[160:163], v222
  ds_read_b128 v[164:167], v222 offset:4096
  v_mov_b32 v254, v254
  s_mov_b32 s101, 200000
  s_mov_b64 exec, 0x3fff
  s_nop 6
L_pl_M_20013:
  v_cmp_ne_u32 vcc, s72, v254
  s_nop 4
  s_cbranch_vccz L_pd_M_20014
  buffer_load_dword v254, v239, s[44:47], s6 offen sc1
  s_waitcnt vmcnt(0)
  s_sub_u32 s101, s101, 1
  s_cmp_lg_u32 s101, 0
  s_cbranch_scc1 L_pl_M_20013
L_pd_M_20014:
  s_mov_b64 exec, -1
  buffer_load_dwordx4 v[76:79], v244, s[44:47], s10 offen sc1
  s_waitcnt lgkmcnt(3)
  v_mfma_f32_32x32x16_bf16 v[84:99], v[152:155], v[44:47], v[84:99]
  s_waitcnt lgkmcnt(2)
  v_mfma_f32_32x32x16_bf16 v[100:115], v[156:159], v[44:47], v[100:115]
  ds_read_b128 v[68:71], v224 offset:32768
  ds_read_b128 v[72:75], v224 offset:36864
  buffer_load_dwordx4 v[116:119], v244, s[44:47], s11 offen sc1
  s_waitcnt lgkmcnt(3)
  v_mfma_f32_32x32x16_bf16 v[84:99], v[160:163], v[48:51], v[84:99]
  s_waitcnt lgkmcnt(2)
  v_mfma_f32_32x32x16_bf16 v[100:115], v[164:167], v[48:51], v[100:115]
  ds_read_b128 v[152:155], v222 offset:32768
  ds_read_b128 v[156:159], v222 offset:36864
  buffer_load_dwordx4 v[168:171], v244, s[44:47], s12 offen sc1
  s_waitcnt lgkmcnt(3)
  v_mfma_f32_32x32x16_bf16 v[84:99], v[68:71], v[52:55], v[84:99]
  s_waitcnt lgkmcnt(2)
  v_mfma_f32_32x32x16_bf16 v[100:115], v[72:75], v[52:55], v[100:115]
  ds_read_b128 v[160:163], v230 offset:16384
  ds_read_b128 v[164:167], v230 offset:20480
  buffer_load_dwordx4 v[172:175], v244, s[44:47], s14 offen sc1
  s_waitcnt lgkmcnt(3)
  v_mfma_f32_32x32x16_bf16 v[84:99], v[152:155], v[56:59], v[84:99]
  s_waitcnt lgkmcnt(2)
  v_mfma_f32_32x32x16_bf16 v[100:115], v[156:159], v[56:59], v[100:115]
  ds_read_b128 v[68:71], v229 offset:16384
  ds_read_b128 v[72:75], v229 offset:20480
  s_add_u32 m0, s75, 8192
  s_lshl4_add_u32 s100, s15, s74
  buffer_load_dwordx4 v252, s[52:55], s100 offen lds
  s_waitcnt lgkmcnt(3)
  v_mfma_f32_32x32x16_bf16 v[84:99], v[160:163], v[60:63], v[84:99]
  s_waitcnt lgkmcnt(2)
  v_mfma_f32_32x32x16_bf16 v[100:115], v[164:167], v[60:63], v[100:115]
  s_waitcnt vmcnt(8)
  s_waitcnt vmcnt(6)
  s_waitcnt vmcnt(5)
  s_waitcnt lgkmcnt(0)
  s_barrier
  ds_read_b64_tr_b16 v[152:153], v219 offset:16384
  ds_read_b64_tr_b16 v[154:155], v219 offset:17408
  ds_read_b64_tr_b16 v[156:157], v217 offset:16384
  ds_read_b64_tr_b16 v[158:159], v217 offset:17408
  s_add_u32 m0, s75, 16384
  s_lshl4_add_u32 s100, s16, s74
  buffer_load_dwordx4 v252, s[52:55], s100 offen lds
  v_mfma_f32_32x32x16_bf16 v[84:99], v[68:71], v[64:67], v[84:99]
  v_mfma_f32_32x32x16_bf16 v[100:115], v[72:75], v[64:67], v[100:115]
  s_add_u32 m0, s75, 24576
  s_lshl4_add_u32 s100, s17, s74
  buffer_load_dwordx4 v252, s[52:55], s100 offen lds
  ds_read_b64_tr_b16 v[160:161], v228 offset:32768
  ds_read_b64_tr_b16 v[162:163], v228 offset:33792
  ds_read_b64_tr_b16 v[164:165], v227 offset:32768
  ds_read_b64_tr_b16 v[166:167], v227 offset:33792
  s_add_u32 m0, s75, 49152
  s_lshl4_add_u32 s100, s30, s74
  buffer_load_dwordx4 v252, s[52:55], s100 offen lds
  s_waitcnt vmcnt(7) lgkmcnt(6)
  v_mfma_f32_32x32x16_bf16 v[136:151], v[152:155], v[76:79], 0
  s_waitcnt lgkmcnt(4)
  v_mfma_f32_32x32x16_bf16 v[192:207], v[156:159], v[76:79], 0
  buffer_load_dwordx4 v[4:7], v244, s[44:47], s15 offen sc1
  ds_read_b64_tr_b16 v[68:69], v228 offset:40960
  ds_read_b64_tr_b16 v[70:71], v228 offset:41984
  ds_read_b64_tr_b16 v[72:73], v227 offset:40960
  ds_read_b64_tr_b16 v[74:75], v227 offset:41984
  buffer_load_dwordx2 v[176:177], v211, s[44:47], s69 offen sc1
  buffer_load_dwordx2 v[178:179], v211, s[44:47], s69 offen offset:2048 sc1
  buffer_load_dwordx4 v[8:11], v244, s[44:47], s16 offen sc1
  s_waitcnt vmcnt(10) lgkmcnt(6)
  v_mfma_f32_32x32x16_bf16 v[136:151], v[160:163], v[116:119], v[136:151]
  s_waitcnt lgkmcnt(4)
  v_mfma_f32_32x32x16_bf16 v[192:207], v[164:167], v[116:119], v[192:207]
  buffer_load_dwordx4 v[12:15], v244, s[44:47], s17 offen sc1
  ds_read_b64_tr_b16 v[152:153], v228
  ds_read_b64_tr_b16 v[154:155], v228 offset:1024
  ds_read_b64_tr_b16 v[156:157], v227
  ds_read_b64_tr_b16 v[158:159], v227 offset:1024
  buffer_load_dwordx4 v[16:19], v244, s[44:47], s30 offen sc1
  s_waitcnt vmcnt(11) lgkmcnt(6)
  v_mfma_f32_32x32x16_bf16 v[136:151], v[68:71], v[168:171], v[136:151]
  s_waitcnt lgkmcnt(4)
  v_mfma_f32_32x32x16_bf16 v[192:207], v[72:75], v[168:171], v[192:207]
  s_add_u32 m0, s75, 57344
  s_lshl4_add_u32 s100, s31, s74
  buffer_load_dwordx4 v252, s[52:55], s100 offen lds
  s_waitcnt vmcnt(10)
  s_waitcnt vmcnt(9)
  s_waitcnt vmcnt(8)
  s_waitcnt vmcnt(7)
  s_waitcnt lgkmcnt(0)
  s_barrier
  ds_read_b64_tr_b16 v[160:161], v228 offset:8192
  ds_read_b64_tr_b16 v[162:163], v228 offset:9216
  ds_read_b64_tr_b16 v[164:165], v227 offset:8192
  ds_read_b64_tr_b16 v[166:167], v227 offset:9216
  s_add_u32 s6, s6, 512
  s_mov_b64 exec, 0x3fff
  buffer_load_dword v254, v239, s[44:47], s6 offen sc1
  s_mov_b64 exec, -1
  s_add_u32 m0, s75, 73728
  s_lshl4_add_u32 s100, s89, s74
  buffer_load_dwordx4 v252, s[52:55], s100 offen lds
  v_mfma_f32_32x32x16_bf16 v[136:151], v[152:155], v[172:175], v[136:151]
  v_mfma_f32_32x32x16_bf16 v[192:207], v[156:159], v[172:175], v[192:207]
  s_mov_b32 s92, 0
  s_cmp_eq_u32 s83, 1
  s_cselect_b32 s92, 32768, s92
  s_cmp_eq_u32 s83, 2
  s_cselect_b32 s92, 40960, s92
  s_add_u32 m0, s75, 81920
  s_lshl4_add_u32 s100, s90, s74
  buffer_load_dwordx4 v252, s[52:55], s100 offen lds
  ds_read_b64_tr_b16 v[68:69], v228 offset:16384
  ds_read_b64_tr_b16 v[70:71], v228 offset:17408
  ds_read_b64_tr_b16 v[72:73], v227 offset:16384
  ds_read_b64_tr_b16 v[74:75], v227 offset:17408
  s_add_u32 m0, s75, 90112
  s_lshl4_add_u32 s100, s91, s74
  buffer_load_dwordx4 v252, s[52:55], s100 offen lds
  s_waitcnt vmcnt(10) lgkmcnt(6)
  v_mfma_f32_32x32x16_bf16 v[136:151], v[160:163], v[4:7], v[136:151]
  s_cmp_eq_u32 s83, 3
  s_cselect_b32 s92, 65536, s92
  v_add_u32 v180, s92, v226
  v_xor_b32 v181, 32, v180
  v_xor_b32 v182, 64, v180
  s_waitcnt lgkmcnt(4)
  v_mfma_f32_32x32x16_bf16 v[192:207], v[164:167], v[4:7], v[192:207]
  v_xor_b32 v183, 96, v180
  ds_write_b128 v180, v[84:87]
  ds_write_b128 v181, v[88:91]
  ds_write_b128 v182, v[92:95]
  ds_write_b128 v183, v[96:99]
  buffer_load_dwordx4 v[20:23], v244, s[44:47], s31 offen sc1
  ds_read_b64_tr_b16 v[152:153], v228 offset:24576
  ds_read_b64_tr_b16 v[154:155], v228 offset:25600
  ds_read_b64_tr_b16 v[156:157], v227 offset:24576
  ds_read_b64_tr_b16 v[158:159], v227 offset:25600
  buffer_load_dwordx4 v[120:123], v244, s[44:47], s89 offen sc1
  s_waitcnt vmcnt(9) lgkmcnt(10)
  v_mfma_f32_32x32x16_bf16 v[136:151], v[68:71], v[8:11], v[136:151]
  s_waitcnt lgkmcnt(8)
  v_mfma_f32_32x32x16_bf16 v[192:207], v[72:75], v[8:11], v[192:207]
  buffer_load_dwordx4 v[124:127], v244, s[44:47], s90 offen sc1
  ds_read_b64_tr_b16 v[160:161], v228 offset:49152
  ds_read_b64_tr_b16 v[162:163], v228 offset:50176
  ds_read_b64_tr_b16 v[164:165], v227 offset:49152
  ds_read_b64_tr_b16 v[166:167], v227 offset:50176
  buffer_load_dwordx4 v[128:131], v244, s[44:47], s91 offen sc1
  s_waitcnt vmcnt(10) lgkmcnt(6)
  v_mfma_f32_32x32x16_bf16 v[136:151], v[152:155], v[12:15], v[136:151]
  s_waitcnt lgkmcnt(4)
  v_mfma_f32_32x32x16_bf16 v[192:207], v[156:159], v[12:15], v[192:207]
  s_add_u32 m0, s75, 98304
  s_lshl4_add_u32 s100, s87, s74
  buffer_load_dwordx4 v252, s[52:55], s100 offen lds
  s_waitcnt vmcnt(9)
  s_waitcnt vmcnt(7)
  s_waitcnt vmcnt(6)
  s_waitcnt vmcnt(5)
  s_waitcnt lgkmcnt(0)
  s_barrier
  ds_read_b64_tr_b16 v[68:69], v228 offset:57344
  ds_read_b64_tr_b16 v[70:71], v228 offset:58368
  ds_read_b64_tr_b16 v[72:73], v227 offset:57344
  ds_read_b64_tr_b16 v[74:75], v227 offset:58368
  s_add_u32 m0, s75, 106496
  s_lshl4_add_u32 s100, s82, s74
  buffer_load_dwordx4 v252, s[52:55], s100 offen lds
  v_mfma_f32_32x32x16_bf16 v[136:151], v[160:163], v[16:19], v[136:151]
  v_mfma_f32_32x32x16_bf16 v[192:207], v[164:167], v[16:19], v[192:207]
  ds_read_b128 v[84:87], v225
  ds_read_b128 v[88:91], v225 offset:32768
  ds_read_b128 v[92:95], v225 offset:40960
  ds_read_b128 v[96:99], v216
  s_waitcnt lgkmcnt(2)
  v_add_f32 v84, v84, v88
  s_add_u32 m0, s75, 114688
  v_add_u32 v252, 0x10000, v252
  s_lshl4_add_u32 s100, s10, s74
  buffer_load_dwordx4 v252, s[52:55], s100 offen lds
  ds_read_b64_tr_b16 v[152:153], v220 offset:8192
  ds_read_b64_tr_b16 v[154:155], v220 offset:9216
  ds_read_b64_tr_b16 v[156:157], v218 offset:8192
  ds_read_b64_tr_b16 v[158:159], v218 offset:9216
  v_mov_b32 v254, v254
  s_mov_b32 s101, 200000
  s_mov_b64 exec, 0x3fff
  s_nop 0
L_pl_M_26015:
  v_cmp_ne_u32 vcc, s72, v254
  s_nop 4
  s_cbranch_vccz L_pd_M_26016
  buffer_load_dword v254, v239, s[44:47], s6 offen sc1
  s_waitcnt vmcnt(0)
  s_sub_u32 s101, s101, 1
  s_cmp_lg_u32 s101, 0
  s_cbranch_scc1 L_pl_M_26015
L_pd_M_26016:
  s_mov_b64 exec, -1
  s_add_u32 m0, s75, 122880
  s_lshl4_add_u32 s100, s11, s74
  buffer_load_dwordx4 v252, s[52:55], s100 offen lds
  s_waitcnt vmcnt(7)
  v_mfma_f32_32x32x16_bf16 v[136:151], v[68:71], v[20:23], v[136:151]
  s_waitcnt lgkmcnt(4)
  v_add_f32 v92, v92, v96
  v_add_f32 v85, v85, v89
  v_add_f32 v93, v93, v97
  v_add_f32 v86, v86, v90
  v_add_f32 v94, v94, v98
  v_mfma_f32_32x32x16_bf16 v[192:207], v[72:75], v[20:23], v[192:207]
  v_add_f32 v87, v87, v91
  v_add_f32 v95, v95, v99
  v_add_f32 v84, v84, v92
  v_add_f32 v85, v85, v93
  v_add_f32 v86, v86, v94
  buffer_load_dwordx4 v[132:135], v244, s[44:47], s87 offen sc1
  ds_read_b64_tr_b16 v[160:161], v220 offset:16384
  ds_read_b64_tr_b16 v[162:163], v220 offset:17408
  ds_read_b64_tr_b16 v[164:165], v218 offset:16384
  ds_read_b64_tr_b16 v[166:167], v218 offset:17408
  buffer_load_dwordx4 v[24:27], v244, s[44:47], s82 offen sc1
  s_waitcnt vmcnt(8) lgkmcnt(6)
  v_mfma_f32_32x32x16_bf16 v[136:151], v[152:155], v[120:123], v[136:151]
  v_add_f32 v87, v87, v95
  v_add_f32 v84, v84, v184
  v_add_f32 v85, v85, v185
  v_add_f32 v86, v86, v186
  v_add_f32 v87, v87, v187
  s_waitcnt lgkmcnt(4)
  v_mfma_f32_32x32x16_bf16 v[192:207], v[156:159], v[120:123], v[192:207]
  v_lshlrev_b32 v88, 16, v80
  v_and_b32 v89, 0xffff0000, v80
  v_lshlrev_b32 v92, 16, v176
  v_and_b32 v93, 0xffff0000, v176
  v_lshlrev_b32 v90, 16, v81
  v_add_u32 v244, 0x1000, v244
  buffer_load_dwordx4 v[28:31], v244, s[44:47], s10 offen sc1
  ds_read_b64_tr_b16 v[68:69], v220 offset:24576
  ds_read_b64_tr_b16 v[70:71], v220 offset:25600
  ds_read_b64_tr_b16 v[72:73], v218 offset:24576
  ds_read_b64_tr_b16 v[74:75], v218 offset:25600
  buffer_load_dwordx4 v[32:35], v244, s[44:47], s11 offen sc1
  s_waitcnt vmcnt(9) lgkmcnt(6)
  v_mfma_f32_32x32x16_bf16 v[136:151], v[160:163], v[124:127], v[136:151]
  v_and_b32 v91, 0xffff0000, v81
  v_lshlrev_b32 v94, 16, v177
  v_and_b32 v95, 0xffff0000, v177
  s_mov_b32 s92, 8192
  s_cmp_eq_u32 s83, 1
  s_cselect_b32 s92, 16384, s92
  s_waitcnt lgkmcnt(4)
  v_mfma_f32_32x32x16_bf16 v[192:207], v[164:167], v[124:127], v[192:207]
  s_cmp_eq_u32 s83, 2
  s_cselect_b32 s92, 24576, s92
  s_cmp_eq_u32 s83, 3
  s_cselect_b32 s92, 49152, s92
  v_add_u32 v180, s92, v226
  s_add_u32 m0, s75, 131072
  s_lshl4_add_u32 s100, s12, s74
  buffer_load_dwordx4 v252, s[52:55], s100 offen lds
  v_xor_b32 v181, 32, v180
  v_xor_b32 v182, 64, v180
  v_xor_b32 v183, 96, v180
  ds_write_b128 v180, v[100:103]
  ds_write_b128 v181, v[104:107]
  ds_write_b128 v182, v[108:111]
  ds_write_b128 v183, v[112:115]
  s_waitcnt vmcnt(8)
  s_waitcnt vmcnt(7)
  s_waitcnt vmcnt(6)
  s_waitcnt vmcnt(5)
  s_waitcnt lgkmcnt(0)
  s_barrier
  ds_read_b64_tr_b16 v[152:153], v220 offset:32768
  ds_read_b64_tr_b16 v[154:155], v220 offset:33792
  ds_read_b64_tr_b16 v[156:157], v218 offset:32768
  ds_read_b64_tr_b16 v[158:159], v218 offset:33792
  s_add_u32 m0, s75, 0
  s_lshl4_add_u32 s100, s14, s74
  buffer_load_dwordx4 v252, s[52:55], s100 offen lds
  v_mfma_f32_32x32x16_bf16 v[136:151], v[68:71], v[128:131], v[136:151]
  v_mfma_f32_32x32x16_bf16 v[192:207], v[72:75], v[128:131], v[192:207]
  ds_read_b128 v[100:103], v225 offset:8192
  ds_read_b128 v[104:107], v225 offset:16384
  ds_read_b128 v[108:111], v225 offset:24576
  ds_read_b128 v[112:115], v225 offset:49152
  s_waitcnt lgkmcnt(2)
  v_add_f32 v100, v100, v104
  s_add_u32 m0, s75, 32768
  s_lshl4_add_u32 s100, s15, s74
  buffer_load_dwordx4 v252, s[52:55], s100 offen lds
  ds_read_b64_tr_b16 v[160:161], v220 offset:40960
  ds_read_b64_tr_b16 v[162:163], v220 offset:41984
  ds_read_b64_tr_b16 v[164:165], v218 offset:40960
  ds_read_b64_tr_b16 v[166:167], v218 offset:41984
  s_add_u32 m0, s75, 40960
  s_lshl4_add_u32 s100, s16, s74
  buffer_load_dwordx4 v252, s[52:55], s100 offen lds
  s_waitcnt vmcnt(7)
  v_mfma_f32_32x32x16_bf16 v[136:151], v[152:155], v[132:135], v[136:151]
  s_waitcnt lgkmcnt(4)
  v_add_f32 v108, v108, v112
  v_add_f32 v101, v101, v105
  v_add_f32 v109, v109, v113
  v_add_f32 v102, v102, v106
  v_add_f32 v110, v110, v114
  v_mfma_f32_32x32x16_bf16 v[192:207], v[156:159], v[132:135], v[192:207]
  v_add_f32 v103, v103, v107
  v_add_f32 v111, v111, v115
  v_add_f32 v100, v100, v108
  v_add_f32 v101, v101, v109
  v_add_f32 v102, v102, v110
  buffer_load_dwordx4 v[36:39], v244, s[44:47], s12 offen sc1
  ds_read_b64_tr_b16 v[68:69], v220 offset:49152
  ds_read_b64_tr_b16 v[70:71], v220 offset:50176
  ds_read_b64_tr_b16 v[72:73], v218 offset:49152
  ds_read_b64_tr_b16 v[74:75], v218 offset:50176
  buffer_load_dwordx4 v[40:43], v244, s[44:47], s14 offen sc1
  s_waitcnt vmcnt(8) lgkmcnt(6)
  v_mfma_f32_32x32x16_bf16 v[136:151], v[160:163], v[24:27], v[136:151]
  v_add_f32 v103, v103, v111
  v_add_f32 v100, v100, v188
  v_add_f32 v101, v101, v189
  v_add_f32 v102, v102, v190
  v_add_f32 v103, v103, v191
  s_waitcnt lgkmcnt(4)
  v_mfma_f32_32x32x16_bf16 v[192:207], v[164:167], v[24:27], v[192:207]
  v_lshlrev_b32 v104, 16, v82
  v_and_b32 v105, 0xffff0000, v82
  v_lshlrev_b32 v108, 16, v178
  v_and_b32 v109, 0xffff0000, v178
  v_lshlrev_b32 v106, 16, v83
  buffer_load_dwordx4 v[44:47], v244, s[44:47], s15 offen sc1
  ds_read_b64_tr_b16 v[152:153], v220 offset:57344
  ds_read_b64_tr_b16 v[154:155], v220 offset:58368
  ds_read_b64_tr_b16 v[156:157], v218 offset:57344
  ds_read_b64_tr_b16 v[158:159], v218 offset:58368
  buffer_load_dwordx4 v[48:51], v244, s[44:47], s16 offen sc1
  s_waitcnt vmcnt(9) lgkmcnt(6)
  v_mfma_f32_32x32x16_bf16 v[136:151], v[68:71], v[28:31], v[136:151]
  v_and_b32 v107, 0xffff0000, v83
  v_lshlrev_b32 v110, 16, v179
  v_and_b32 v111, 0xffff0000, v179
  s_waitcnt lgkmcnt(4)
  v_mfma_f32_32x32x16_bf16 v[192:207], v[72:75], v[28:31], v[192:207]
  s_add_u32 m0, s75, 57344
  s_lshl4_add_u32 s100, s17, s74
  buffer_load_dwordx4 v252, s[52:55], s100 offen lds
  s_waitcnt vmcnt(8)
  s_waitcnt vmcnt(7)
  s_waitcnt vmcnt(6)
  s_waitcnt vmcnt(5)
  s_waitcnt lgkmcnt(0)
  s_barrier
  ds_read_b64_tr_b16 v[160:161], v219
  ds_read_b64_tr_b16 v[162:163], v219 offset:1024
  ds_read_b64_tr_b16 v[164:165], v217
  ds_read_b64_tr_b16 v[166:167], v217 offset:1024
  s_add_u32 m0, s75, 8192
  s_lshl4_add_u32 s100, s30, s74
  buffer_load_dwordx4 v252, s[52:55], s100 offen lds
  v_mfma_f32_32x32x16_bf16 v[136:151], v[152:155], v[32:35], v[136:151]
  v_mfma_f32_32x32x16_bf16 v[192:207], v[156:159], v[32:35], v[192:207]
  s_add_u32 m0, s75, 16384
  s_lshl4_add_u32 s100, s31, s74
  buffer_load_dwordx4 v252, s[52:55], s100 offen lds
  ds_read_b64_tr_b16 v[68:69], v228
  ds_read_b64_tr_b16 v[70:71], v228 offset:1024
  ds_read_b64_tr_b16 v[72:73], v227
  ds_read_b64_tr_b16 v[74:75], v227 offset:1024
  s_add_u32 m0, s75, 24576
  s_lshl4_add_u32 s100, s89, s74
  buffer_load_dwordx4 v252, s[52:55], s100 offen lds
  s_waitcnt vmcnt(7) lgkmcnt(6)
  v_mfma_f32_32x32x16_bf16 v[136:151], v[160:163], v[36:39], v[136:151]
  s_waitcnt lgkmcnt(4)
  v_mfma_f32_32x32x16_bf16 v[192:207], v[164:167], v[36:39], v[192:207]
  buffer_load_dwordx4 v[52:55], v244, s[44:47], s17 offen sc1
  ds_read_b64_tr_b16 v[152:153], v228 offset:32768
  ds_read_b64_tr_b16 v[154:155], v228 offset:33792
  ds_read_b64_tr_b16 v[156:157], v227 offset:32768
  ds_read_b64_tr_b16 v[158:159], v227 offset:33792
  buffer_load_dwordx4 v[56:59], v244, s[44:47], s30 offen sc1
  s_waitcnt vmcnt(8) lgkmcnt(6)
  v_mfma_f32_32x32x16_bf16 v[136:151], v[68:71], v[40:43], v[136:151]
  s_waitcnt lgkmcnt(4)
  v_mfma_f32_32x32x16_bf16 v[192:207], v[72:75], v[40:43], v[192:207]
  buffer_load_dwordx4 v[60:63], v244, s[44:47], s31 offen sc1
  ds_read_b64_tr_b16 v[160:161], v228 offset:40960
  ds_read_b64_tr_b16 v[162:163], v228 offset:41984
  ds_read_b64_tr_b16 v[164:165], v227 offset:40960
  ds_read_b64_tr_b16 v[166:167], v227 offset:41984
  buffer_load_dwordx4 v[64:67], v244, s[44:47], s89 offen sc1
  s_waitcnt vmcnt(9) lgkmcnt(6)
  v_mfma_f32_32x32x16_bf16 v[136:151], v[152:155], v[44:47], v[136:151]
  s_waitcnt lgkmcnt(4)
  v_mfma_f32_32x32x16_bf16 v[192:207], v[156:159], v[44:47], v[192:207]
  s_add_u32 m0, s75, 49152
  s_lshl4_add_u32 s100, s90, s74
  buffer_load_dwordx4 v252, s[52:55], s100 offen lds
  s_waitcnt vmcnt(8)
  s_waitcnt vmcnt(7)
  s_waitcnt vmcnt(6)
  s_waitcnt vmcnt(5)
  s_waitcnt lgkmcnt(0)
  s_barrier
  ds_read_b64_tr_b16 v[68:69], v228 offset:57344
  ds_read_b64_tr_b16 v[70:71], v228 offset:58368
  ds_read_b64_tr_b16 v[72:73], v227 offset:57344
  ds_read_b64_tr_b16 v[74:75], v227 offset:58368
  s_add_u32 m0, s75, 0
  s_lshl4_add_u32 s100, s91, s74
  buffer_load_dwordx4 v252, s[52:55], s100 offen lds
  v_mfma_f32_32x32x16_bf16 v[136:151], v[160:163], v[48:51], v[136:151]
  v_mfma_f32_32x32x16_bf16 v[192:207], v[164:167], v[48:51], v[192:207]
  s_add_u32 m0, s75, 32768
  s_lshl4_add_u32 s100, s87, s74
  buffer_load_dwordx4 v252, s[52:55], s100 offen lds
  ds_read_b64_tr_b16 v[152:153], v228 offset:8192
  ds_read_b64_tr_b16 v[154:155], v228 offset:9216
  ds_read_b64_tr_b16 v[156:157], v227 offset:8192
  ds_read_b64_tr_b16 v[158:159], v227 offset:9216
  s_add_u32 m0, s75, 40960
  s_lshl4_add_u32 s100, s82, s74
  buffer_load_dwordx4 v252, s[52:55], s100 offen lds
  s_waitcnt vmcnt(7) lgkmcnt(6)
  v_mfma_f32_32x32x16_bf16 v[136:151], v[68:71], v[52:55], v[136:151]
  s_waitcnt lgkmcnt(4)
  v_mfma_f32_32x32x16_bf16 v[192:207], v[72:75], v[52:55], v[192:207]
  buffer_load_dwordx4 v[76:79], v244, s[44:47], s90 offen sc1
  ds_read_b64_tr_b16 v[160:161], v228 offset:16384
  ds_read_b64_tr_b16 v[162:163], v228 offset:17408
  ds_read_b64_tr_b16 v[164:165], v227 offset:16384
  ds_read_b64_tr_b16 v[166:167], v227 offset:17408
  buffer_load_dwordx4 v[116:119], v244, s[44:47], s91 offen sc1
  s_waitcnt vmcnt(8) lgkmcnt(6)
  v_mfma_f32_32x32x16_bf16 v[136:151], v[152:155], v[56:59], v[136:151]
  s_waitcnt lgkmcnt(4)
  v_mfma_f32_32x32x16_bf16 v[192:207], v[156:159], v[56:59], v[192:207]
  buffer_load_dwordx4 v[168:171], v244, s[44:47], s87 offen sc1
  ds_read_b64_tr_b16 v[68:69], v228 offset:24576
  ds_read_b64_tr_b16 v[70:71], v228 offset:25600
  ds_read_b64_tr_b16 v[72:73], v227 offset:24576
  ds_read_b64_tr_b16 v[74:75], v227 offset:25600
  buffer_load_dwordx4 v[172:175], v244, s[44:47], s82 offen sc1
  s_waitcnt vmcnt(9) lgkmcnt(6)
  v_mfma_f32_32x32x16_bf16 v[136:151], v[160:163], v[60:63], v[136:151]
  s_waitcnt lgkmcnt(4)
  v_mfma_f32_32x32x16_bf16 v[192:207], v[164:167], v[60:63], v[192:207]
  s_waitcnt vmcnt(7)
  s_waitcnt vmcnt(6)
  s_waitcnt vmcnt(5)
  s_waitcnt vmcnt(4)
  s_waitcnt lgkmcnt(0)
  s_barrier
  ds_read_b64_tr_b16 v[152:153], v228 offset:49152
  ds_read_b64_tr_b16 v[154:155], v228 offset:50176
  ds_read_b64_tr_b16 v[156:157], v227 offset:49152
  ds_read_b64_tr_b16 v[158:159], v227 offset:50176
  v_mfma_f32_32x32x16_bf16 v[136:151], v[68:71], v[64:67], v[136:151]
  v_mfma_f32_32x32x16_bf16 v[192:207], v[72:75], v[64:67], v[192:207]
  s_mov_b32 s92, 8192
  s_cmp_eq_u32 s83, 1
  s_cselect_b32 s92, 16384, s92
  s_cmp_eq_u32 s83, 2
  s_cselect_b32 s92, 24576, s92
  ds_read_b64_tr_b16 v[160:161], v228
  ds_read_b64_tr_b16 v[162:163], v228 offset:1024
  ds_read_b64_tr_b16 v[164:165], v227
  ds_read_b64_tr_b16 v[166:167], v227 offset:1024
  s_waitcnt vmcnt(3) lgkmcnt(6)
  v_mfma_f32_32x32x16_bf16 v[136:151], v[152:155], v[76:79], v[136:151]
  s_cmp_eq_u32 s83, 3
  s_cselect_b32 s92, 57344, s92
  v_add_u32 v180, s92, v226
  v_xor_b32 v181, 32, v180
  v_xor_b32 v182, 64, v180
  s_waitcnt lgkmcnt(4)
  v_mfma_f32_32x32x16_bf16 v[192:207], v[156:159], v[76:79], v[192:207]
  v_xor_b32 v183, 96, v180
  s_mov_b32 s92, 65536
  s_cmp_eq_u32 s83, 1
  s_cselect_b32 s92, 73728, s92
  s_cmp_eq_u32 s83, 2
  s_cselect_b32 s92, 81920, s92
  ds_read_b64_tr_b16 v[68:69], v228 offset:32768
  ds_read_b64_tr_b16 v[70:71], v228 offset:33792
  ds_read_b64_tr_b16 v[72:73], v227 offset:32768
  ds_read_b64_tr_b16 v[74:75], v227 offset:33792
  s_waitcnt vmcnt(2) lgkmcnt(6)
  v_mfma_f32_32x32x16_bf16 v[136:151], v[160:163], v[116:119], v[136:151]
  s_cmp_eq_u32 s83, 3
  s_cselect_b32 s92, 90112, s92
  v_add_u32 v208, s92, v226
  v_xor_b32 v209, 32, v208
  v_xor_b32 v210, 64, v208
  s_waitcnt lgkmcnt(4)
  v_mfma_f32_32x32x16_bf16 v[192:207], v[164:167], v[116:119], v[192:207]
  v_xor_b32 v211, 96, v208
  ds_read_b64_tr_b16 v[152:153], v228 offset:40960
  ds_read_b64_tr_b16 v[154:155], v228 offset:41984
  ds_read_b64_tr_b16 v[156:157], v227 offset:40960
  ds_read_b64_tr_b16 v[158:159], v227 offset:41984
  s_waitcnt vmcnt(1) lgkmcnt(6)
  v_mfma_f32_32x32x16_bf16 v[136:151], v[68:71], v[168:171], v[136:151]
  s_waitcnt lgkmcnt(4)
  v_mfma_f32_32x32x16_bf16 v[192:207], v[72:75], v[168:171], v[192:207]
  s_waitcnt vmcnt(0) lgkmcnt(2)
  v_mfma_f32_32x32x16_bf16 v[136:151], v[152:155], v[172:175], v[136:151]
  s_waitcnt lgkmcnt(0)
  v_mfma_f32_32x32x16_bf16 v[192:207], v[156:159], v[172:175], v[192:207]
  s_nop 9
  ds_write_b128 v180, v[136:139]
  ds_write_b128 v181, v[140:143]
  ds_write_b128 v182, v[144:147]
  ds_write_b128 v183, v[148:151]
  ds_write_b128 v208, v[192:195]
  ds_write_b128 v209, v[196:199]
  ds_write_b128 v210, v[200:203]
  ds_write_b128 v211, v[204:207]
  s_waitcnt lgkmcnt(0)
  s_barrier
  ds_read_b128 v[136:139], v225 offset:8192
  ds_read_b128 v[140:143], v225 offset:16384
  ds_read_b128 v[144:147], v225 offset:24576
  ds_read_b128 v[148:151], v225 offset:57344
  s_waitcnt lgkmcnt(2)
  v_add_f32 v136, v136, v140
  s_waitcnt lgkmcnt(0)
  v_add_f32 v144, v144, v148
  v_add_f32 v137, v137, v141
  v_add_f32 v145, v145, v149
  v_add_f32 v138, v138, v142
  v_add_f32 v146, v146, v150
  v_add_f32 v139, v139, v143
  v_add_f32 v147, v147, v151
  v_add_f32 v136, v136, v144
  v_add_f32 v137, v137, v145
  v_add_f32 v138, v138, v146
  v_add_f32 v139, v139, v147
  ds_read_b128 v[192:195], v216
  ds_read_b128 v[196:199], v216 offset:8192
  ds_read_b128 v[200:203], v216 offset:16384
  ds_read_b128 v[204:207], v216 offset:24576
  s_waitcnt lgkmcnt(2)
  v_add_f32 v192, v192, v196
  s_waitcnt lgkmcnt(0)
  v_add_f32 v200, v200, v204
  v_add_f32 v193, v193, v197
  v_add_f32 v201, v201, v205
  v_add_f32 v194, v194, v198
  v_add_f32 v202, v202, v206
  v_add_f32 v195, v195, v199
  v_add_f32 v203, v203, v207
  v_add_f32 v192, v192, v200
  v_add_f32 v193, v193, v201
  v_add_f32 v194, v194, v202
  v_add_f32 v195, v195, v203
  v_add_f32 v136, v136, v92
  v_add_f32 v137, v137, v93
  v_add_f32 v138, v138, v94
  v_add_f32 v139, v139, v95
  v_mul_f32 v140, 0xbfb8aa3b, v136
  v_mul_f32 v141, 0xbfb8aa3b, v137
  v_mul_f32 v142, 0xbfb8aa3b, v138
  v_mul_f32 v143, 0xbfb8aa3b, v139
  v_exp_f32 v140, v140
  v_exp_f32 v141, v141
  v_exp_f32 v142, v142
  v_exp_f32 v143, v143
  v_mul_f32 v136, v136, v84
  v_mul_f32 v137, v137, v85
  v_mul_f32 v138, v138, v86
  v_mul_f32 v139, v139, v87
  v_add_f32 v140, 1.0, v140
  v_add_f32 v141, 1.0, v141
  v_add_f32 v142, 1.0, v142
  v_add_f32 v143, 1.0, v143
  v_rcp_f32 v140, v140
  v_rcp_f32 v141, v141
  v_rcp_f32 v142, v142
  v_rcp_f32 v143, v143
  v_fma_f32 v140, v136, v140, v88
  v_fma_f32 v141, v137, v141, v89
  v_fma_f32 v142, v138, v142, v90
  v_fma_f32 v143, v139, v143, v91
  buffer_store_dwordx4 v[140:143], v212, s[64:67], s88 offen offset:0 sc0 sc1 nt
  v_add_f32 v192, v192, v108
  v_add_f32 v193, v193, v109
  v_add_f32 v194, v194, v110
  v_add_f32 v195, v195, v111
  v_mul_f32 v196, 0xbfb8aa3b, v192
  v_mul_f32 v197, 0xbfb8aa3b, v193
  v_mul_f32 v198, 0xbfb8aa3b, v194
  v_mul_f32 v199, 0xbfb8aa3b, v195
  v_exp_f32 v196, v196
  v_exp_f32 v197, v197
  v_exp_f32 v198, v198
  v_exp_f32 v199, v199
  v_mul_f32 v192, v192, v100
  v_mul_f32 v193, v193, v101
  v_mul_f32 v194, v194, v102
  v_mul_f32 v195, v195, v103
  v_add_f32 v196, 1.0, v196
  v_add_f32 v197, 1.0, v197
  v_add_f32 v198, 1.0, v198
  v_add_f32 v199, 1.0, v199
  v_rcp_f32 v196, v196
  v_rcp_f32 v197, v197
  v_rcp_f32 v198, v198
  v_rcp_f32 v199, v199
  v_fma_f32 v196, v192, v196, v104
  v_fma_f32 v197, v193, v197, v105
  v_fma_f32 v198, v194, v198, v106
  v_fma_f32 v199, v195, v199, v107
  buffer_store_dwordx4 v[196:199], v212, s[64:67], s88 offen offset:128 sc0 sc1 nt
  s_endpgm
L_pathS3:
  v_and_b32 v244, 31, v1
  v_lshrrev_b32 v243, 5, v1
  s_lshl_b32 s92, s84, 6
  s_add_u32 s92, s92, s79
  v_lshlrev_b32 v242, 1, v244
  s_mov_b32 s64, s6
  s_mov_b32 s65, s7
  s_mov_b32 s66, 1024
  s_mov_b32 s67, 0x00020000
  buffer_load_ushort v240, v242, s[64:67], s92 offen
  s_mov_b32 s64, s8
  s_mov_b32 s65, s9
  s_mov_b32 s66, 1024
  s_mov_b32 s67, 0x00020000
  buffer_load_ushort v239, v242, s[64:67], s92 offen
  s_mov_b32 s64, s18
  s_mov_b32 s65, s19
  s_mov_b32 s66, 1024
  s_mov_b32 s67, 0x00020000
  buffer_load_ushort v238, v242, s[64:67], s92 offen
  s_mov_b32 s76, 0x3b000000
  s_mov_b32 s77, 0xbdd2d3e8
  s_mov_b32 s78, 0x3f803f80
  s_lshl_b32 s81, s68, 12
  s_add_u32 s81, s81, 17825792
  s_getreg_b32 s82, hwreg(HW_REG_XCC_ID)
  s_and_b32 s82, s82, 7
  s_min_u32 s85, s69, 13
  s_lshl_b32 s85, s85, 8
  v_lshlrev_b32 v235, 2, v1
  v_lshlrev_b32 v234, 4, v1
  s_lshr_b32 s92, s2, 5
  s_and_b32 s92, s92, 4
  s_and_b32 s93, s2, 7
  s_xor_b32 s92, s92, s93
  s_lshr_b32 s23, s92, 2
  s_xor_b32 s23, s23, s84
  s_lshr_b32 s93, s69, 2
  s_xor_b32 s34, s92, s93
  s_and_b32 s93, s69, 3
  s_xor_b32 s35, s93, s83
  s_and_b32 s93, s34, 3
  s_lshl_b32 s93, s93, 2
  s_or_b32 s35, s35, s93
  v_bfe_u32 v237, v250, 1, 1
  v_lshlrev_b32 v237, 2, v237
  v_bfe_u32 v236, v250, 2, 1
  v_lshl_add_u32 v237, v236, 1, v237
  v_xor_b32 v237, v237, v249
  v_lshlrev_b32 v237, 4, v237
  v_lshl_add_u32 v252, v248, 10, v237
  v_mul_u32_u24 v236, 3584, v248
  v_add_u32 v232, v236, v237
  s_mov_b32 s60, s28
  s_mov_b32 s61, s29
  s_mov_b32 s62, 1835008
  s_mov_b32 s63, 0x00020000
  v_lshrrev_b32 v242, 2, v244
  v_and_b32 v242, 1, v242
  v_lshlrev_b32 v242, 4, v242
  v_lshrrev_b32 v241, 3, v244
  v_lshl_add_u32 v242, v241, 2, v242
  v_and_b32 v241, 3, v244
  v_add_u32 v242, v242, v241
  v_bfe_u32 v241, v242, 1, 3
  v_xor_b32 v241, v241, v243
  v_lshlrev_b32 v241, 4, v241
  v_lshl_add_u32 v250, v242, 7, v241
  s_lshl_b32 s92, s83, 12
  v_add_u32 v250, s92, v250
  v_bfe_u32 v241, v244, 1, 3
  v_xor_b32 v241, v241, v243
  v_lshlrev_b32 v241, 4, v241
  v_lshl_add_u32 v236, v244, 7, v241
  s_lshl_b32 s92, s84, 12
  v_add_u32 v236, s92, v236
  s_lshl_b32 s92, s83, 5
  v_xor_b32 v250, s92, v250
  v_xor_b32 v236, s92, v236
  v_xor_b32 v249, 32, v250
  v_xor_b32 v231, 32, v236
  v_xor_b32 v248, 64, v250
  v_xor_b32 v230, 64, v236
  v_xor_b32 v237, 96, v250
  v_xor_b32 v229, 96, v236
  v_add_u32 v228, 65536, v250
  v_add_u32 v227, 131072, v250
  v_add_u32 v226, 65536, v249
  v_add_u32 v225, 131072, v249
  v_add_u32 v224, 65536, v248
  v_add_u32 v223, 131072, v248
  v_add_u32 v222, 65536, v237
  v_add_u32 v221, 131072, v237
  v_add_u32 v220, 65536, v236
  v_add_u32 v219, 131072, v236
  v_add_u32 v218, 65536, v231
  v_add_u32 v217, 131072, v231
  v_add_u32 v216, 65536, v230
  v_add_u32 v215, 131072, v230
  v_add_u32 v214, 65536, v229
  v_add_u32 v213, 131072, v229
  v_lshrrev_b32 v212, 4, v1
  v_xor_b32 v212, v212, v1
  v_and_b32 v212, 1, v212
  v_cmp_eq_u32 vcc, 0, v212
  v_mov_b32 v212, s78
  s_nop 0
  v_cndmask_b32 v8, 0, v212, vcc
  v_cndmask_b32 v9, 0, v212, vcc
  v_cndmask_b32 v10, 0, v212, vcc
  v_cndmask_b32 v11, 0, v212, vcc
  v_mov_b32 v212, 0
  v_mov_b32 v211, 0
  s_waitcnt vmcnt(8)
  v_dot2c_f32_bf16 v212, s78, v4
  v_dot2c_f32_bf16 v211, v4, v4
  v_dot2c_f32_bf16 v212, s78, v5
  v_dot2c_f32_bf16 v211, v5, v5
  v_dot2c_f32_bf16 v212, s78, v6
  v_dot2c_f32_bf16 v211, v6, v6
  v_dot2c_f32_bf16 v212, s78, v7
  v_dot2c_f32_bf16 v211, v7, v7
  s_nop 1
  v_add_f32_dpp v212, v212, v212 quad_perm:[1,0,3,2] row_mask:0xf bank_mask:0xf
  v_add_f32_dpp v211, v211, v211 quad_perm:[1,0,3,2] row_mask:0xf bank_mask:0xf
  s_nop 0
  v_add_f32_dpp v212, v212, v212 quad_perm:[2,3,0,1] row_mask:0xf bank_mask:0xf
  v_add_f32_dpp v211, v211, v211 quad_perm:[2,3,0,1] row_mask:0xf bank_mask:0xf
  s_nop 0
  v_add_f32_dpp v212, v212, v212 row_half_mirror row_mask:0xf bank_mask:0xf
  v_add_f32_dpp v211, v211, v211 row_half_mirror row_mask:0xf bank_mask:0xf
  s_nop 0
  v_add_f32_dpp v212, v212, v212 row_mirror row_mask:0xf bank_mask:0xf
  v_add_f32_dpp v211, v211, v211 row_mirror row_mask:0xf bank_mask:0xf
  v_mov_b32 v12, v212
  v_mov_b32 v13, v211
  s_nop 0
  v_permlane16_swap_b32 v212, v12
  v_permlane16_swap_b32 v211, v13
  v_add_f32 v212, v212, v12
  v_add_f32 v211, v211, v13
  v_mov_b32 v12, v212
  v_mov_b32 v13, v211
  s_nop 0
  v_permlane32_swap_b32 v212, v12
  v_permlane32_swap_b32 v211, v13
  v_add_f32 v212, v212, v12
  v_add_f32 v211, v211, v13
  v_mul_f32 v12, 0x3b000000, v212
  v_mul_f32 v19, v12, v12
  v_fma_f32 v13, v211, s76, -v19
  v_max_f32 v13, 0, v13
  v_cvt_pk_bf16_f32 v14, v12, v12
  v_and_b32 v14, 0xffff0000, v14
  v_cvt_pk_bf16_f32 v19, v13, v13
  v_and_b32 v19, 0xffff0000, v19
  v_add_f32 v19, 0x3727c5ac, v19
  v_cvt_pk_bf16_f32 v19, v19, v19
  v_and_b32 v19, 0xffff0000, v19
  v_sqrt_f32 v19, v19
  s_nop 0
  v_cvt_pk_bf16_f32 v15, v19, v19
  v_and_b32 v15, 0xffff0000, v15
  v_rcp_f32 v16, v15
  v_sub_f32 v19, v12, v14
  v_mul_f32 v17, v19, v16
  v_mul_f32 v19, v13, v16
  v_mul_f32 v19, v19, v16
  v_cvt_pk_bf16_f32 v19, v19, v19
  v_and_b32 v19, 0xffff0000, v19
  v_add_f32 v19, 0x3727c5ac, v19
  v_cvt_pk_bf16_f32 v19, v19, v19
  v_and_b32 v19, 0xffff0000, v19
  v_sqrt_f32 v18, v19
  v_cvt_pk_bf16_f32 v20, v14, v15
  v_cvt_pk_bf16_f32 v22, v17, v18
  s_waitcnt vmcnt(7)
  v_readfirstlane_b32 s72, v251
  s_add_u32 s72, s72, 1
  s_lshl_b32 s92, s82, 29
  s_xor_b32 s92, s92, s72
  v_mov_b32 v21, s72
  v_mov_b32 v23, s92
  v_mov_b32 v233, s72
  s_lshl_b32 s92, s89, 4
  s_add_u32 s92, s92, 17563648
  s_mov_b64 exec, 1
  buffer_store_dwordx4 v[20:23], off, s[44:47], s92 sc1
  s_mov_b64 exec, -1
  s_add_u32 m0, s75, 106496
  s_add_u32 s100, s22, 128
  s_and_b32 s100, s100, 0x380
  buffer_load_dwordx4 v247, s[40:43], s100 offen lds
  s_add_u32 m0, s75, 114688
  s_add_u32 s100, s22, 128
  s_and_b32 s100, s100, 0x380
  buffer_load_dwordx4 v246, s[40:43], s100 offen lds
  s_add_u32 m0, s75, 122880
  s_add_u32 s100, s22, 128
  s_and_b32 s100, s100, 0x380
  s_add_u32 s100, s100, s86
  buffer_load_dwordx4 v253, s[48:51], s100 offen lds
  s_add_u32 m0, s75, 131072
  s_add_u32 s100, s22, 128
  s_and_b32 s100, s100, 0x380
  s_add_u32 s100, s100, s86
  buffer_load_dwordx4 v253, s[52:55], s100 offen lds
  s_mov_b32 s4, 0
  s_mov_b32 s5, -1
  s_bitcmp1_b32 s83, 0
  s_cselect_b64 s[6:7], -1, 0
  s_bitcmp1_b32 s83, 1
  s_cselect_b64 s[8:9], -1, 0
  s_waitcnt vmcnt(8)
  s_waitcnt lgkmcnt(0)
  s_barrier
  ds_read_b128 v[48:51], v228 offset:8192
  ds_read_b128 v[60:63], v220 offset:24576
  ds_read_b128 v[72:75], v220 offset:32768
  s_add_u32 m0, s75, 139264
  s_add_u32 s100, s22, 256
  s_and_b32 s100, s100, 0x380
  buffer_load_dwordx4 v247, s[40:43], s100 offen lds
  s_add_u32 m0, s75, 147456
  s_add_u32 s100, s22, 256
  s_and_b32 s100, s100, 0x380
  buffer_load_dwordx4 v246, s[40:43], s100 offen lds
  ds_read_b128 v[52:55], v226 offset:8192
  ds_read_b128 v[64:67], v218 offset:24576
  ds_read_b128 v[76:79], v218 offset:32768
  s_waitcnt lgkmcnt(4)
  v_mfma_f32_32x32x16_bf16 v[12:27], v[48:51], v[60:63], 0
  s_waitcnt vmcnt(9)
  v_lshlrev_b32 v240, 16, v240
  s_waitcnt vmcnt(8)
  v_lshlrev_b32 v239, 16, v239
  s_waitcnt vmcnt(7)
  v_lshlrev_b32 v238, 16, v238
  s_waitcnt lgkmcnt(3)
  v_mfma_f32_32x32x16_bf16 v[28:43], v[48:51], v[72:75], 0
  v_mul_f32 v209, 0x3fb8aa3b, v238
  v_exp_f32 v209, v209
  v_mfma_f32_16x16x32_bf16 v[4:7], v[60:63], v[8:11], 0
  v_cvt_pk_bf16_f32 v209, v209, v209
  v_and_b32 v209, 0xffff0000, v209
  v_mul_f32 v208, v209, v240
  v_mfma_f32_16x16x32_bf16 v[44:47], v[72:75], v[8:11], 0
  v_mul_f32 v208, 0x3fb8aa3b, v208
  v_exp_f32 v208, v208
  s_add_u32 m0, s75, 0
  s_add_u32 s100, s22, 256
  s_and_b32 s100, s100, 0x380
  s_add_u32 s100, s100, s86
  buffer_load_dwordx4 v253, s[48:51], s100 offen lds
  s_add_u32 m0, s75, 8192
  s_add_u32 s100, s22, 256
  s_and_b32 s100, s100, 0x380
  s_add_u32 s100, s100, s86
  buffer_load_dwordx4 v253, s[52:55], s100 offen lds
  ds_read_b128 v[56:59], v224 offset:8192
  ds_read_b128 v[68:71], v216 offset:24576
  ds_read_b128 v[80:83], v216 offset:32768
  s_waitcnt lgkmcnt(4)
  v_mfma_f32_32x32x16_bf16 v[12:27], v[52:55], v[64:67], v[12:27]
  v_mul_f32 v207, v209, v239
  v_mul_f32 v207, 0x3e22f983, v207
  v_cos_f32 v251, v207
  s_waitcnt lgkmcnt(3)
  v_mfma_f32_32x32x16_bf16 v[28:43], v[52:55], v[76:79], v[28:43]
  v_sin_f32 v212, v207
  v_mul_f32 v251, v251, v208
  s_add_u32 m0, s75, 16384
  s_add_u32 s100, s22, 384
  s_and_b32 s100, s100, 0x380
  buffer_load_dwordx4 v247, s[40:43], s100 offen lds
  ds_read_b128 v[48:51], v222 offset:8192
  ds_read_b128 v[60:63], v214 offset:24576
  ds_read_b128 v[72:75], v214 offset:32768
  s_waitcnt lgkmcnt(4)
  v_mfma_f32_32x32x16_bf16 v[12:27], v[56:59], v[68:71], v[12:27]
  v_mul_f32 v212, v212, v208
  v_mul_f32 v208, v240, v240
  v_fma_f32 v208, v239, v239, v208
  s_waitcnt lgkmcnt(3)
  v_mfma_f32_32x32x16_bf16 v[28:43], v[56:59], v[80:83], v[28:43]
  v_rcp_f32 v208, v208
  v_add_f32 v207, -1.0, v251
  s_add_u32 m0, s75, 24576
  s_add_u32 s100, s22, 384
  s_and_b32 s100, s100, 0x380
  buffer_load_dwordx4 v246, s[40:43], s100 offen lds
  s_waitcnt vmcnt(6)
  s_waitcnt lgkmcnt(0)
  s_barrier
  ds_read_b128 v[52:55], v228 offset:40960
  ds_read_b128 v[64:67], v220 offset:57344
  ds_read_b128 v[76:79], v219
  v_mfma_f32_32x32x16_bf16 v[12:27], v[48:51], v[60:63], v[12:27]
  v_mul_f32 v211, v207, v240
  v_fma_f32 v211, v212, v239, v211
  v_mul_f32 v210, v212, v240
  v_mfma_f32_32x32x16_bf16 v[28:43], v[48:51], v[72:75], v[28:43]
  v_fma_f32 v210, -v207, v239, v210
  v_add_f32 v208, v208, v208
  v_mul_f32 v211, v211, v208
  s_add_u32 m0, s75, 32768
  s_add_u32 s100, s22, 384
  s_and_b32 s100, s100, 0x380
  s_add_u32 s100, s100, s86
  buffer_load_dwordx4 v253, s[48:51], s100 offen lds
  s_add_u32 m0, s75, 40960
  s_add_u32 s100, s22, 384
  s_and_b32 s100, s100, 0x380
  s_add_u32 s100, s100, s86
  buffer_load_dwordx4 v253, s[52:55], s100 offen lds
  ds_read_b128 v[56:59], v226 offset:40960
  ds_read_b128 v[68:71], v218 offset:57344
  ds_read_b128 v[80:83], v217
  s_waitcnt lgkmcnt(4)
  v_mfma_f32_32x32x16_bf16 v[12:27], v[52:55], v[64:67], v[12:27]
  v_mul_f32 v210, v210, v208
  v_mul_f32 v2, v212, v212
  v_mul_f32 v3, v251, v212
  s_waitcnt lgkmcnt(3)
  v_mfma_f32_32x32x16_bf16 v[28:43], v[52:55], v[76:79], v[28:43]
  v_fma_f32 v2, v251, v251, -v2
  v_add_f32 v3, v3, v3
  v_mul_f32 v84, v3, v3
  v_mfma_f32_16x16x32_bf16 v[4:7], v[64:67], v[8:11], v[4:7]
  v_mul_f32 v85, v2, v3
  v_fma_f32 v84, v2, v2, -v84
  v_add_f32 v85, v85, v85
  v_mfma_f32_16x16x32_bf16 v[44:47], v[76:79], v[8:11], v[44:47]
  v_mul_f32 v2, v85, v85
  v_mul_f32 v3, v84, v85
  v_fma_f32 v2, v84, v84, -v2
  s_add_u32 m0, s75, 73728
  s_add_u32 s100, s22, 512
  s_and_b32 s100, s100, 0x380
  buffer_load_dwordx4 v247, s[40:43], s100 offen lds
  ds_read_b128 v[48:51], v224 offset:40960
  ds_read_b128 v[60:63], v216 offset:57344
  ds_read_b128 v[72:75], v215
  s_waitcnt lgkmcnt(4)
  v_mfma_f32_32x32x16_bf16 v[12:27], v[56:59], v[68:71], v[12:27]
  v_add_f32 v3, v3, v3
  v_mul_f32 v86, v3, v3
  v_mul_f32 v87, v2, v3
  s_waitcnt lgkmcnt(3)
  v_mfma_f32_32x32x16_bf16 v[28:43], v[56:59], v[80:83], v[28:43]
  v_fma_f32 v86, v2, v2, -v86
  v_add_f32 v87, v87, v87
  v_cndmask_b32 v90, 1.0, v86, s[4:5]
  s_add_u32 m0, s75, 81920
  s_add_u32 s100, s22, 512
  s_and_b32 s100, s100, 0x380
  buffer_load_dwordx4 v246, s[40:43], s100 offen lds
  ds_read_b128 v[52:55], v222 offset:40960
  ds_read_b128 v[64:67], v214 offset:57344
  ds_read_b128 v[76:79], v213
  s_waitcnt lgkmcnt(4)
  v_mfma_f32_32x32x16_bf16 v[12:27], v[48:51], v[60:63], v[12:27]
  v_cndmask_b32 v91, 0, v87, s[4:5]
  v_mul_f32 v2, v87, v87
  v_mul_f32 v3, v86, v87
  s_waitcnt lgkmcnt(3)
  v_mfma_f32_32x32x16_bf16 v[28:43], v[48:51], v[72:75], v[28:43]
  v_fma_f32 v2, v86, v86, -v2
  v_add_f32 v3, v3, v3
  v_mul_f32 v208, v90, v2
  s_add_u32 m0, s75, 90112
  s_add_u32 s100, s22, 512
  s_and_b32 s100, s100, 0x380
  s_add_u32 s100, s100, s86
  buffer_load_dwordx4 v253, s[48:51], s100 offen lds
  s_sub_u32 s92, s70, 4
  s_lshl_b32 s92, s92, 7
  s_lshl_b32 s93, s68, 3
  s_add_u32 s92, s92, s93
  s_add_u32 s92, s92, s74
  s_cmp_ge_u32 s92, 288
  s_cbranch_scc1 L_w2m_S3_2001
  s_mov_b32 s64, s28
  s_mov_b32 s65, s29
  s_mov_b32 s66, 1835008
  s_mov_b32 s94, 0
  s_cmp_ge_u32 s92, 224
  s_cselect_b32 s64, s26, s64
  s_cselect_b32 s65, s27, s65
  s_cselect_b32 s66, 524288, s66
  s_cselect_b32 s94, 224, s94
  s_mov_b32 s67, 0x00020000
  s_sub_u32 s94, s92, s94
  s_lshl_b32 s94, s94, 13
  v_lshlrev_b32 v205, 7, v1
  buffer_load_dword v206, v205, s[64:67], s94 offen
  s_nop 1
L_w2m_S3_2001:
  s_waitcnt vmcnt(7)
  s_waitcnt lgkmcnt(0)
  s_barrier
  ds_read_b128 v[56:59], v227 offset:8192
  ds_read_b128 v[68:71], v236
  ds_read_b128 v[80:83], v236 offset:8192
  v_mfma_f32_32x32x16_bf16 v[12:27], v[52:55], v[64:67], v[12:27]
  v_mul_f32 v207, v90, v3
  v_fma_f32 v208, -v91, v3, v208
  v_fma_f32 v207, v91, v2, v207
  v_mfma_f32_32x32x16_bf16 v[28:43], v[52:55], v[76:79], v[28:43]
  v_cndmask_b32 v90, v90, v208, s[6:7]
  v_cndmask_b32 v91, v91, v207, s[6:7]
  v_mul_f32 v84, v3, v3
  s_add_u32 m0, s75, 98304
  s_add_u32 s100, s22, 512
  s_and_b32 s100, s100, 0x380
  s_add_u32 s100, s100, s86
  buffer_load_dwordx4 v253, s[52:55], s100 offen lds
  ds_read_b128 v[48:51], v225 offset:8192
  ds_read_b128 v[60:63], v231
  ds_read_b128 v[72:75], v231 offset:8192
  s_waitcnt lgkmcnt(4)
  v_mfma_f32_32x32x16_bf16 v[12:27], v[56:59], v[68:71], v[12:27]
  v_mul_f32 v85, v2, v3
  v_fma_f32 v84, v2, v2, -v84
  v_add_f32 v85, v85, v85
  s_waitcnt lgkmcnt(3)
  v_mfma_f32_32x32x16_bf16 v[28:43], v[56:59], v[80:83], v[28:43]
  v_mul_f32 v208, v90, v84
  v_mul_f32 v207, v90, v85
  v_fma_f32 v208, -v91, v85, v208
  v_mfma_f32_16x16x32_bf16 v[4:7], v[68:71], v[8:11], v[4:7]
  v_fma_f32 v207, v91, v84, v207
  v_cndmask_b32 v90, v90, v208, s[8:9]
  v_cndmask_b32 v91, v91, v207, s[8:9]
  v_mfma_f32_16x16x32_bf16 v[44:47], v[80:83], v[8:11], v[44:47]
  v_mul_f32 v88, v85, v85
  v_mul_f32 v89, v84, v85
  v_fma_f32 v88, v84, v84, -v88
  s_add_u32 m0, s75, 106496
  s_add_u32 s100, s22, 640
  s_and_b32 s100, s100, 0x380
  buffer_load_dwordx4 v247, s[40:43], s100 offen lds
  ds_read_b128 v[52:55], v223 offset:8192
  ds_read_b128 v[64:67], v230
  ds_read_b128 v[76:79], v230 offset:8192
  s_waitcnt lgkmcnt(4)
  v_mfma_f32_32x32x16_bf16 v[12:27], v[48:51], v[60:63], v[12:27]
  v_add_f32 v89, v89, v89
  v_mul_f32 v94, v89, v89
  v_mul_f32 v95, v88, v89
  s_waitcnt lgkmcnt(3)
  v_mfma_f32_32x32x16_bf16 v[28:43], v[48:51], v[72:75], v[28:43]
  v_fma_f32 v94, v88, v88, -v94
  v_add_f32 v95, v95, v95
  v_cndmask_b32 v92, 1.0, v94, s[4:5]
  s_add_u32 m0, s75, 114688
  s_add_u32 s100, s22, 640
  s_and_b32 s100, s100, 0x380
  buffer_load_dwordx4 v246, s[40:43], s100 offen lds
  ds_read_b128 v[56:59], v221 offset:8192
  ds_read_b128 v[68:71], v229
  ds_read_b128 v[80:83], v229 offset:8192
  s_waitcnt lgkmcnt(4)
  v_mfma_f32_32x32x16_bf16 v[12:27], v[52:55], v[64:67], v[12:27]
  v_cndmask_b32 v93, 0, v95, s[4:5]
  v_mul_f32 v2, v95, v95
  v_mul_f32 v3, v94, v95
  s_waitcnt lgkmcnt(3)
  v_mfma_f32_32x32x16_bf16 v[28:43], v[52:55], v[76:79], v[28:43]
  v_fma_f32 v2, v94, v94, -v2
  v_add_f32 v3, v3, v3
  v_mul_f32 v208, v92, v2
  s_add_u32 m0, s75, 122880
  s_add_u32 s100, s22, 640
  s_and_b32 s100, s100, 0x380
  s_add_u32 s100, s100, s86
  buffer_load_dwordx4 v253, s[48:51], s100 offen lds
  s_waitcnt vmcnt(7)
  s_waitcnt lgkmcnt(0)
  s_barrier
  ds_read_b128 v[48:51], v250 offset:16384
  ds_read_b128 v[60:63], v236 offset:32768
  ds_read_b128 v[72:75], v236 offset:40960
  v_mfma_f32_32x32x16_bf16 v[12:27], v[56:59], v[68:71], v[12:27]
  v_mul_f32 v207, v92, v3
  v_fma_f32 v208, -v93, v3, v208
  v_fma_f32 v207, v93, v2, v207
  v_mfma_f32_32x32x16_bf16 v[28:43], v[56:59], v[80:83], v[28:43]
  v_cndmask_b32 v92, v92, v208, s[6:7]
  v_cndmask_b32 v93, v93, v207, s[6:7]
  v_mul_f32 v84, v3, v3
  s_add_u32 m0, s75, 131072
  s_add_u32 s100, s22, 640
  s_and_b32 s100, s100, 0x380
  s_add_u32 s100, s100, s86
  buffer_load_dwordx4 v253, s[52:55], s100 offen lds
  ds_read_b128 v[52:55], v249 offset:16384
  ds_read_b128 v[64:67], v231 offset:32768
  ds_read_b128 v[76:79], v231 offset:40960
  s_waitcnt lgkmcnt(4)
  v_mfma_f32_32x32x16_bf16 v[12:27], v[48:51], v[60:63], v[12:27]
  v_mul_f32 v85, v2, v3
  v_fma_f32 v84, v2, v2, -v84
  v_add_f32 v85, v85, v85
  s_waitcnt lgkmcnt(3)
  v_mfma_f32_32x32x16_bf16 v[28:43], v[48:51], v[72:75], v[28:43]
  v_mul_f32 v208, v92, v84
  v_mul_f32 v207, v92, v85
  v_fma_f32 v208, -v93, v85, v208
  v_mfma_f32_16x16x32_bf16 v[4:7], v[60:63], v[8:11], v[4:7]
  v_fma_f32 v207, v93, v84, v207
  v_cndmask_b32 v92, v92, v208, s[8:9]
  v_cndmask_b32 v93, v93, v207, s[8:9]
  v_mfma_f32_16x16x32_bf16 v[44:47], v[72:75], v[8:11], v[44:47]
  s_add_u32 m0, s75, 139264
  s_add_u32 s100, s22, 768
  s_and_b32 s100, s100, 0x380
  buffer_load_dwordx4 v247, s[40:43], s100 offen lds
  ds_read_b128 v[56:59], v248 offset:16384
  ds_read_b128 v[68:71], v230 offset:32768
  ds_read_b128 v[80:83], v230 offset:40960
  s_waitcnt lgkmcnt(4)
  v_mfma_f32_32x32x16_bf16 v[12:27], v[52:55], v[64:67], v[12:27]
  s_waitcnt lgkmcnt(3)
  v_mfma_f32_32x32x16_bf16 v[28:43], v[52:55], v[76:79], v[28:43]
  s_add_u32 m0, s75, 147456
  s_add_u32 s100, s22, 768
  s_and_b32 s100, s100, 0x380
  buffer_load_dwordx4 v246, s[40:43], s100 offen lds
  ds_read_b128 v[48:51], v237 offset:16384
  ds_read_b128 v[60:63], v229 offset:32768
  ds_read_b128 v[72:75], v229 offset:40960
  s_waitcnt lgkmcnt(4)
  v_mfma_f32_32x32x16_bf16 v[12:27], v[56:59], v[68:71], v[12:27]
  s_waitcnt lgkmcnt(3)
  v_mfma_f32_32x32x16_bf16 v[28:43], v[56:59], v[80:83], v[28:43]
  s_add_u32 m0, s75, 0
  s_add_u32 s100, s22, 768
  s_and_b32 s100, s100, 0x380
  s_add_u32 s100, s100, s86
  buffer_load_dwordx4 v253, s[48:51], s100 offen lds
  v_mov_b32 v205, 0
  s_cmp_lt_u32 s70, 5
  s_nop 4
  s_cbranch_scc1 L_si_S3_2002
  s_sub_u32 s92, s70, 5
  s_lshl_b32 s92, s92, 6
  v_add_u32 v204, s92, v1
  v_min_u32 v204, 131, v204
  s_sub_u32 s92, s71, 2
  v_add_u32 v203, s92, v204
  v_max_i32 v203, 0, v203
  v_min_i32 v203, 2047, v203
  v_lshlrev_b32 v205, 4, v203
  s_mov_b32 s92, 17563648
  buffer_load_dwordx4 v[128:131], v205, s[44:47], s92 offen sc1
  s_nop 0
L_si_S3_2002:
  s_waitcnt vmcnt(7)
  s_waitcnt lgkmcnt(0)
  s_barrier
  ds_read_b128 v[52:55], v228 offset:8192
  ds_read_b128 v[64:67], v220 offset:24576
  ds_read_b128 v[76:79], v220 offset:32768
  v_mfma_f32_32x32x16_bf16 v[12:27], v[48:51], v[60:63], v[12:27]
  v_mfma_f32_32x32x16_bf16 v[28:43], v[48:51], v[72:75], v[28:43]
  s_add_u32 m0, s75, 8192
  s_add_u32 s100, s22, 768
  s_and_b32 s100, s100, 0x380
  s_add_u32 s100, s100, s86
  buffer_load_dwordx4 v253, s[52:55], s100 offen lds
  ds_read_b128 v[56:59], v226 offset:8192
  ds_read_b128 v[68:71], v218 offset:24576
  ds_read_b128 v[80:83], v218 offset:32768
  s_waitcnt lgkmcnt(4)
  v_mfma_f32_32x32x16_bf16 v[12:27], v[52:55], v[64:67], v[12:27]
  s_waitcnt lgkmcnt(3)
  v_mfma_f32_32x32x16_bf16 v[28:43], v[52:55], v[76:79], v[28:43]
  v_mfma_f32_16x16x32_bf16 v[4:7], v[64:67], v[8:11], v[4:7]
  v_mfma_f32_16x16x32_bf16 v[44:47], v[76:79], v[8:11], v[44:47]
  s_add_u32 m0, s75, 16384
  s_add_u32 s100, s22, 896
  s_and_b32 s100, s100, 0x380
  buffer_load_dwordx4 v247, s[40:43], s100 offen lds
  ds_read_b128 v[48:51], v224 offset:8192
  ds_read_b128 v[60:63], v216 offset:24576
  ds_read_b128 v[72:75], v216 offset:32768
  s_waitcnt lgkmcnt(4)
  v_mfma_f32_32x32x16_bf16 v[12:27], v[56:59], v[68:71], v[12:27]
  s_waitcnt lgkmcnt(3)
  v_mfma_f32_32x32x16_bf16 v[28:43], v[56:59], v[80:83], v[28:43]
  s_add_u32 m0, s75, 24576
  s_add_u32 s100, s22, 896
  s_and_b32 s100, s100, 0x380
  buffer_load_dwordx4 v246, s[40:43], s100 offen lds
  ds_read_b128 v[52:55], v222 offset:8192
  ds_read_b128 v[64:67], v214 offset:24576
  ds_read_b128 v[76:79], v214 offset:32768
  s_waitcnt lgkmcnt(4)
  v_mfma_f32_32x32x16_bf16 v[12:27], v[48:51], v[60:63], v[12:27]
  s_waitcnt lgkmcnt(3)
  v_mfma_f32_32x32x16_bf16 v[28:43], v[48:51], v[72:75], v[28:43]
  s_add_u32 m0, s75, 32768
  s_add_u32 s100, s22, 896
  s_and_b32 s100, s100, 0x380
  s_add_u32 s100, s100, s86
  buffer_load_dwordx4 v253, s[48:51], s100 offen lds
  s_waitcnt vmcnt(7)
  s_waitcnt lgkmcnt(0)
  s_barrier
  ds_read_b128 v[56:59], v228 offset:40960
  ds_read_b128 v[68:71], v220 offset:57344
  ds_read_b128 v[80:83], v219
  v_mfma_f32_32x32x16_bf16 v[12:27], v[52:55], v[64:67], v[12:27]
  v_mfma_f32_32x32x16_bf16 v[28:43], v[52:55], v[76:79], v[28:43]
  s_add_u32 m0, s75, 40960
  s_add_u32 s100, s22, 896
  s_and_b32 s100, s100, 0x380
  s_add_u32 s100, s100, s86
  buffer_load_dwordx4 v253, s[52:55], s100 offen lds
  ds_read_b128 v[48:51], v226 offset:40960
  ds_read_b128 v[60:63], v218 offset:57344
  ds_read_b128 v[72:75], v217
  s_waitcnt lgkmcnt(4)
  v_mfma_f32_32x32x16_bf16 v[12:27], v[56:59], v[68:71], v[12:27]
  s_waitcnt lgkmcnt(3)
  v_mfma_f32_32x32x16_bf16 v[28:43], v[56:59], v[80:83], v[28:43]
  v_mfma_f32_16x16x32_bf16 v[4:7], v[68:71], v[8:11], v[4:7]
  v_mfma_f32_16x16x32_bf16 v[44:47], v[80:83], v[8:11], v[44:47]
  ds_read_b128 v[52:55], v224 offset:40960
  ds_read_b128 v[64:67], v216 offset:57344
  ds_read_b128 v[76:79], v215
  s_waitcnt lgkmcnt(4)
  v_mfma_f32_32x32x16_bf16 v[12:27], v[48:51], v[60:63], v[12:27]
  s_waitcnt lgkmcnt(3)
  v_mfma_f32_32x32x16_bf16 v[28:43], v[48:51], v[72:75], v[28:43]
  ds_read_b128 v[56:59], v222 offset:40960
  ds_read_b128 v[68:71], v214 offset:57344
  ds_read_b128 v[80:83], v213
  s_waitcnt lgkmcnt(4)
  v_mfma_f32_32x32x16_bf16 v[12:27], v[52:55], v[64:67], v[12:27]
  s_waitcnt lgkmcnt(3)
  v_mfma_f32_32x32x16_bf16 v[28:43], v[52:55], v[76:79], v[28:43]
  s_add_u32 m0, s75, 49152
  s_xor_b32 s100, s34, 0
  s_mul_i32 s100, s100, 229376
  s_add_u32 s100, s100, s85
  s_add_u32 s100, s100, 128
  buffer_load_dwordx4 v232, s[60:63], s100 offen lds
  s_add_u32 m0, s75, 57344
  s_xor_b32 s100, s34, 1
  s_mul_i32 s100, s100, 229376
  s_add_u32 s100, s100, s85
  s_add_u32 s100, s100, 128
  buffer_load_dwordx4 v232, s[60:63], s100 offen lds
  s_waitcnt vmcnt(6)
  s_waitcnt lgkmcnt(0)
  s_barrier
  ds_read_b128 v[48:51], v227 offset:8192
  ds_read_b128 v[60:63], v236
  ds_read_b128 v[72:75], v236 offset:8192
  v_mfma_f32_32x32x16_bf16 v[12:27], v[56:59], v[68:71], v[12:27]
  v_mfma_f32_32x32x16_bf16 v[28:43], v[56:59], v[80:83], v[28:43]
  ds_read_b128 v[52:55], v225 offset:8192
  ds_read_b128 v[64:67], v231
  ds_read_b128 v[76:79], v231 offset:8192
  s_waitcnt lgkmcnt(4)
  v_mfma_f32_32x32x16_bf16 v[12:27], v[48:51], v[60:63], v[12:27]
  s_waitcnt lgkmcnt(3)
  v_mfma_f32_32x32x16_bf16 v[28:43], v[48:51], v[72:75], v[28:43]
  v_mfma_f32_16x16x32_bf16 v[4:7], v[60:63], v[8:11], v[4:7]
  v_mfma_f32_16x16x32_bf16 v[44:47], v[72:75], v[8:11], v[44:47]
  ds_read_b128 v[56:59], v223 offset:8192
  ds_read_b128 v[68:71], v230
  ds_read_b128 v[80:83], v230 offset:8192
  s_waitcnt lgkmcnt(4)
  v_mfma_f32_32x32x16_bf16 v[12:27], v[52:55], v[64:67], v[12:27]
  s_waitcnt lgkmcnt(3)
  v_mfma_f32_32x32x16_bf16 v[28:43], v[52:55], v[76:79], v[28:43]
  ds_read_b128 v[48:51], v221 offset:8192
  ds_read_b128 v[60:63], v229
  ds_read_b128 v[72:75], v229 offset:8192
  s_waitcnt lgkmcnt(4)
  v_mfma_f32_32x32x16_bf16 v[12:27], v[56:59], v[68:71], v[12:27]
  s_waitcnt lgkmcnt(3)
  v_mfma_f32_32x32x16_bf16 v[28:43], v[56:59], v[80:83], v[28:43]
  s_add_u32 m0, s75, 65536
  s_xor_b32 s100, s34, 2
  s_mul_i32 s100, s100, 229376
  s_add_u32 s100, s100, s85
  s_add_u32 s100, s100, 128
  buffer_load_dwordx4 v232, s[60:63], s100 offen lds
  s_add_u32 m0, s75, 73728
  s_xor_b32 s100, s34, 3
  s_mul_i32 s100, s100, 229376
  s_add_u32 s100, s100, s85
  s_add_u32 s100, s100, 128
  buffer_load_dwordx4 v232, s[60:63], s100 offen lds
  s_cmp_lt_u32 s70, 5
  s_cbranch_scc1 L_sc_S3_2003
  v_mov_b32 v138, v129
  s_mov_b32 s93, 200000
  s_mov_b32 s92, 17563648
  s_nop 0
L_sl_S3_2004:
  v_xor_b32 v138, s72, v129
  v_xor_b32 v139, s72, v131
  v_lshlrev_b32 v136, 3, v139
  v_or_b32 v138, v138, v136
  v_cmp_ne_u32 vcc, 0, v138
  s_nop 4
  s_cbranch_vccz L_sd_S3_2005
  buffer_load_dwordx4 v[128:131], v205, s[44:47], s92 offen sc1
  s_waitcnt vmcnt(0)
  s_sub_u32 s93, s93, 1
  s_cmp_lg_u32 s93, 0
  s_cbranch_scc1 L_sl_S3_2004
L_sd_S3_2005:
  v_lshrrev_b32 v139, 29, v139
  v_subrev_u32 v138, 2, v204
  v_cmp_gt_u32 vcc, 128, v138
  v_cmp_ne_u32 s[94:95], s82, v139
  s_and_b64 vcc, vcc, s[94:95]
  s_cselect_b32 s94, 1, 0
  s_lshl_b32 s95, s70, 2
  s_add_u32 s95, s95, 162892
  v_mov_b32 v138, s94
  v_mov_b32 v139, s95
  ds_write_b32 v139, v138
  s_sub_u32 s92, s71, 2
  v_add_u32 v138, s92, v204
  v_cmp_gt_u32 vcc, 2048, v138
  s_nop 1
  v_cndmask_b32 v203, 0, 1.0, vcc
  v_lshlrev_b32 v132, 16, v128
  v_and_b32 v133, 0xffff0000, v128
  v_lshlrev_b32 v134, 16, v130
  v_and_b32 v135, 0xffff0000, v130
  v_rcp_f32 v136, v133
  v_rcp_f32 v137, v135
  v_mul_f32 v132, v132, v203
  v_mul_f32 v134, v134, v203
  v_mov_b32 v140, v136
  v_mul_f32 v141, v132, v136
  v_mul_f32 v142, v136, v137
  v_fma_f32 v138, v134, v133, v132
  v_mul_f32 v143, v138, v142
  v_mov_b32 v144, v132
  v_mov_b32 v145, v136
  v_lshlrev_b32 v139, 3, v204
  v_add_u32 v139, 155648, v139
  ds_write_b64 v139, v[140:141] offset:0
  ds_write_b64 v139, v[142:143] offset:1056
  ds_write_b64 v139, v[144:145] offset:2112
L_sc_S3_2003:
  s_waitcnt vmcnt(4)
  s_waitcnt lgkmcnt(0)
  s_barrier
  ds_read_b128 v[52:55], v250 offset:16384
  ds_read_b128 v[64:67], v236 offset:32768
  ds_read_b128 v[76:79], v236 offset:40960
  v_mfma_f32_32x32x16_bf16 v[12:27], v[48:51], v[60:63], v[12:27]
  v_mfma_f32_32x32x16_bf16 v[28:43], v[48:51], v[72:75], v[28:43]
  ds_read_b128 v[56:59], v249 offset:16384
  ds_read_b128 v[68:71], v231 offset:32768
  ds_read_b128 v[80:83], v231 offset:40960
  s_waitcnt lgkmcnt(4)
  v_mfma_f32_32x32x16_bf16 v[12:27], v[52:55], v[64:67], v[12:27]
  s_waitcnt lgkmcnt(3)
  v_mfma_f32_32x32x16_bf16 v[28:43], v[52:55], v[76:79], v[28:43]
  v_mfma_f32_16x16x32_bf16 v[4:7], v[64:67], v[8:11], v[4:7]
  v_mfma_f32_16x16x32_bf16 v[44:47], v[76:79], v[8:11], v[44:47]
  ds_read_b128 v[48:51], v248 offset:16384
  ds_read_b128 v[60:63], v230 offset:32768
  ds_read_b128 v[72:75], v230 offset:40960
  s_waitcnt lgkmcnt(4)
  v_mfma_f32_32x32x16_bf16 v[12:27], v[56:59], v[68:71], v[12:27]
  s_waitcnt lgkmcnt(3)
  v_mfma_f32_32x32x16_bf16 v[28:43], v[56:59], v[80:83], v[28:43]
  ds_read_b128 v[52:55], v237 offset:16384
  ds_read_b128 v[64:67], v229 offset:32768
  ds_read_b128 v[76:79], v229 offset:40960
  s_waitcnt lgkmcnt(4)
  v_mfma_f32_32x32x16_bf16 v[12:27], v[48:51], v[60:63], v[12:27]
  s_waitcnt lgkmcnt(3)
  v_mfma_f32_32x32x16_bf16 v[28:43], v[48:51], v[72:75], v[28:43]
  s_add_u32 m0, s75, 81920
  s_xor_b32 s100, s34, 4
  s_mul_i32 s100, s100, 229376
  s_add_u32 s100, s100, s85
  s_add_u32 s100, s100, 128
  buffer_load_dwordx4 v232, s[60:63], s100 offen lds
  s_add_u32 m0, s75, 90112
  s_xor_b32 s100, s34, 5
  s_mul_i32 s100, s100, 229376
  s_add_u32 s100, s100, s85
  s_add_u32 s100, s100, 128
  buffer_load_dwordx4 v232, s[60:63], s100 offen lds
  s_lshl_b32 s92, s83, 8
  s_add_u32 s92, s92, 155664
  v_lshl_add_u32 v241, v243, 7, s92
  ds_read_b128 v[96:99], v241 offset:0
  ds_read_b128 v[100:103], v241 offset:16
  ds_read_b128 v[104:107], v241 offset:32
  ds_read_b128 v[108:111], v241 offset:48
  ds_read_b128 v[112:115], v241 offset:64
  ds_read_b128 v[116:119], v241 offset:80
  ds_read_b128 v[120:123], v241 offset:96
  ds_read_b128 v[124:127], v241 offset:112
  s_waitcnt lgkmcnt(9)
  v_mfma_f32_32x32x16_bf16 v[12:27], v[52:55], v[64:67], v[12:27]
  s_waitcnt lgkmcnt(8)
  v_mfma_f32_32x32x16_bf16 v[28:43], v[52:55], v[76:79], v[28:43]
  v_lshrrev_b32 v242, 4, v1
  v_and_b32 v241, 1, v1
  v_lshl_add_u32 v242, v241, 2, v242
  s_lshl_b32 s92, s84, 10
  s_add_u32 s92, s92, 158816
  s_lshl_b32 s93, s83, 3
  s_add_u32 s93, s93, s92
  v_lshl_add_u32 v241, v242, 7, s93
  v_lshl_add_u32 v242, v244, 5, s92
  s_mov_b32 exec_lo, 0x30003
  s_mov_b32 exec_hi, 0x30003
  ds_write2_b32 v241, v4, v44 offset0:0 offset1:1
  ds_write2_b32 v241, v5, v45 offset0:8 offset1:9
  ds_write2_b32 v241, v6, v46 offset0:16 offset1:17
  ds_write2_b32 v241, v7, v47 offset0:24 offset1:25
  s_mov_b64 exec, -1
  s_waitcnt lgkmcnt(11)
  v_mul_f32 v12, v96, v12
  v_mul_f32 v28, v96, v28
  v_mul_f32 v13, v98, v13
  v_mul_f32 v29, v98, v29
  s_waitcnt lgkmcnt(10)
  v_mul_f32 v14, v100, v14
  v_mul_f32 v30, v100, v30
  v_mul_f32 v15, v102, v15
  v_mul_f32 v31, v102, v31
  s_waitcnt lgkmcnt(9)
  v_mul_f32 v16, v104, v16
  v_mul_f32 v32, v104, v32
  v_mul_f32 v17, v106, v17
  v_mul_f32 v33, v106, v33
  s_waitcnt lgkmcnt(8)
  v_mul_f32 v18, v108, v18
  v_mul_f32 v34, v108, v34
  v_mul_f32 v19, v110, v19
  v_mul_f32 v35, v110, v35
  s_waitcnt lgkmcnt(7)
  v_mul_f32 v20, v112, v20
  v_mul_f32 v36, v112, v36
  v_mul_f32 v21, v114, v21
  v_mul_f32 v37, v114, v37
  s_waitcnt lgkmcnt(6)
  v_mul_f32 v22, v116, v22
  v_mul_f32 v38, v116, v38
  v_mul_f32 v23, v118, v23
  v_mul_f32 v39, v118, v39
  s_waitcnt lgkmcnt(5)
  v_mul_f32 v24, v120, v24
  v_mul_f32 v40, v120, v40
  v_mul_f32 v25, v122, v25
  v_mul_f32 v41, v122, v41
  s_waitcnt lgkmcnt(4)
  v_mul_f32 v26, v124, v26
  v_mul_f32 v42, v124, v42
  v_mul_f32 v27, v126, v27
  v_mul_f32 v43, v126, v43
  s_add_u32 m0, s75, 98304
  s_xor_b32 s100, s34, 6
  s_mul_i32 s100, s100, 229376
  s_add_u32 s100, s100, s85
  s_add_u32 s100, s100, 128
  buffer_load_dwordx4 v232, s[60:63], s100 offen lds
  s_waitcnt lgkmcnt(0)
  s_barrier
  ds_read_b128 v[48:51], v242
  ds_read_b128 v[52:55], v242 offset:16
  s_add_u32 m0, s75, 106496
  s_xor_b32 s100, s34, 7
  s_mul_i32 s100, s100, 229376
  s_add_u32 s100, s100, s85
  s_add_u32 s100, s100, 128
  buffer_load_dwordx4 v232, s[60:63], s100 offen lds
  s_waitcnt lgkmcnt(1)
  v_add_f32 v4, v48, v50
  v_add_f32 v44, v49, v51
  s_waitcnt lgkmcnt(0)
  v_add_f32 v52, v52, v54
  v_add_f32 v53, v53, v55
  v_add_f32 v4, v4, v52
  v_add_f32 v44, v44, v53
  v_fma_f32 v12, -v97, v4, v12
  v_fma_f32 v28, -v97, v44, v28
  v_fma_f32 v13, -v99, v4, v13
  v_fma_f32 v29, -v99, v44, v29
  v_fma_f32 v14, -v101, v4, v14
  v_fma_f32 v30, -v101, v44, v30
  v_fma_f32 v15, -v103, v4, v15
  v_fma_f32 v31, -v103, v44, v31
  v_fma_f32 v16, -v105, v4, v16
  v_fma_f32 v32, -v105, v44, v32
  v_fma_f32 v17, -v107, v4, v17
  v_fma_f32 v33, -v107, v44, v33
  v_fma_f32 v18, -v109, v4, v18
  v_fma_f32 v34, -v109, v44, v34
  v_fma_f32 v19, -v111, v4, v19
  v_fma_f32 v35, -v111, v44, v35
  v_fma_f32 v20, -v113, v4, v20
  v_fma_f32 v36, -v113, v44, v36
  v_fma_f32 v21, -v115, v4, v21
  v_fma_f32 v37, -v115, v44, v37
  v_fma_f32 v22, -v117, v4, v22
  v_fma_f32 v38, -v117, v44, v38
  v_fma_f32 v23, -v119, v4, v23
  v_fma_f32 v39, -v119, v44, v39
  v_fma_f32 v24, -v121, v4, v24
  v_fma_f32 v40, -v121, v44, v40
  v_fma_f32 v25, -v123, v4, v25
  v_fma_f32 v41, -v123, v44, v41
  v_fma_f32 v26, -v125, v4, v26
  v_fma_f32 v42, -v125, v44, v42
  v_fma_f32 v27, -v127, v4, v27
  v_fma_f32 v43, -v127, v44, v43
  s_add_u32 m0, s75, 114688
  s_xor_b32 s100, s34, 0
  s_mul_i32 s100, s100, 229376
  s_add_u32 s100, s100, s85
  buffer_load_dwordx4 v232, s[60:63], s100 offen lds
  v_fma_f32 v4, v251, v12, v13
  v_fma_f32 v5, v251, v28, v29
  v_fma_f32 v4, -v212, v28, v4
  v_fma_f32 v5, v212, v12, v5
  v_fma_f32 v2, v251, v4, v14
  v_fma_f32 v3, v251, v5, v30
  v_fma_f32 v2, -v212, v5, v2
  v_fma_f32 v3, v212, v4, v3
  v_fma_f32 v4, v251, v2, v15
  v_fma_f32 v5, v251, v3, v31
  v_fma_f32 v4, -v212, v3, v4
  v_fma_f32 v5, v212, v2, v5
  v_fma_f32 v2, v251, v4, v16
  v_fma_f32 v3, v251, v5, v32
  v_fma_f32 v2, -v212, v5, v2
  v_fma_f32 v3, v212, v4, v3
  v_fma_f32 v4, v251, v2, v17
  v_fma_f32 v5, v251, v3, v33
  v_fma_f32 v4, -v212, v3, v4
  v_fma_f32 v5, v212, v2, v5
  v_fma_f32 v2, v251, v4, v18
  v_fma_f32 v3, v251, v5, v34
  v_fma_f32 v2, -v212, v5, v2
  v_fma_f32 v3, v212, v4, v3
  v_fma_f32 v4, v251, v2, v19
  v_fma_f32 v5, v251, v3, v35
  v_fma_f32 v4, -v212, v3, v4
  v_fma_f32 v5, v212, v2, v5
  v_fma_f32 v2, v251, v4, v20
  v_fma_f32 v3, v251, v5, v36
  v_fma_f32 v2, -v212, v5, v2
  v_fma_f32 v3, v212, v4, v3
  v_fma_f32 v4, v251, v2, v21
  v_fma_f32 v5, v251, v3, v37
  v_fma_f32 v4, -v212, v3, v4
  v_fma_f32 v5, v212, v2, v5
  v_fma_f32 v2, v251, v4, v22
  v_fma_f32 v3, v251, v5, v38
  v_fma_f32 v2, -v212, v5, v2
  v_fma_f32 v3, v212, v4, v3
  v_fma_f32 v4, v251, v2, v23
  v_fma_f32 v5, v251, v3, v39
  v_fma_f32 v4, -v212, v3, v4
  v_fma_f32 v5, v212, v2, v5
  v_fma_f32 v2, v251, v4, v24
  v_fma_f32 v3, v251, v5, v40
  v_fma_f32 v2, -v212, v5, v2
  v_fma_f32 v3, v212, v4, v3
  v_fma_f32 v4, v251, v2, v25
  v_fma_f32 v5, v251, v3, v41
  v_fma_f32 v4, -v212, v3, v4
  v_fma_f32 v5, v212, v2, v5
  v_fma_f32 v2, v251, v4, v26
  v_fma_f32 v3, v251, v5, v42
  v_fma_f32 v2, -v212, v5, v2
  v_fma_f32 v3, v212, v4, v3
  v_fma_f32 v4, v251, v2, v27
  v_fma_f32 v5, v251, v3, v43
  v_fma_f32 v4, -v212, v3, v4
  v_fma_f32 v5, v212, v2, v5
  s_lshl_b32 s92, s84, 8
  s_add_u32 s92, s92, 147456
  v_lshl_add_u32 v242, v244, 3, s92
  v_lshl_add_u32 v241, v243, 9, v242
  s_lshl_b32 s92, s83, 10
  v_add_u32 v241, s92, v241
  ds_write_b64 v241, v[4:5]
  s_lshl_b32 s92, s83, 2
  s_sub_u32 s92, s68, s92
  s_sub_u32 s92, s92, 1
  s_lshl_b32 s92, s92, 13
  s_lshl_b32 s93, s74, 10
  s_add_u32 s92, s92, s93
  s_lshl_b32 s93, s84, 9
  s_add_u32 s92, s92, s93
  v_lshl_add_u32 v6, v244, 4, s92
  v_lshlrev_b32 v7, 14, v243
  v_sub_u32 v6, v6, v7
  v_subrev_u32 v7, 8192, v6
  s_add_u32 m0, s75, 122880
  s_xor_b32 s100, s34, 1
  s_mul_i32 s100, s100, 229376
  s_add_u32 s100, s100, s85
  buffer_load_dwordx4 v232, s[60:63], s100 offen lds
  s_waitcnt lgkmcnt(0)
  s_barrier
  ds_read_b64 v[52:53], v242 offset:0
  ds_read_b64 v[54:55], v242 offset:512
  ds_read_b64 v[56:57], v242 offset:1024
  ds_read_b64 v[58:59], v242 offset:1536
  ds_read_b64 v[60:61], v242 offset:2048
  ds_read_b64 v[62:63], v242 offset:2560
  ds_read_b64 v[64:65], v242 offset:3072
  ds_read_b64 v[66:67], v242 offset:3584
  s_lshl_b32 s92, s83, 1
  v_add_u32 v241, s92, v243
  v_mov_b32 v8, 0
  v_mov_b32 v9, 0
  v_cmp_eq_u32 vcc, 1, v241
  s_waitcnt lgkmcnt(7)
  s_nop 0
  v_cndmask_b32 v8, v8, v52, vcc
  v_cndmask_b32 v9, v9, v53, vcc
  s_waitcnt lgkmcnt(6)
  v_fma_f32 v4, v86, v52, v54
  v_fma_f32 v5, v86, v53, v55
  v_fma_f32 v4, -v87, v53, v4
  v_fma_f32 v5, v87, v52, v5
  v_cmp_eq_u32 vcc, 2, v241
  s_nop 1
  v_cndmask_b32 v8, v8, v4, vcc
  v_cndmask_b32 v9, v9, v5, vcc
  s_waitcnt lgkmcnt(5)
  v_fma_f32 v2, v86, v4, v56
  v_fma_f32 v3, v86, v5, v57
  v_fma_f32 v2, -v87, v5, v2
  v_fma_f32 v3, v87, v4, v3
  v_cmp_eq_u32 vcc, 3, v241
  s_nop 1
  v_cndmask_b32 v8, v8, v2, vcc
  v_cndmask_b32 v9, v9, v3, vcc
  s_waitcnt lgkmcnt(4)
  v_fma_f32 v4, v86, v2, v58
  v_fma_f32 v5, v86, v3, v59
  v_fma_f32 v4, -v87, v3, v4
  v_fma_f32 v5, v87, v2, v5
  v_cmp_eq_u32 vcc, 4, v241
  s_nop 1
  v_cndmask_b32 v8, v8, v4, vcc
  v_cndmask_b32 v9, v9, v5, vcc
  s_waitcnt lgkmcnt(3)
  v_fma_f32 v2, v86, v4, v60
  v_fma_f32 v3, v86, v5, v61
  v_fma_f32 v2, -v87, v5, v2
  v_fma_f32 v3, v87, v4, v3
  v_cmp_eq_u32 vcc, 5, v241
  s_nop 1
  v_cndmask_b32 v8, v8, v2, vcc
  v_cndmask_b32 v9, v9, v3, vcc
  s_waitcnt lgkmcnt(2)
  v_fma_f32 v4, v86, v2, v62
  v_fma_f32 v5, v86, v3, v63
  v_fma_f32 v4, -v87, v3, v4
  v_fma_f32 v5, v87, v2, v5
  v_cmp_eq_u32 vcc, 6, v241
  s_nop 1
  v_cndmask_b32 v8, v8, v4, vcc
  v_cndmask_b32 v9, v9, v5, vcc
  s_waitcnt lgkmcnt(1)
  v_fma_f32 v2, v86, v4, v64
  v_fma_f32 v3, v86, v5, v65
  v_fma_f32 v2, -v87, v5, v2
  v_fma_f32 v3, v87, v4, v3
  v_cmp_eq_u32 vcc, 7, v241
  s_nop 1
  v_cndmask_b32 v8, v8, v2, vcc
  v_cndmask_b32 v9, v9, v3, vcc
  s_waitcnt lgkmcnt(0)
  v_fma_f32 v4, v86, v2, v66
  v_fma_f32 v5, v86, v3, v67
  v_fma_f32 v4, -v87, v3, v4
  v_fma_f32 v5, v87, v2, v5
  s_cmp_lg_u32 s83, 0
  s_nop 1
  s_cbranch_scc1 L_es_S3_2006
  v_mov_b32 v52, v4
  v_mov_b32 v53, s72
  v_mov_b32 v54, v5
  v_mov_b32 v55, s72
  s_lshl_b32 s92, s68, 13
  s_lshl_b32 s93, s74, 10
  s_add_u32 s92, s92, s93
  s_lshl_b32 s93, s84, 9
  s_add_u32 s92, s92, s93
  s_add_u32 s92, s92, 16777216
  s_mov_b64 exec, 0xffffffff
  buffer_store_dwordx4 v[52:55], v234, s[44:47], s92 offen sc1
  s_mov_b64 exec, -1
  s_nop 0
L_es_S3_2006:
  v_mov_b32 v250, 162912
  ds_read_b96 v[52:54], v250
  s_waitcnt lgkmcnt(0)
  v_or3_b32 v52, v52, v53, v54
  s_nop 0
  v_readfirstlane_b32 s80, v52
  v_mov_b32 v245, 0
  v_mov_b32 v206, 0
  v_mov_b32 v254, 0
  v_mul_f32 v254, v211, v12
  v_fma_f32 v254, -v210, v28, v254
  v_mul_f32 v28, v211, v28
  v_fma_f32 v28, v210, v12, v28
  v_mul_f32 v12, v211, v13
  v_fma_f32 v12, -v210, v29, v12
  v_mul_f32 v29, v211, v29
  v_fma_f32 v29, v210, v13, v29
  v_mul_f32 v13, v211, v14
  v_fma_f32 v13, -v210, v30, v13
  v_mul_f32 v30, v211, v30
  v_fma_f32 v30, v210, v14, v30
  v_mul_f32 v14, v211, v15
  v_fma_f32 v14, -v210, v31, v14
  v_mul_f32 v31, v211, v31
  v_fma_f32 v31, v210, v15, v31
  s_add_u32 m0, s75, 131072
  s_xor_b32 s100, s34, 2
  s_mul_i32 s100, s100, 229376
  s_add_u32 s100, s100, s85
  buffer_load_dwordx4 v232, s[60:63], s100 offen lds
  s_add_u32 m0, s75, 139264
  s_xor_b32 s100, s34, 3
  s_mul_i32 s100, s100, 229376
  s_add_u32 s100, s100, s85
  buffer_load_dwordx4 v232, s[60:63], s100 offen lds
  v_mul_f32 v15, v211, v16
  v_fma_f32 v15, -v210, v32, v15
  v_mul_f32 v32, v211, v32
  v_fma_f32 v32, v210, v16, v32
  v_mul_f32 v16, v211, v17
  v_fma_f32 v16, -v210, v33, v16
  v_mul_f32 v33, v211, v33
  v_fma_f32 v33, v210, v17, v33
  v_mul_f32 v17, v211, v18
  v_fma_f32 v17, -v210, v34, v17
  v_mul_f32 v34, v211, v34
  v_fma_f32 v34, v210, v18, v34
  v_mul_f32 v18, v211, v19
  v_fma_f32 v18, -v210, v35, v18
  v_mul_f32 v35, v211, v35
  v_fma_f32 v35, v210, v19, v35
  s_add_u32 m0, s75, 0
  s_xor_b32 s100, s34, 4
  s_mul_i32 s100, s100, 229376
  s_add_u32 s100, s100, s85
  buffer_load_dwordx4 v232, s[60:63], s100 offen lds
  s_add_u32 m0, s75, 8192
  s_xor_b32 s100, s34, 5
  s_mul_i32 s100, s100, 229376
  s_add_u32 s100, s100, s85
  buffer_load_dwordx4 v232, s[60:63], s100 offen lds
  v_mul_f32 v19, v211, v20
  v_fma_f32 v19, -v210, v36, v19
  v_mul_f32 v36, v211, v36
  v_fma_f32 v36, v210, v20, v36
  v_mul_f32 v20, v211, v21
  v_fma_f32 v20, -v210, v37, v20
  v_mul_f32 v37, v211, v37
  v_fma_f32 v37, v210, v21, v37
  v_mul_f32 v21, v211, v22
  v_fma_f32 v21, -v210, v38, v21
  v_mul_f32 v38, v211, v38
  v_fma_f32 v38, v210, v22, v38
  v_mul_f32 v22, v211, v23
  v_fma_f32 v22, -v210, v39, v22
  v_mul_f32 v39, v211, v39
  v_fma_f32 v39, v210, v23, v39
  s_add_u32 m0, s75, 16384
  s_xor_b32 s100, s34, 6
  s_mul_i32 s100, s100, 229376
  s_add_u32 s100, s100, s85
  buffer_load_dwordx4 v232, s[60:63], s100 offen lds
  v_mul_f32 v23, v211, v24
  v_fma_f32 v23, -v210, v40, v23
  v_mul_f32 v40, v211, v40
  v_fma_f32 v40, v210, v24, v40
  v_mul_f32 v24, v211, v25
  v_fma_f32 v24, -v210, v41, v24
  v_mul_f32 v41, v211, v41
  v_fma_f32 v41, v210, v25, v41
  v_mul_f32 v25, v211, v26
  v_fma_f32 v25, -v210, v42, v25
  v_mul_f32 v42, v211, v42
  v_fma_f32 v42, v210, v26, v42
  v_mul_f32 v26, v211, v27
  v_fma_f32 v26, -v210, v43, v26
  v_mul_f32 v43, v211, v43
  v_fma_f32 v43, v210, v27, v43
  s_add_u32 m0, s75, 24576
  s_xor_b32 s100, s34, 7
  s_mul_i32 s100, s100, 229376
  s_add_u32 s100, s100, s85
  buffer_load_dwordx4 v232, s[60:63], s100 offen lds
  v_mul_f32 v2, v211, v8
  v_mul_f32 v3, v211, v9
  v_fma_f32 v2, -v210, v9, v2
  v_fma_f32 v3, v210, v8, v3
  v_mul_f32 v8, v211, v90
  v_mul_f32 v9, v211, v91
  v_fma_f32 v8, -v210, v91, v8
  v_fma_f32 v9, v210, v90, v9
  s_lshl_b32 s28, s83, 10
  s_lshl_b32 s13, s84, 12
  s_lshr_b32 s92, s2, 7
  s_lshl_b32 s3, s92, 1
  s_add_u32 s3, s3, s73
  s_lshl_b32 s3, s3, 1
  s_add_u32 s3, s3, s74
  s_add_u32 s3, s3, s2
  s_lshl_b32 s3, s3, 7
  s_and_b32 s3, s3, 0x380
  s_add_u32 s3, s3, s86
  s_mul_i32 s92, s92, 7
  s_mul_i32 s93, s73, 3
  s_add_u32 s92, s92, s93
  s_lshl_b32 s93, s74, 1
  s_add_u32 s92, s92, s93
  s_sub_u32 s93, s92, 14
  s_min_u32 s92, s92, s93
  s_and_b32 s93, s2, 7
  s_lshl_b32 s93, s93, 1
  s_add_u32 s92, s92, s93
  s_sub_u32 s93, s92, 14
  s_min_u32 s92, s92, s93
  s_sub_u32 s93, s92, 14
  s_min_u32 s92, s92, s93
  s_lshl_b32 s1, s92, 13
  s_lshl_b32 s0, s92, 17
  s_add_u32 s0, s0, s79
  s_lshr_b32 s92, s71, 5
  s_lshl_b32 s93, s73, 1
  s_add_u32 s93, s93, s84
  s_add_u32 s92, s92, s93
  s_mul_i32 s4, s92, 114688
  s_add_u32 s4, s4, 8388608
  s_add_u32 s4, s4, s28
  s_lshl_b32 s8, s92, 16
  s_lshl_b32 s94, s83, 11
  s_add_u32 s8, s8, s94
  s_add_u32 s8, s8, 4194304
  s_and_b32 s94, s3, 0x380
  s_lshl_b32 s94, s94, 6
  s_add_u32 s8, s8, s94
  s_lshl_b32 s93, s93, 1
  s_lshr_b32 s94, s70, 2
  s_add_u32 s93, s93, s94
  s_lshl_b32 s94, s93, 5
  s_add_u32 s94, s94, s81
  s_add_u32 s5, s94, 2048
  s_lshl_b32 s94, s93, 6
  s_add_u32 s94, s94, s81
  s_add_u32 s6, s94, 3072
  s_lshl_b32 s92, s70, 6
  s_lshr_b32 s93, s85, 6
  s_add_u32 s92, s92, s93
  s_add_u32 s92, s92, s81
  s_add_u32 s9, s92, 3072
  s_bfe_u32 s92, s35, 0x10001
  s_lshl_b32 s92, s92, 12
  s_and_b32 s93, s35, 1
  s_lshl_b32 s93, s93, 10
  s_or_b32 s92, s92, s93
  s_mov_b32 s24, 81920
  s_cmp_eq_u32 s23, 0
  s_cselect_b32 s93, 114688, 0
  s_cselect_b32 s24, 4294901760, s24
  s_add_u32 s25, s92, s93
  s_lshr_b32 s92, s71, 5
  s_add_u32 s92, s92, s83
  s_mul_i32 s18, s92, 114688
  s_lshl_b32 s93, s85, 5
  s_add_u32 s18, s18, s93
  s_lshl_b32 s93, s84, 11
  s_add_u32 s18, s18, s93
  s_add_u32 s18, s18, 8388608
  s_lshl_b32 s92, s92, 1
  s_add_u32 s92, s92, s84
  s_lshl_b32 s93, s92, 11
  s_add_u32 s7, s93, 17039360
  s_lshl_b32 s92, s92, 14
  s_add_u32 s19, s92, 2097152
  s_lshl_b32 s92, s35, 10
  s_add_u32 s19, s19, s92
  s_lshl_b32 s92, s75, 3
  s_add_u32 s93, s92, 114688
  s_sub_u32 s92, s92, 32768
  s_cmp_lt_u32 s70, 4
  s_cselect_b32 s29, s93, s92
  s_mov_b32 s26, 114688
  s_cmp_eq_u32 s83, 1
  s_cselect_b32 s26, 122880, s26
  s_cmp_eq_u32 s83, 2
  s_cselect_b32 s26, 0, s26
  s_cmp_eq_u32 s83, 3
  s_cselect_b32 s26, 8192, s26
  s_add_u32 s26, s26, s13
  s_mov_b32 s27, 49152
  s_cmp_eq_u32 s83, 1
  s_cselect_b32 s27, 57344, s27
  s_cmp_eq_u32 s83, 2
  s_cselect_b32 s27, 81920, s27
  s_cmp_eq_u32 s83, 3
  s_cselect_b32 s27, 90112, s27
  s_add_u32 s27, s27, s13
  s_mov_b32 s56, s14
  s_mov_b32 s57, s15
  s_mov_b32 s58, 524288
  s_mov_b32 s59, 0x00020000
  s_mov_b32 s52, s30
  s_mov_b32 s53, s31
  s_mov_b32 s54, 1835008
  s_mov_b32 s55, 0x00020000
  s_mov_b32 s48, s16
  s_mov_b32 s49, s17
  s_mov_b32 s50, 524288
  s_mov_b32 s51, 0x00020000
  s_add_u32 s64, s36, 16777216
  s_addc_u32 s65, s37, 0
  s_mov_b32 s66, 131072
  s_mov_b32 s67, 0x00020000
  buffer_load_dwordx4 v[44:47], v6, s[64:67], 0 offen sc1
  buffer_load_dwordx4 v[48:51], v7, s[64:67], 0 offen sc1
  v_lshrrev_b32 v224, 5, v1
  v_bfe_u32 v226, v1, 2, 2
  v_lshl_add_u32 v225, v224, 2, v226
  v_lshlrev_b32 v239, 7, v225
  v_lshrrev_b32 v226, 1, v226
  v_lshlrev_b32 v226, 2, v226
  v_lshl_add_u32 v226, v224, 1, v226
  v_bfe_u32 v225, v1, 4, 1
  v_bfe_u32 v224, v1, 1, 1
  v_lshl_add_u32 v225, v225, 1, v224
  v_xor_b32 v225, v225, v226
  v_lshl_add_u32 v239, v225, 4, v239
  v_and_b32 v225, 1, v1
  v_lshl_add_u32 v239, v225, 3, v239
  v_lshl_add_u32 v224, s83, 11, v239
  v_xor_b32 v223, 64, v224
  v_and_b32 v220, 31, v1
  v_bfe_u32 v218, v1, 1, 3
  s_lshl_b32 s92, s83, 1
  v_xor_b32 v219, s92, v218
  v_lshlrev_b32 v219, 4, v219
  v_lshl_add_u32 v226, v220, 7, v219
  v_lshrrev_b32 v219, 5, v1
  v_lshl_add_u32 v226, v219, 13, v226
  v_xor_b32 v225, 16, v226
  v_xor_b32 v219, v219, v218
  v_lshlrev_b32 v219, 4, v219
  v_lshl_add_u32 v222, v220, 7, v219
  v_add_u32 v222, s13, v222
  v_lshrrev_b32 v220, 3, v1
  v_lshl_add_u32 v220, s83, 3, v220
  v_bfe_u32 v219, v220, 1, 3
  v_xor_b32 v219, v219, v1
  v_and_b32 v219, 7, v219
  v_lshlrev_b32 v219, 4, v219
  v_lshl_add_u32 v221, v220, 7, v219
  v_add_u32 v221, s13, v221
  v_add_u32 v220, 65536, v226
  v_add_u32 v219, 131072, v226
  v_add_u32 v218, 65536, v225
  v_add_u32 v217, 131072, v225
  v_add_u32 v216, 65536, v224
  v_add_u32 v215, 131072, v224
  v_add_u32 v214, 65536, v223
  v_add_u32 v213, 131072, v223
  v_add_u32 v211, 65536, v221
  v_add_u32 v210, 131072, v221
  s_lshl_b32 s92, s84, 6
  v_xor_b32 v250, s92, v239
  v_add_u32 v250, s25, v250
  v_xor_b32 v246, 64, v250
  v_lshl_add_u32 v237, s75, 3, v239
  v_add_u32 v239, s29, v239
  v_xor_b32 v238, 64, v239
  v_xor_b32 v236, 64, v237
  v_and_b32 v227, 31, v1
  v_lshrrev_b32 v52, 5, v1
  v_lshlrev_b32 v52, 10, v52
  v_lshl_add_u32 v240, v227, 3, v52
  s_lshl_b32 s92, s70, 8
  s_add_u32 s92, s92, 155648
  v_lshl_add_u32 v229, v227, 3, s92
  s_lshl_b32 s92, s84, 7
  s_add_u32 s92, s92, 158816
  v_lshl_add_u32 v227, v227, 2, s92
  v_lshrrev_b32 v228, 4, v1
  v_and_b32 v52, 1, v1
  v_lshl_add_u32 v228, v52, 2, v228
  s_lshl_b32 s92, s70, 9
  s_add_u32 s92, s92, 158816
  v_lshl_add_u32 v228, v228, 4, s92
  v_add_u32 v231, s26, v234
  v_add_u32 v230, s27, v234
  v_xor_b32 v249, 1024, v250
  v_xor_b32 v248, 4096, v250
  v_xor_b32 v247, 5120, v250
  v_xor_b32 v245, 1024, v246
  v_xor_b32 v242, 4096, v246
  v_xor_b32 v241, 5120, v246
  v_lshrrev_b32 v209, 4, v1
  v_xor_b32 v209, v209, v1
  v_and_b32 v209, 1, v209
  v_cmp_eq_u32 vcc, 0, v209
  v_mov_b32 v209, s78
  s_nop 0
  v_cndmask_b32 v60, 0, v209, vcc
  v_cndmask_b32 v61, 0, v209, vcc
  v_cndmask_b32 v62, 0, v209, vcc
  v_cndmask_b32 v63, 0, v209, vcc
  s_mov_b32 s64, s20
  s_mov_b32 s65, s21
  s_mov_b32 s66, 1024
  s_mov_b32 s67, 0x00020000
  v_lshrrev_b32 v209, 3, v1
  v_and_b32 v206, 7, v1
  v_lshlrev_b32 v208, 3, v206
  buffer_load_dwordx2 v[68:69], v208, s[64:67], s79 offen
  buffer_load_dwordx2 v[70:71], v208, s[64:67], s79 offen offset:64
  v_lshl_add_u32 v207, v209, 10, v208
  s_lshl_b32 s92, s73, 6
  s_lshl_b32 s93, s84, 5
  s_add_u32 s92, s92, s93
  s_lshl_b32 s93, s83, 3
  s_add_u32 s92, s92, s93
  s_add_u32 s93, s92, s71
  s_lshl_b32 s93, s93, 10
  s_add_u32 s88, s93, s79
  buffer_load_dwordx2 v[64:65], v207, s[40:43], s88 offen
  buffer_load_dwordx2 v[66:67], v207, s[40:43], s88 offen offset:64
  s_lshl_b32 s92, s92, 3
  s_add_u32 s92, s92, 157776
  v_lshl_add_u32 v208, v209, 3, s92
  ds_read_b64 v[4:5], v208
  v_lshlrev_b32 v209, 4, v209
  v_and_b32 v208, 1, v206
  v_lshl_add_u32 v209, v208, 9, v209
  v_bfe_u32 v208, v206, 1, 1
  v_lshl_add_u32 v209, v208, 10, v209
  v_lshrrev_b32 v208, 2, v206
  v_lshl_add_u32 v206, v208, 3, v209
  s_lshr_b32 s92, s71, 5
  s_lshl_b32 s93, s73, 1
  s_add_u32 s92, s92, s93
  s_add_u32 s92, s92, s84
  s_lshl_b32 s92, s92, 15
  s_lshl_b32 s93, s79, 5
  s_add_u32 s92, s92, s93
  s_lshl_b32 s93, s83, 7
  s_add_u32 s92, s92, s93
  s_add_u32 s69, s92, 2097152
  v_lshlrev_b32 v207, 1, v207
  s_lshl_b32 s88, s88, 1
  s_waitcnt vmcnt(4)
  v_mov_b32 v209, v51
  s_mov_b32 s93, 200000
  s_nop 1
L_el_S3_2007:
  v_mov_b32 v209, 0
  v_cmp_le_i32 vcc, 0, v6
  s_nop 1
  v_cndmask_b32 v208, 0, v233, vcc
  v_xor_b32 v205, v208, v45
  v_xor_b32 v204, v208, v47
  v_or3_b32 v209, v209, v205, v204
  v_cmp_le_i32 vcc, 0, v7
  s_nop 1
  v_cndmask_b32 v208, 0, v233, vcc
  v_xor_b32 v205, v208, v49
  v_xor_b32 v204, v208, v51
  v_or3_b32 v209, v209, v205, v204
  v_cmp_ne_u32 vcc, 0, v209
  s_nop 4
  s_cbranch_vccz L_ed_S3_2008
  s_add_u32 s64, s36, 16777216
  s_addc_u32 s65, s37, 0
  s_mov_b32 s66, 131072
  s_mov_b32 s67, 0x00020000
  buffer_load_dwordx4 v[44:47], v6, s[64:67], 0 offen sc1
  buffer_load_dwordx4 v[48:51], v7, s[64:67], 0 offen sc1
  s_waitcnt vmcnt(0)
  s_sub_u32 s93, s93, 1
  s_cmp_lg_u32 s93, 0
  s_cbranch_scc1 L_el_S3_2007
L_ed_S3_2008:
  v_fma_f32 v205, v88, v48, v44
  v_fma_f32 v204, v88, v50, v46
  v_fma_f32 v205, -v89, v50, v205
  v_fma_f32 v204, v89, v48, v204
  v_mul_f32 v10, v92, v205
  v_mul_f32 v11, v92, v204
  v_fma_f32 v10, -v93, v204, v10
  v_fma_f32 v11, v93, v205, v11
  v_mov_b32 v205, v10
  v_mov_b32 v204, v11
  s_nop 0
  v_permlane32_swap_b32 v10, v205
  v_permlane32_swap_b32 v11, v204
  v_add_f32 v10, v10, v205
  v_add_f32 v11, v11, v204
  s_lshl_b32 s92, s84, 8
  s_add_u32 s92, s92, 151552
  v_lshl_add_u32 v208, v244, 3, s92
  s_lshl_b32 s92, s83, 9
  v_add_u32 v209, s92, v208
  ds_write_b64 v209, v[10:11]
  s_waitcnt lgkmcnt(0)
  s_barrier
  ds_read_b64_tr_b16 v[96:97], v239 offset:0
  ds_read_b64_tr_b16 v[98:99], v239 offset:2048
  ds_read_b64_tr_b16 v[100:101], v239 offset:1024
  ds_read_b64_tr_b16 v[102:103], v239 offset:3072
  ds_read_b64_tr_b16 v[104:105], v239 offset:4096
  ds_read_b64_tr_b16 v[106:107], v239 offset:6144
  ds_read_b64_tr_b16 v[108:109], v239 offset:5120
  ds_read_b64_tr_b16 v[110:111], v239 offset:7168
  ds_read_b64_tr_b16 v[112:113], v238 offset:0
  ds_read_b64_tr_b16 v[114:115], v238 offset:2048
  ds_read_b64_tr_b16 v[116:117], v238 offset:1024
  ds_read_b64_tr_b16 v[118:119], v238 offset:3072
  ds_read_b64_tr_b16 v[120:121], v238 offset:4096
  ds_read_b64_tr_b16 v[122:123], v238 offset:6144
  ds_read_b64_tr_b16 v[124:125], v238 offset:5120
  ds_read_b64_tr_b16 v[126:127], v238 offset:7168
  ds_read_b64_tr_b16 v[128:129], v237 offset:49152
  ds_read_b64_tr_b16 v[130:131], v237 offset:51200
  ds_read_b64_tr_b16 v[132:133], v237 offset:50176
  ds_read_b64_tr_b16 v[134:135], v237 offset:52224
  ds_read_b64_tr_b16 v[136:137], v237 offset:53248
  ds_read_b64_tr_b16 v[138:139], v237 offset:55296
  ds_read_b64_tr_b16 v[140:141], v237 offset:54272
  ds_read_b64_tr_b16 v[142:143], v237 offset:56320
  ds_read_b64_tr_b16 v[144:145], v236 offset:49152
  ds_read_b64_tr_b16 v[146:147], v236 offset:51200
  ds_read_b64_tr_b16 v[148:149], v236 offset:50176
  ds_read_b64_tr_b16 v[150:151], v236 offset:52224
  ds_read_b64_tr_b16 v[152:153], v236 offset:53248
  ds_read_b64_tr_b16 v[154:155], v236 offset:55296
  ds_read_b64_tr_b16 v[156:157], v236 offset:54272
  ds_read_b64_tr_b16 v[158:159], v236 offset:56320
  s_waitcnt lgkmcnt(15)
  v_mfma_f32_16x16x32_bf16 v[44:47], v[96:99], v[60:63], 0
  s_waitcnt lgkmcnt(15)
  v_mfma_f32_16x16x32_bf16 v[44:47], v[100:103], v[60:63], v[44:47]
  s_waitcnt lgkmcnt(15)
  v_mfma_f32_16x16x32_bf16 v[44:47], v[104:107], v[60:63], v[44:47]
  s_waitcnt lgkmcnt(15)
  v_mfma_f32_16x16x32_bf16 v[44:47], v[108:111], v[60:63], v[44:47]
  s_waitcnt lgkmcnt(15)
  v_mfma_f32_16x16x32_bf16 v[48:51], v[112:115], v[60:63], 0
  s_waitcnt lgkmcnt(15)
  v_mfma_f32_16x16x32_bf16 v[48:51], v[116:119], v[60:63], v[48:51]
  s_waitcnt lgkmcnt(15)
  v_mfma_f32_16x16x32_bf16 v[48:51], v[120:123], v[60:63], v[48:51]
  s_waitcnt lgkmcnt(15)
  v_mfma_f32_16x16x32_bf16 v[48:51], v[124:127], v[60:63], v[48:51]
  s_waitcnt lgkmcnt(14)
  v_mfma_f32_16x16x32_bf16 v[72:75], v[128:131], v[60:63], 0
  s_waitcnt lgkmcnt(12)
  v_mfma_f32_16x16x32_bf16 v[72:75], v[132:135], v[60:63], v[72:75]
  s_waitcnt lgkmcnt(10)
  v_mfma_f32_16x16x32_bf16 v[72:75], v[136:139], v[60:63], v[72:75]
  s_waitcnt lgkmcnt(8)
  v_mfma_f32_16x16x32_bf16 v[72:75], v[140:143], v[60:63], v[72:75]
  s_waitcnt lgkmcnt(6)
  v_mfma_f32_16x16x32_bf16 v[76:79], v[144:147], v[60:63], 0
  s_waitcnt lgkmcnt(4)
  v_mfma_f32_16x16x32_bf16 v[76:79], v[148:151], v[60:63], v[76:79]
  s_waitcnt lgkmcnt(2)
  v_mfma_f32_16x16x32_bf16 v[76:79], v[152:155], v[60:63], v[76:79]
  s_waitcnt lgkmcnt(0)
  v_mfma_f32_16x16x32_bf16 v[76:79], v[156:159], v[60:63], v[76:79]
  s_mov_b32 exec_lo, 0x30003
  s_mov_b32 exec_hi, 0x30003
  ds_write_b128 v228, v[44:47] offset:0
  ds_write_b128 v228, v[48:51] offset:128
  ds_write_b128 v228, v[72:75] offset:256
  s_nop 2
  ds_write_b128 v228, v[76:79] offset:384
  s_mov_b64 exec, -1
  ds_read_b64 v[44:45], v208 offset:0
  ds_read_b64 v[46:47], v208 offset:512
  ds_read_b64 v[48:49], v208 offset:1024
  ds_read_b64 v[50:51], v208 offset:1536
  s_xor_b32 s92, s70, 1
  s_lshl_b32 s92, s92, 11
  s_add_u32 s92, s92, 32768
  v_lshl_add_u32 v239, v244, 5, s92
  v_lshl_add_u32 v239, v243, 4, v239
  v_lshl_add_u32 v238, v243, 10, s92
  v_bfe_u32 v236, v1, 4, 1
  v_lshl_add_u32 v238, v236, 8, v238
  v_lshlrev_b32 v237, 10, v236
  v_and_b32 v236, 15, v1
  v_lshl_add_u32 v238, v236, 3, v238
  v_lshl_add_u32 v237, v243, 9, v237
  v_bfe_u32 v236, v1, 3, 1
  v_lshl_add_u32 v237, v236, 8, v237
  v_and_b32 v236, 7, v1
  v_lshl_add_u32 v237, v236, 4, v237
  s_lshr_b32 s92, s71, 5
  s_add_u32 s92, s92, s83
  s_lshl_b32 s92, s92, 16
  s_lshl_b32 s93, s74, 13
  s_add_u32 s92, s92, s93
  s_lshl_b32 s93, s84, 12
  s_add_u32 s92, s92, s93
  s_add_u32 s87, s92, 4194304
  s_lshl_b32 s92, s70, 3
  s_add_u32 s92, s92, s74
  s_lshl_b32 s92, s92, 2
  s_add_u32 s92, s92, s81
  s_add_u32 s36, s92, 2048
  s_waitcnt lgkmcnt(2)
  v_add_f32 v44, v44, v46
  v_add_f32 v45, v45, v47
  s_waitcnt lgkmcnt(0)
  v_add_f32 v48, v48, v50
  v_add_f32 v49, v49, v51
  v_add_f32 v44, v44, v48
  v_add_f32 v45, v45, v49
  v_fma_f32 v46, v8, v44, v2
  v_fma_f32 v47, v8, v45, v3
  v_fma_f32 v46, -v9, v45, v46
  v_fma_f32 v47, v9, v44, v47
  v_fma_f32 v254, v251, v46, v254
  v_fma_f32 v28, v251, v47, v28
  v_fma_f32 v254, -v212, v47, v254
  v_fma_f32 v28, v212, v46, v28
  v_fma_f32 v12, v251, v254, v12
  v_fma_f32 v29, v251, v28, v29
  v_fma_f32 v12, -v212, v28, v12
  v_fma_f32 v29, v212, v254, v29
  v_cvt_pk_bf16_f32 v60, v254, v12
  v_cvt_pk_bf16_f32 v72, -v28, -v29
  v_fma_f32 v13, v251, v12, v13
  v_fma_f32 v30, v251, v29, v30
  v_fma_f32 v13, -v212, v29, v13
  v_fma_f32 v30, v212, v12, v30
  v_fma_f32 v14, v251, v13, v14
  v_fma_f32 v31, v251, v30, v31
  v_fma_f32 v14, -v212, v30, v14
  v_fma_f32 v31, v212, v13, v31
  v_cvt_pk_bf16_f32 v61, v13, v14
  v_cvt_pk_bf16_f32 v73, -v30, -v31
  v_fma_f32 v15, v251, v14, v15
  v_fma_f32 v32, v251, v31, v32
  v_fma_f32 v15, -v212, v31, v15
  v_fma_f32 v32, v212, v14, v32
  v_fma_f32 v16, v251, v15, v16
  v_fma_f32 v33, v251, v32, v33
  v_fma_f32 v16, -v212, v32, v16
  v_fma_f32 v33, v212, v15, v33
  v_cvt_pk_bf16_f32 v62, v15, v16
  v_cvt_pk_bf16_f32 v74, -v32, -v33
  v_fma_f32 v17, v251, v16, v17
  v_fma_f32 v34, v251, v33, v34
  v_fma_f32 v17, -v212, v33, v17
  v_fma_f32 v34, v212, v16, v34
  v_fma_f32 v18, v251, v17, v18
  v_fma_f32 v35, v251, v34, v35
  v_fma_f32 v18, -v212, v34, v18
  v_fma_f32 v35, v212, v17, v35
  v_cvt_pk_bf16_f32 v63, v17, v18
  v_cvt_pk_bf16_f32 v75, -v34, -v35
  ds_write_b128 v239, v[60:63]
  ds_write_b128 v239, v[72:75] offset:1024
  ds_read_b64_tr_b16 v[76:77], v238 offset:0
  ds_read_b64_tr_b16 v[78:79], v238 offset:128
  ds_read_b64_tr_b16 v[80:81], v238 offset:512
  ds_read_b64_tr_b16 v[82:83], v238 offset:640
  v_fma_f32 v19, v251, v18, v19
  v_fma_f32 v36, v251, v35, v36
  v_fma_f32 v19, -v212, v35, v19
  v_fma_f32 v36, v212, v18, v36
  v_fma_f32 v20, v251, v19, v20
  v_fma_f32 v37, v251, v36, v37
  v_fma_f32 v20, -v212, v36, v20
  v_fma_f32 v37, v212, v19, v37
  v_cvt_pk_bf16_f32 v60, v19, v20
  v_cvt_pk_bf16_f32 v72, -v36, -v37
  v_fma_f32 v21, v251, v20, v21
  v_fma_f32 v38, v251, v37, v38
  v_fma_f32 v21, -v212, v37, v21
  v_fma_f32 v38, v212, v20, v38
  v_fma_f32 v22, v251, v21, v22
  v_fma_f32 v39, v251, v38, v39
  v_fma_f32 v22, -v212, v38, v22
  v_fma_f32 v39, v212, v21, v39
  v_cvt_pk_bf16_f32 v61, v21, v22
  v_cvt_pk_bf16_f32 v73, -v38, -v39
  s_waitcnt lgkmcnt(2)
  buffer_store_dwordx4 v[76:79], v237, s[44:47], s87 offen offset:0 sc1
  s_waitcnt lgkmcnt(0)
  buffer_store_dwordx4 v[80:83], v237, s[44:47], s87 offen offset:2048 sc1
  v_fma_f32 v23, v251, v22, v23
  v_fma_f32 v40, v251, v39, v40
  v_fma_f32 v23, -v212, v39, v23
  v_fma_f32 v40, v212, v22, v40
  v_fma_f32 v24, v251, v23, v24
  v_fma_f32 v41, v251, v40, v41
  v_fma_f32 v24, -v212, v40, v24
  v_fma_f32 v41, v212, v23, v41
  v_cvt_pk_bf16_f32 v62, v23, v24
  v_cvt_pk_bf16_f32 v74, -v40, -v41
  v_fma_f32 v25, v251, v24, v25
  v_fma_f32 v42, v251, v41, v42
  v_fma_f32 v25, -v212, v41, v25
  v_fma_f32 v42, v212, v24, v42
  v_fma_f32 v26, v251, v25, v26
  v_fma_f32 v43, v251, v42, v43
  v_fma_f32 v26, -v212, v42, v26
  v_fma_f32 v43, v212, v25, v43
  v_cvt_pk_bf16_f32 v63, v25, v26
  v_cvt_pk_bf16_f32 v75, -v42, -v43
  ds_write_b128 v239, v[60:63]
  ds_write_b128 v239, v[72:75] offset:1024
  ds_read_b64_tr_b16 v[84:85], v238 offset:0
  ds_read_b64_tr_b16 v[86:87], v238 offset:128
  ds_read_b64_tr_b16 v[88:89], v238 offset:512
  ds_read_b64_tr_b16 v[90:91], v238 offset:640
  s_waitcnt lgkmcnt(2)
  buffer_store_dwordx4 v[84:87], v237, s[44:47], s87 offen offset:128 sc1
  s_waitcnt lgkmcnt(0)
  buffer_store_dwordx4 v[88:91], v237, s[44:47], s87 offen offset:2176 sc1
  s_and_b32 s92, s83, 1
  s_lshl_b32 s92, s92, 7
  s_add_u32 s92, s92, s81
  s_add_u32 s89, s92, 1024
  s_mov_b64 exec, 0xffffffff
  buffer_load_dword v228, v235, s[44:47], s89 offen sc1
  s_mov_b64 exec, -1
  s_mov_b32 s64, s32
  s_mov_b32 s65, s33
  s_mov_b32 s66, 4194304
  s_mov_b32 s67, 0x00020000
  s_waitcnt vmcnt(0)
  v_mov_b32 v228, v228
  s_mov_b32 s101, 200000
  s_mov_b64 exec, 0xffffffff
  s_nop 0
L_pl_S3_2009:
  v_cmp_ne_u32 vcc, s72, v228
  s_nop 4
  s_cbranch_vccz L_pd_S3_2010
  buffer_load_dword v228, v235, s[44:47], s89 offen sc1
  s_waitcnt vmcnt(0)
  s_sub_u32 s101, s101, 1
  s_cmp_lg_u32 s101, 0
  s_cbranch_scc1 L_pl_S3_2009
L_pd_S3_2010:
  s_mov_b64 exec, -1
  s_xor_b32 s99, s19, 0
  buffer_load_dwordx4 v[96:99], v234, s[44:47], s99 offen sc1
  s_xor_b32 s99, s19, 1024
  buffer_load_dwordx4 v[100:103], v234, s[44:47], s99 offen sc1
  s_xor_b32 s99, s19, 2048
  buffer_load_dwordx4 v[104:107], v234, s[44:47], s99 offen sc1
  buffer_load_dwordx2 v[52:53], v240, s[44:47], s7 offen offset:0 sc1
  buffer_load_dwordx2 v[54:55], v240, s[44:47], s7 offen offset:256 sc1
  buffer_load_dwordx2 v[56:57], v240, s[44:47], s7 offen offset:512 sc1
  buffer_load_dwordx2 v[58:59], v240, s[44:47], s7 offen offset:768 sc1
  s_xor_b32 s99, s19, 3072
  buffer_load_dwordx4 v[108:111], v234, s[44:47], s99 offen sc1
  s_xor_b32 s99, s19, 4096
  buffer_load_dwordx4 v[112:115], v234, s[44:47], s99 offen sc1
  ds_read_b64_tr_b16 v[60:61], v246 offset:0
  ds_read_b64_tr_b16 v[62:63], v246 offset:2048
  ds_read_b64_tr_b16 v[88:89], v245 offset:0
  ds_read_b64_tr_b16 v[90:91], v245 offset:2048
  ds_read_b64_tr_b16 v[40:41], v250 offset:0
  ds_read_b64_tr_b16 v[42:43], v250 offset:2048
  ds_read_b64_tr_b16 v[44:45], v249 offset:0
  ds_read_b64_tr_b16 v[46:47], v249 offset:2048
  ds_read_b64_tr_b16 v[92:93], v242 offset:0
  ds_read_b64_tr_b16 v[94:95], v242 offset:2048
  s_xor_b32 s99, s19, 5120
  buffer_load_dwordx4 v[116:119], v234, s[44:47], s99 offen sc1
  s_waitcnt vmcnt(9) lgkmcnt(8)
  v_mfma_f32_32x32x16_bf16 v[24:39], v[60:63], v[96:99], 0
  s_lshl_b32 s97, s4, 4
  s_sub_u32 s74, s79, s97
  s_add_u32 s10, s1, s4
  v_mov_b32 v254, v234
  s_add_u32 s97, s1, 8192
  s_sub_u32 s98, s97, 114688
  s_min_u32 s97, s97, s98
  s_add_u32 s11, s97, s4
  s_add_u32 s97, s1, 16384
  ds_read_b64_tr_b16 v[60:61], v241 offset:0
  ds_read_b64_tr_b16 v[62:63], v241 offset:2048
  s_xor_b32 s99, s19, 6144
  buffer_load_dwordx4 v[120:123], v234, s[44:47], s99 offen sc1
  s_waitcnt vmcnt(9) lgkmcnt(8)
  v_mfma_f32_32x32x16_bf16 v[24:39], v[88:91], v[100:103], v[24:39]
  s_sub_u32 s98, s97, 114688
  s_min_u32 s97, s97, s98
  s_add_u32 s12, s97, s4
  s_add_u32 s97, s1, 24576
  s_sub_u32 s98, s97, 114688
  s_min_u32 s97, s97, s98
  s_add_u32 s14, s97, s4
  s_add_u32 s97, s1, 32768
  s_sub_u32 s98, s97, 114688
  ds_read_b64_tr_b16 v[88:89], v246 offset:8192
  ds_read_b64_tr_b16 v[90:91], v246 offset:10240
  s_xor_b32 s99, s19, 7168
  buffer_load_dwordx4 v[124:127], v234, s[44:47], s99 offen sc1
  s_waitcnt vmcnt(9) lgkmcnt(4)
  v_mfma_f32_32x32x16_bf16 v[24:39], v[92:95], v[104:107], v[24:39]
  s_min_u32 s97, s97, s98
  s_add_u32 s15, s97, s4
  s_add_u32 s97, s1, 40960
  s_sub_u32 s98, s97, 114688
  s_min_u32 s97, s97, s98
  s_add_u32 s16, s97, s4
  s_add_u32 s97, s1, 49152
  s_sub_u32 s98, s97, 114688
  s_min_u32 s97, s97, s98
  ds_read_b64_tr_b16 v[48:49], v248 offset:0
  ds_read_b64_tr_b16 v[50:51], v248 offset:2048
  v_mfma_f32_32x32x16_bf16 v[8:23], v[40:43], v[96:99], 0
  s_add_u32 s17, s97, s4
  s_add_u32 s97, s1, 57344
  s_sub_u32 s98, s97, 114688
  s_min_u32 s97, s97, s98
  s_add_u32 s30, s97, s4
  s_add_u32 s97, s1, 65536
  s_sub_u32 s98, s97, 114688
  s_min_u32 s97, s97, s98
  s_add_u32 s31, s97, s4
  ds_read_b64_tr_b16 v[92:93], v245 offset:8192
  ds_read_b64_tr_b16 v[94:95], v245 offset:10240
  s_xor_b32 s99, s19, 8192
  buffer_load_dwordx4 v[128:131], v234, s[44:47], s99 offen sc1
  s_waitcnt vmcnt(5) lgkmcnt(6)
  v_mfma_f32_32x32x16_bf16 v[24:39], v[60:63], v[108:111], v[24:39]
  s_add_u32 s97, s1, 73728
  s_sub_u32 s98, s97, 114688
  s_min_u32 s97, s97, s98
  s_add_u32 s89, s97, s4
  s_add_u32 s97, s1, 81920
  s_sub_u32 s98, s97, 114688
  s_min_u32 s97, s97, s98
  s_add_u32 s90, s97, s4
  s_add_u32 s97, s1, 90112
  ds_read_b64_tr_b16 v[40:41], v247 offset:0
  ds_read_b64_tr_b16 v[42:43], v247 offset:2048
  v_mfma_f32_32x32x16_bf16 v[8:23], v[44:47], v[100:103], v[8:23]
  s_sub_u32 s98, s97, 114688
  s_min_u32 s97, s97, s98
  s_add_u32 s91, s97, s4
  s_add_u32 s97, s1, 98304
  s_sub_u32 s98, s97, 114688
  s_min_u32 s97, s97, s98
  s_add_u32 s87, s97, s4
  s_add_u32 s97, s1, 106496
  s_sub_u32 s98, s97, 114688
  ds_read_b64_tr_b16 v[60:61], v242 offset:8192
  ds_read_b64_tr_b16 v[62:63], v242 offset:10240
  s_xor_b32 s99, s19, 9216
  buffer_load_dwordx4 v[132:135], v234, s[44:47], s99 offen sc1
  s_waitcnt vmcnt(5) lgkmcnt(8)
  v_mfma_f32_32x32x16_bf16 v[24:39], v[88:91], v[112:115], v[24:39]
  s_min_u32 s97, s97, s98
  s_add_u32 s82, s97, s4
  v_lshlrev_b32 v251, 16, v64
  v_and_b32 v244, 0xffff0000, v64
  v_sub_f32 v251, v251, v4
  v_sub_f32 v244, v244, v4
  v_cvt_pk_bf16_f32 v192, v251, v244
  v_lshlrev_b32 v251, 16, v192
  v_and_b32 v244, 0xffff0000, v192
  s_mov_b64 exec, 1
  s_cmp_eq_u32 s80, 0
  s_cbranch_scc1 L_du_S3_1_f
  buffer_store_dword v233, off, s[44:47], s36 sc1
  s_branch L_du_S3_1_d
L_du_S3_1_f:
  buffer_store_dword v233, off, s[44:47], s36
L_du_S3_1_d:
  s_mov_b64 exec, -1
  ds_read_b64_tr_b16 v[44:45], v250 offset:8192
  ds_read_b64_tr_b16 v[46:47], v250 offset:10240
  s_waitcnt lgkmcnt(8)
  v_mfma_f32_32x32x16_bf16 v[8:23], v[48:51], v[104:107], v[8:23]
  v_mul_f32 v251, v251, v5
  v_mul_f32 v244, v244, v5
  v_cvt_pk_bf16_f32 v192, v251, v244
  v_lshlrev_b32 v251, 16, v65
  v_and_b32 v244, 0xffff0000, v65
  v_sub_f32 v251, v251, v4
  v_sub_f32 v244, v244, v4
  v_cvt_pk_bf16_f32 v193, v251, v244
  v_lshlrev_b32 v251, 16, v193
  ds_read_b64_tr_b16 v[88:89], v241 offset:8192
  ds_read_b64_tr_b16 v[90:91], v241 offset:10240
  s_xor_b32 s99, s19, 10240
  buffer_load_dwordx4 v[136:139], v234, s[44:47], s99 offen sc1
  s_waitcnt vmcnt(6) lgkmcnt(8)
  v_mfma_f32_32x32x16_bf16 v[24:39], v[92:95], v[116:119], v[24:39]
  v_and_b32 v244, 0xffff0000, v193
  v_mul_f32 v251, v251, v5
  v_mul_f32 v244, v244, v5
  v_cvt_pk_bf16_f32 v193, v251, v244
  v_lshlrev_b32 v251, 16, v66
  v_and_b32 v244, 0xffff0000, v66
  v_sub_f32 v251, v251, v4
  v_sub_f32 v244, v244, v4
  v_cvt_pk_bf16_f32 v194, v251, v244
  ds_read_b64_tr_b16 v[48:49], v249 offset:8192
  ds_read_b64_tr_b16 v[50:51], v249 offset:10240
  s_waitcnt lgkmcnt(8)
  v_mfma_f32_32x32x16_bf16 v[8:23], v[40:43], v[108:111], v[8:23]
  v_lshlrev_b32 v251, 16, v194
  v_and_b32 v244, 0xffff0000, v194
  v_mul_f32 v251, v251, v5
  v_mul_f32 v244, v244, v5
  v_cvt_pk_bf16_f32 v194, v251, v244
  v_lshlrev_b32 v251, 16, v67
  v_and_b32 v244, 0xffff0000, v67
  v_sub_f32 v251, v251, v4
  v_sub_f32 v244, v244, v4
  v_add_f32 v52, v52, v54
  v_add_f32 v53, v53, v55
  v_add_f32 v56, v56, v58
  v_add_f32 v57, v57, v59
  v_add_f32 v52, v52, v56
  v_add_f32 v53, v53, v57
  v_mov_b32 v54, v52
  v_mov_b32 v55, v53
  s_nop 0
  v_permlane32_swap_b32 v52, v54
  v_permlane32_swap_b32 v53, v55
  v_add_f32 v52, v52, v54
  v_add_f32 v53, v53, v55
  ds_write_b64 v229, v[52:53]
  v_xor_b32 v229, 256, v229
  ds_read_b64_tr_b16 v[92:93], v246 offset:16384
  ds_read_b64_tr_b16 v[94:95], v246 offset:18432
  s_xor_b32 s99, s19, 11264
  buffer_load_dwordx4 v[140:143], v234, s[44:47], s99 offen sc1
  s_waitcnt vmcnt(6) lgkmcnt(9)
  v_mfma_f32_32x32x16_bf16 v[24:39], v[60:63], v[120:123], v[24:39]
  v_cvt_pk_bf16_f32 v195, v251, v244
  v_lshlrev_b32 v251, 16, v195
  v_and_b32 v244, 0xffff0000, v195
  v_mul_f32 v251, v251, v5
  v_mul_f32 v244, v244, v5
  v_cvt_pk_bf16_f32 v195, v251, v244
  v_lshlrev_b32 v243, 16, v192
  v_and_b32 v240, 0xffff0000, v192
  v_lshlrev_b32 v184, 16, v68
  ds_read_b64_tr_b16 v[40:41], v248 offset:8192
  ds_read_b64_tr_b16 v[42:43], v248 offset:10240
  s_waitcnt lgkmcnt(9)
  v_mfma_f32_32x32x16_bf16 v[8:23], v[44:47], v[112:115], v[8:23]
  v_and_b32 v185, 0xffff0000, v68
  v_mul_f32 v243, v243, v184
  v_mul_f32 v240, v240, v185
  v_cvt_pk_bf16_f32 v185, v243, v240
  v_lshlrev_b32 v184, 16, v185
  v_and_b32 v185, 0xffff0000, v185
  v_lshlrev_b32 v243, 16, v193
  v_and_b32 v240, 0xffff0000, v193
  v_lshlrev_b32 v186, 16, v69
  ds_read_b64_tr_b16 v[60:61], v245 offset:16384
  ds_read_b64_tr_b16 v[62:63], v245 offset:18432
  s_xor_b32 s99, s19, 12288
  buffer_load_dwordx4 v[144:147], v234, s[44:47], s99 offen sc1
  s_waitcnt vmcnt(6) lgkmcnt(9)
  v_mfma_f32_32x32x16_bf16 v[24:39], v[88:91], v[124:127], v[24:39]
  v_and_b32 v187, 0xffff0000, v69
  v_mul_f32 v243, v243, v186
  v_mul_f32 v240, v240, v187
  v_cvt_pk_bf16_f32 v187, v243, v240
  v_lshlrev_b32 v186, 16, v187
  v_and_b32 v187, 0xffff0000, v187
  v_lshlrev_b32 v243, 16, v194
  v_and_b32 v240, 0xffff0000, v194
  v_lshlrev_b32 v188, 16, v70
  ds_read_b64_tr_b16 v[44:45], v247 offset:8192
  ds_read_b64_tr_b16 v[46:47], v247 offset:10240
  s_waitcnt lgkmcnt(9)
  v_mfma_f32_32x32x16_bf16 v[8:23], v[48:51], v[116:119], v[8:23]
  v_and_b32 v189, 0xffff0000, v70
  v_mul_f32 v243, v243, v188
  v_mul_f32 v240, v240, v189
  v_cvt_pk_bf16_f32 v189, v243, v240
  v_lshlrev_b32 v188, 16, v189
  v_and_b32 v189, 0xffff0000, v189
  v_lshlrev_b32 v243, 16, v195
  v_and_b32 v240, 0xffff0000, v195
  v_lshlrev_b32 v190, 16, v71
  ds_read_b64_tr_b16 v[88:89], v242 offset:16384
  ds_read_b64_tr_b16 v[90:91], v242 offset:18432
  s_xor_b32 s99, s19, 13312
  buffer_load_dwordx4 v[148:151], v234, s[44:47], s99 offen sc1
  s_waitcnt vmcnt(6) lgkmcnt(8)
  v_mfma_f32_32x32x16_bf16 v[24:39], v[92:95], v[128:131], v[24:39]
  v_and_b32 v191, 0xffff0000, v71
  v_mul_f32 v243, v243, v190
  v_mul_f32 v240, v240, v191
  v_cvt_pk_bf16_f32 v191, v243, v240
  v_lshlrev_b32 v190, 16, v191
  v_and_b32 v191, 0xffff0000, v191
  ds_read_b64_tr_b16 v[48:49], v250 offset:16384
  ds_read_b64_tr_b16 v[50:51], v250 offset:18432
  s_waitcnt lgkmcnt(8)
  v_mfma_f32_32x32x16_bf16 v[8:23], v[40:43], v[120:123], v[8:23]
  ds_read_b64_tr_b16 v[92:93], v241 offset:16384
  ds_read_b64_tr_b16 v[94:95], v241 offset:18432
  s_xor_b32 s99, s19, 14336
  buffer_load_dwordx4 v[152:155], v234, s[44:47], s99 offen sc1
  s_waitcnt vmcnt(6) lgkmcnt(8)
  v_mfma_f32_32x32x16_bf16 v[24:39], v[60:63], v[132:135], v[24:39]
  ds_read_b64_tr_b16 v[40:41], v249 offset:16384
  ds_read_b64_tr_b16 v[42:43], v249 offset:18432
  s_waitcnt lgkmcnt(8)
  v_mfma_f32_32x32x16_bf16 v[8:23], v[44:47], v[124:127], v[8:23]
  s_barrier
  ds_read_b64_tr_b16 v[60:61], v246 offset:24576
  ds_read_b64_tr_b16 v[62:63], v246 offset:26624
  s_xor_b32 s99, s19, 15360
  buffer_load_dwordx4 v[156:159], v234, s[44:47], s99 offen sc1
  s_waitcnt vmcnt(5) lgkmcnt(8)
  v_mfma_f32_32x32x16_bf16 v[24:39], v[88:91], v[136:139], v[24:39]
  ds_read_b64 v[54:55], v229
  s_waitcnt lgkmcnt(0)
  v_add_f32 v52, v52, v54
  v_add_f32 v53, v53, v55
  v_mul_f32 v56, 0x3b000000, v52
  v_mul_f32 v57, v56, v56
  v_fma_f32 v57, v53, s76, -v57
  v_max_f32 v57, 0, v57
  ds_read_b64_tr_b16 v[44:45], v248 offset:16384
  ds_read_b64_tr_b16 v[46:47], v248 offset:18432
  v_mfma_f32_32x32x16_bf16 v[8:23], v[48:51], v[128:131], v[8:23]
  v_cvt_pk_bf16_f32 v180, -v56, -v56
  v_cvt_pk_bf16_f32 v57, v57, v57
  v_and_b32 v57, 0xffff0000, v57
  v_add_f32 v57, 0x3727c5ac, v57
  v_mov_b32 v181, v180
  v_cvt_pk_bf16_f32 v57, v57, v57
  v_and_b32 v57, 0xffff0000, v57
  ds_read_b64_tr_b16 v[88:89], v245 offset:24576
  ds_read_b64_tr_b16 v[90:91], v245 offset:26624
  s_add_u32 m0, s75, 32768
  s_xor_b32 s100, s3, 0
  buffer_load_dwordx4 v253, s[56:59], s100 offen lds
  s_waitcnt vmcnt(5)
  v_mfma_f32_32x32x16_bf16 v[24:39], v[92:95], v[140:143], v[24:39]
  v_sqrt_f32 v57, v57
  s_nop 0
  v_cvt_pk_bf16_f32 v178, v57, v57
  v_and_b32 v178, 0xffff0000, v178
  v_rcp_f32 v56, v178
  s_nop 0
  v_mul_f32 v177, 0xc0135761, v56
  ds_read_b64_tr_b16 v[48:49], v247 offset:16384
  ds_read_b64_tr_b16 v[50:51], v247 offset:18432
  v_mfma_f32_32x32x16_bf16 v[8:23], v[40:43], v[132:135], v[8:23]
  v_mul_f32 v57, v56, v56
  v_mul_f32 v57, 0x3d372713, v57
  v_mul_f32 v176, v57, v177
  ds_read2st64_b32 v[72:73], v227 offset0:0 offset1:2
  ds_read2st64_b32 v[74:75], v227 offset0:4 offset1:6
  ds_read2st64_b32 v[76:77], v227 offset0:8 offset1:10
  ds_read2st64_b32 v[78:79], v227 offset0:12 offset1:14
  ds_read_b64_tr_b16 v[92:93], v242 offset:24576
  ds_read_b64_tr_b16 v[94:95], v242 offset:26624
  s_add_u32 m0, s75, 40960
  s_xor_b32 s100, s3, 0
  buffer_load_dwordx4 v253, s[48:51], s100 offen lds
  s_waitcnt vmcnt(5)
  v_mfma_f32_32x32x16_bf16 v[24:39], v[60:63], v[144:147], v[24:39]
  ds_read2st64_b32 v[80:81], v227 offset0:1 offset1:3
  ds_read2st64_b32 v[82:83], v227 offset0:5 offset1:7
  ds_read2st64_b32 v[84:85], v227 offset0:9 offset1:11
  ds_read2st64_b32 v[86:87], v227 offset0:13 offset1:15
  v_cmp_gt_u32 vcc, 32, v1
  s_waitcnt lgkmcnt(9)
  v_add_f32 v72, v72, v73
  s_waitcnt lgkmcnt(8)
  v_add_f32 v74, v74, v75
  ds_read_b64_tr_b16 v[40:41], v250 offset:24576
  ds_read_b64_tr_b16 v[42:43], v250 offset:26624
  v_mfma_f32_32x32x16_bf16 v[8:23], v[44:47], v[136:139], v[8:23]
  s_waitcnt lgkmcnt(9)
  v_add_f32 v76, v76, v77
  s_waitcnt lgkmcnt(8)
  v_add_f32 v78, v78, v79
  v_add_f32 v72, v72, v74
  v_add_f32 v76, v76, v78
  v_add_f32 v72, v72, v76
  v_cndmask_b32 v72, 0, v72, vcc
  v_cvt_pk_bf16_f32 v73, v72, v72
  ds_read_b64_tr_b16 v[60:61], v241 offset:24576
  ds_read_b64_tr_b16 v[62:63], v241 offset:26624
  s_add_u32 m0, s75, 147456
  s_mov_b32 s100, s0
  buffer_load_dwordx4 v252, s[52:55], s100 offen lds
  s_waitcnt vmcnt(5)
  v_mfma_f32_32x32x16_bf16 v[24:39], v[88:91], v[148:151], v[24:39]
  v_and_b32 v73, 0xffff0000, v73
  v_sub_f32 v72, v72, v73
  v_cvt_pk_bf16_f32 v74, v72, v72
  v_and_b32 v74, 0xffff0000, v74
  v_sub_f32 v72, v72, v74
  v_cvt_pk_bf16_f32 v2, v73, v74
  v_cvt_pk_bf16_f32 v3, v72, 0
  ds_read_b64_tr_b16 v[44:45], v249 offset:24576
  ds_read_b64_tr_b16 v[46:47], v249 offset:26624
  v_mfma_f32_32x32x16_bf16 v[8:23], v[48:51], v[140:143], v[8:23]
  s_waitcnt lgkmcnt(9)
  v_add_f32 v80, v80, v81
  s_waitcnt lgkmcnt(8)
  v_add_f32 v82, v82, v83
  s_waitcnt lgkmcnt(7)
  v_add_f32 v84, v84, v85
  s_waitcnt lgkmcnt(6)
  v_add_f32 v86, v86, v87
  v_add_f32 v80, v80, v82
  v_add_f32 v84, v84, v86
  v_add_f32 v80, v80, v84
  v_add_u32 v246, s24, v246
  v_add_u32 v245, s24, v245
  v_add_u32 v242, s24, v242
  v_add_u32 v241, s24, v241
  ds_read_b64_tr_b16 v[88:89], v246 offset:0
  ds_read_b64_tr_b16 v[90:91], v246 offset:2048
  s_waitcnt vmcnt(4)
  v_mfma_f32_32x32x16_bf16 v[24:39], v[92:95], v[152:155], v[24:39]
  v_cndmask_b32 v80, 0, v80, vcc
  v_cvt_pk_bf16_f32 v81, v80, v80
  v_and_b32 v81, 0xffff0000, v81
  v_sub_f32 v80, v80, v81
  v_cvt_pk_bf16_f32 v82, v80, v80
  v_and_b32 v82, 0xffff0000, v82
  v_sub_f32 v80, v80, v82
  ds_read_b64_tr_b16 v[48:49], v248 offset:24576
  ds_read_b64_tr_b16 v[50:51], v248 offset:26624
  s_waitcnt lgkmcnt(8)
  v_mfma_f32_32x32x16_bf16 v[8:23], v[40:43], v[144:147], v[8:23]
  v_cvt_pk_bf16_f32 v6, v81, v82
  v_cvt_pk_bf16_f32 v7, v80, 0
  ds_read_b64_tr_b16 v[92:93], v245 offset:0
  ds_read_b64_tr_b16 v[94:95], v245 offset:2048
  s_waitcnt vmcnt(3) lgkmcnt(8)
  v_mfma_f32_32x32x16_bf16 v[24:39], v[60:63], v[156:159], v[24:39]
  v_mfma_f32_32x32x8_bf16 v[8:23], v[2:3], v[180:181], v[8:23]
  ds_read_b64_tr_b16 v[40:41], v247 offset:24576
  ds_read_b64_tr_b16 v[42:43], v247 offset:26624
  s_waitcnt lgkmcnt(8)
  v_mfma_f32_32x32x16_bf16 v[8:23], v[44:47], v[148:151], v[8:23]
  s_nop 6
  ds_write_b128 v231, v[24:27] offset:0
  ds_write_b128 v231, v[28:31] offset:1024
  ds_write_b128 v231, v[32:35] offset:2048
  ds_write_b128 v231, v[36:39] offset:3072
  s_mov_b64 exec, 0xff
  buffer_load_dword v251, v235, s[44:47], s5 offen sc1
  s_mov_b64 exec, -1
  ds_read_b64_tr_b16 v[60:61], v242 offset:0
  ds_read_b64_tr_b16 v[62:63], v242 offset:2048
  s_waitcnt lgkmcnt(12)
  v_mfma_f32_32x32x16_bf16 v[160:175], v[88:91], v[96:99], 0
  v_add_u32 v250, s24, v250
  v_add_u32 v249, s24, v249
  v_add_u32 v248, s24, v248
  v_add_u32 v247, s24, v247
  ds_read_b64_tr_b16 v[44:45], v250 offset:0
  ds_read_b64_tr_b16 v[46:47], v250 offset:2048
  s_waitcnt lgkmcnt(12)
  v_mfma_f32_32x32x16_bf16 v[8:23], v[48:51], v[152:155], v[8:23]
  ds_read_b64_tr_b16 v[88:89], v241 offset:0
  ds_read_b64_tr_b16 v[90:91], v241 offset:2048
  s_waitcnt lgkmcnt(12)
  v_mfma_f32_32x32x16_bf16 v[160:175], v[92:95], v[100:103], v[160:175]
  ds_read_b64_tr_b16 v[48:49], v249 offset:0
  ds_read_b64_tr_b16 v[50:51], v249 offset:2048
  s_waitcnt lgkmcnt(12)
  v_mfma_f32_32x32x16_bf16 v[8:23], v[40:43], v[156:159], v[8:23]
  s_waitcnt lgkmcnt(0)
  s_barrier
  ds_read_b64_tr_b16 v[92:93], v246 offset:8192
  ds_read_b64_tr_b16 v[94:95], v246 offset:10240
  v_mfma_f32_32x32x16_bf16 v[160:175], v[60:63], v[104:107], v[160:175]
  v_xor_b32 v231, 4096, v231
  ds_read_b128 v[24:27], v231 offset:0
  ds_read_b128 v[28:31], v231 offset:1024
  ds_read_b128 v[32:35], v231 offset:2048
  ds_read_b128 v[36:39], v231 offset:3072
  s_waitcnt lgkmcnt(3)
  s_nop 0
  v_add_f32 v8, v8, v24
  v_add_f32 v9, v9, v25
  ds_read_b64_tr_b16 v[40:41], v248 offset:0
  ds_read_b64_tr_b16 v[42:43], v248 offset:2048
  v_mfma_f32_32x32x8_bf16 v[72:87], v[6:7], v[180:181], 0
  v_add_f32 v10, v10, v26
  v_add_f32 v11, v11, v27
  s_waitcnt lgkmcnt(4)
  v_add_f32 v12, v12, v28
  v_add_f32 v13, v13, v29
  v_add_f32 v14, v14, v30
  v_add_f32 v15, v15, v31
  v_mul_f32 v24, v8, v8
  v_mfma_f32_32x32x16_bf16 v[72:87], v[44:47], v[96:99], v[72:87]
  v_mul_f32 v25, v9, v9
  v_mul_f32 v26, v10, v10
  v_mul_f32 v27, v11, v11
  v_mul_f32 v28, v12, v12
  v_mul_f32 v29, v13, v13
  v_mul_f32 v30, v14, v14
  v_mul_f32 v31, v15, v15
  s_add_u32 m0, s75, 16384
  s_xor_b32 s100, s3, 128
  buffer_load_dwordx4 v253, s[56:59], s100 offen lds
  s_add_u32 m0, s75, 24576
  s_xor_b32 s100, s3, 128
  buffer_load_dwordx4 v253, s[48:51], s100 offen lds
  ds_read_b64_tr_b16 v[60:61], v245 offset:8192
  ds_read_b64_tr_b16 v[62:63], v245 offset:10240
  v_mfma_f32_32x32x16_bf16 v[160:175], v[88:91], v[108:111], v[160:175]
  v_fma_f32 v24, v24, v176, v177
  v_fma_f32 v25, v25, v176, v177
  v_fma_f32 v26, v26, v176, v177
  v_fma_f32 v27, v27, v176, v177
  v_fma_f32 v28, v28, v176, v177
  v_fma_f32 v29, v29, v176, v177
  v_fma_f32 v30, v30, v176, v177
  ds_read_b64_tr_b16 v[44:45], v247 offset:0
  ds_read_b64_tr_b16 v[46:47], v247 offset:2048
  v_mfma_f32_32x32x16_bf16 v[72:87], v[48:51], v[100:103], v[72:87]
  v_fma_f32 v31, v31, v176, v177
  v_mul_f32 v24, v24, v8
  v_mul_f32 v25, v25, v9
  v_mul_f32 v26, v26, v10
  v_mul_f32 v27, v27, v11
  v_mul_f32 v28, v28, v12
  v_mul_f32 v29, v29, v13
  s_waitcnt vmcnt(2)
  v_mov_b32 v251, v251
  s_mov_b32 s101, 200000
  s_mov_b64 exec, 0xff
  s_nop 0
L_pl_S3_8011:
  v_cmp_ne_u32 vcc, s72, v251
  s_nop 4
  s_cbranch_vccz L_pd_S3_8012
  buffer_load_dword v251, v235, s[44:47], s5 offen sc1
  s_waitcnt vmcnt(0)
  s_sub_u32 s101, s101, 1
  s_cmp_lg_u32 s101, 0
  s_cbranch_scc1 L_pl_S3_8011
L_pd_S3_8012:
  s_mov_b64 exec, -1
  s_add_u32 m0, s75, 131072
  s_xor_b32 s100, s3, 256
  buffer_load_dwordx4 v253, s[56:59], s100 offen lds
  s_add_u32 m0, s75, 139264
  s_xor_b32 s100, s3, 256
  buffer_load_dwordx4 v253, s[48:51], s100 offen lds
  ds_read_b64_tr_b16 v[88:89], v242 offset:8192
  ds_read_b64_tr_b16 v[90:91], v242 offset:10240
  v_mfma_f32_32x32x16_bf16 v[160:175], v[92:95], v[112:115], v[160:175]
  v_mul_f32 v30, v30, v14
  v_mul_f32 v31, v31, v15
  v_exp_f32 v24, v24
  v_exp_f32 v25, v25
  v_exp_f32 v26, v26
  ds_read_b64_tr_b16 v[48:49], v250 offset:8192
  ds_read_b64_tr_b16 v[50:51], v250 offset:10240
  s_waitcnt lgkmcnt(8)
  v_mfma_f32_32x32x16_bf16 v[72:87], v[40:43], v[104:107], v[72:87]
  v_exp_f32 v27, v27
  v_exp_f32 v28, v28
  v_exp_f32 v29, v29
  v_exp_f32 v30, v30
  s_xor_b32 s100, s8, 0
  buffer_load_dwordx4 v[96:99], v234, s[44:47], s100 offen offset:0 sc1
  ds_read_b64_tr_b16 v[92:93], v241 offset:8192
  ds_read_b64_tr_b16 v[94:95], v241 offset:10240
  s_waitcnt lgkmcnt(8)
  v_mfma_f32_32x32x16_bf16 v[160:175], v[60:63], v[116:119], v[160:175]
  v_exp_f32 v31, v31
  v_fma_f32 v24, v24, v178, v178
  v_fma_f32 v25, v25, v178, v178
  v_fma_f32 v26, v26, v178, v178
  v_fma_f32 v27, v27, v178, v178
  v_fma_f32 v28, v28, v178, v178
  ds_read_b64_tr_b16 v[40:41], v249 offset:8192
  ds_read_b64_tr_b16 v[42:43], v249 offset:10240
  s_waitcnt lgkmcnt(8)
  v_mfma_f32_32x32x16_bf16 v[72:87], v[44:47], v[108:111], v[72:87]
  v_fma_f32 v29, v29, v178, v178
  v_fma_f32 v30, v30, v178, v178
  v_fma_f32 v31, v31, v178, v178
  v_rcp_f32 v24, v24
  v_rcp_f32 v25, v25
  s_xor_b32 s100, s8, 0
  buffer_load_dwordx4 v[100:103], v234, s[44:47], s100 offen offset:1024 sc1
  ds_read_b64_tr_b16 v[60:61], v246 offset:16384
  ds_read_b64_tr_b16 v[62:63], v246 offset:18432
  s_waitcnt lgkmcnt(8)
  v_mfma_f32_32x32x16_bf16 v[160:175], v[88:91], v[120:123], v[160:175]
  v_rcp_f32 v26, v26
  v_rcp_f32 v27, v27
  v_rcp_f32 v28, v28
  v_rcp_f32 v29, v29
  ds_read_b64_tr_b16 v[44:45], v248 offset:8192
  ds_read_b64_tr_b16 v[46:47], v248 offset:10240
  s_waitcnt lgkmcnt(8)
  v_mfma_f32_32x32x16_bf16 v[72:87], v[48:51], v[112:115], v[72:87]
  v_rcp_f32 v30, v30
  v_rcp_f32 v31, v31
  v_mul_f32 v8, v8, v24
  v_mul_f32 v9, v9, v25
  v_mul_f32 v10, v10, v26
  s_xor_b32 s100, s8, 8192
  buffer_load_dwordx4 v[104:107], v234, s[44:47], s100 offen offset:0 sc1
  ds_read_b64_tr_b16 v[88:89], v245 offset:16384
  ds_read_b64_tr_b16 v[90:91], v245 offset:18432
  s_waitcnt lgkmcnt(8)
  v_mfma_f32_32x32x16_bf16 v[160:175], v[92:95], v[124:127], v[160:175]
  v_mul_f32 v11, v11, v27
  v_mul_f32 v12, v12, v28
  v_mul_f32 v13, v13, v29
  v_mul_f32 v14, v14, v30
  v_mul_f32 v15, v15, v31
  v_cvt_pk_bf16_f32 v24, v8, v9
  v_cvt_pk_bf16_f32 v25, v10, v11
  ds_read_b64_tr_b16 v[48:49], v247 offset:8192
  ds_read_b64_tr_b16 v[50:51], v247 offset:10240
  s_waitcnt lgkmcnt(8)
  v_mfma_f32_32x32x16_bf16 v[72:87], v[40:43], v[116:119], v[72:87]
  v_cvt_pk_bf16_f32 v26, v12, v13
  v_cvt_pk_bf16_f32 v27, v14, v15
  buffer_store_dwordx4 v[24:27], v234, s[44:47], s18 offen offset:0 sc1
  v_add_f32 v16, v16, v32
  v_add_f32 v17, v17, v33
  v_add_f32 v18, v18, v34
  v_add_f32 v19, v19, v35
  s_xor_b32 s100, s8, 8192
  buffer_load_dwordx4 v[108:111], v234, s[44:47], s100 offen offset:1024 sc1
  ds_read_b64_tr_b16 v[92:93], v242 offset:16384
  ds_read_b64_tr_b16 v[94:95], v242 offset:18432
  s_waitcnt lgkmcnt(8)
  v_mfma_f32_32x32x16_bf16 v[160:175], v[60:63], v[128:131], v[160:175]
  v_add_f32 v20, v20, v36
  v_add_f32 v21, v21, v37
  v_add_f32 v22, v22, v38
  v_add_f32 v23, v23, v39
  v_mul_f32 v32, v16, v16
  v_mul_f32 v33, v17, v17
  v_mul_f32 v34, v18, v18
  ds_read_b64_tr_b16 v[40:41], v250 offset:16384
  ds_read_b64_tr_b16 v[42:43], v250 offset:18432
  s_waitcnt lgkmcnt(8)
  v_mfma_f32_32x32x16_bf16 v[72:87], v[44:47], v[120:123], v[72:87]
  v_mul_f32 v35, v19, v19
  v_mul_f32 v36, v20, v20
  v_mul_f32 v37, v21, v21
  v_mul_f32 v38, v22, v22
  v_mul_f32 v39, v23, v23
  v_fma_f32 v32, v32, v176, v177
  v_fma_f32 v33, v33, v176, v177
  s_xor_b32 s100, s8, 16384
  buffer_load_dwordx4 v[112:115], v234, s[44:47], s100 offen offset:0 sc1
  ds_read_b64_tr_b16 v[60:61], v241 offset:16384
  ds_read_b64_tr_b16 v[62:63], v241 offset:18432
  s_waitcnt lgkmcnt(8)
  v_mfma_f32_32x32x16_bf16 v[160:175], v[88:91], v[132:135], v[160:175]
  v_fma_f32 v34, v34, v176, v177
  v_fma_f32 v35, v35, v176, v177
  v_fma_f32 v36, v36, v176, v177
  v_fma_f32 v37, v37, v176, v177
  v_fma_f32 v38, v38, v176, v177
  v_fma_f32 v39, v39, v176, v177
  v_mul_f32 v32, v32, v16
  ds_read_b64_tr_b16 v[44:45], v249 offset:16384
  ds_read_b64_tr_b16 v[46:47], v249 offset:18432
  s_waitcnt lgkmcnt(8)
  v_mfma_f32_32x32x16_bf16 v[72:87], v[48:51], v[124:127], v[72:87]
  v_mul_f32 v33, v33, v17
  v_mul_f32 v34, v34, v18
  v_mul_f32 v35, v35, v19
  v_mul_f32 v36, v36, v20
  v_mul_f32 v37, v37, v21
  v_mul_f32 v38, v38, v22
  v_mul_f32 v39, v39, v23
  s_xor_b32 s100, s8, 16384
  buffer_load_dwordx4 v[116:119], v234, s[44:47], s100 offen offset:1024 sc1
  s_barrier
  ds_read_b64_tr_b16 v[88:89], v246 offset:24576
  ds_read_b64_tr_b16 v[90:91], v246 offset:26624
  s_waitcnt lgkmcnt(8)
  v_mfma_f32_32x32x16_bf16 v[160:175], v[92:95], v[136:139], v[160:175]
  v_exp_f32 v32, v32
  v_exp_f32 v33, v33
  v_exp_f32 v34, v34
  v_exp_f32 v35, v35
  ds_read_b64_tr_b16 v[48:49], v248 offset:16384
  ds_read_b64_tr_b16 v[50:51], v248 offset:18432
  s_waitcnt lgkmcnt(8)
  v_mfma_f32_32x32x16_bf16 v[72:87], v[40:43], v[128:131], v[72:87]
  v_exp_f32 v36, v36
  v_exp_f32 v37, v37
  v_exp_f32 v38, v38
  v_exp_f32 v39, v39
  s_add_u32 m0, s75, 0
  s_xor_b32 s100, s3, 384
  buffer_load_dwordx4 v253, s[56:59], s100 offen lds
  ds_read_b64_tr_b16 v[92:93], v245 offset:24576
  ds_read_b64_tr_b16 v[94:95], v245 offset:26624
  s_waitcnt lgkmcnt(8)
  v_mfma_f32_32x32x16_bf16 v[160:175], v[60:63], v[140:143], v[160:175]
  v_fma_f32 v32, v32, v178, v178
  v_fma_f32 v33, v33, v178, v178
  v_fma_f32 v34, v34, v178, v178
  v_fma_f32 v35, v35, v178, v178
  v_fma_f32 v36, v36, v178, v178
  v_fma_f32 v37, v37, v178, v178
  v_fma_f32 v38, v38, v178, v178
  ds_read_b64_tr_b16 v[40:41], v247 offset:16384
  ds_read_b64_tr_b16 v[42:43], v247 offset:18432
  s_waitcnt lgkmcnt(8)
  v_mfma_f32_32x32x16_bf16 v[72:87], v[44:47], v[132:135], v[72:87]
  v_fma_f32 v39, v39, v178, v178
  v_rcp_f32 v32, v32
  v_rcp_f32 v33, v33
  v_rcp_f32 v34, v34
  s_add_u32 m0, s75, 8192
  s_xor_b32 s100, s3, 384
  buffer_load_dwordx4 v253, s[48:51], s100 offen lds
  ds_read_b64_tr_b16 v[60:61], v242 offset:24576
  ds_read_b64_tr_b16 v[62:63], v242 offset:26624
  s_waitcnt lgkmcnt(8)
  v_mfma_f32_32x32x16_bf16 v[160:175], v[88:91], v[144:147], v[160:175]
  v_rcp_f32 v35, v35
  v_rcp_f32 v36, v36
  v_rcp_f32 v37, v37
  v_rcp_f32 v38, v38
  ds_read_b64_tr_b16 v[44:45], v250 offset:24576
  ds_read_b64_tr_b16 v[46:47], v250 offset:26624
  s_waitcnt lgkmcnt(8)
  v_mfma_f32_32x32x16_bf16 v[72:87], v[48:51], v[136:139], v[72:87]
  v_rcp_f32 v39, v39
  v_mul_f32 v16, v16, v32
  v_mul_f32 v17, v17, v33
  v_mul_f32 v18, v18, v34
  v_mul_f32 v19, v19, v35
  v_mul_f32 v20, v20, v36
  s_add_u32 m0, s75, 114688
  s_xor_b32 s100, s3, 512
  buffer_load_dwordx4 v253, s[56:59], s100 offen lds
  ds_read_b64_tr_b16 v[88:89], v241 offset:24576
  ds_read_b64_tr_b16 v[90:91], v241 offset:26624
  s_waitcnt lgkmcnt(8)
  v_mfma_f32_32x32x16_bf16 v[160:175], v[92:95], v[148:151], v[160:175]
  v_mul_f32 v21, v21, v37
  v_mul_f32 v22, v22, v38
  v_mul_f32 v23, v23, v39
  v_cvt_pk_bf16_f32 v32, v16, v17
  v_cvt_pk_bf16_f32 v33, v18, v19
  v_cvt_pk_bf16_f32 v34, v20, v21
  v_cvt_pk_bf16_f32 v35, v22, v23
  ds_read_b64_tr_b16 v[48:49], v249 offset:24576
  ds_read_b64_tr_b16 v[50:51], v249 offset:26624
  s_waitcnt lgkmcnt(8)
  v_mfma_f32_32x32x16_bf16 v[72:87], v[40:43], v[140:143], v[72:87]
  buffer_store_dwordx4 v[32:35], v234, s[44:47], s18 offen offset:1024 sc1
  s_add_u32 s18, s18, 4096
  s_add_u32 m0, s75, 122880
  s_xor_b32 s100, s3, 512
  buffer_load_dwordx4 v253, s[48:51], s100 offen lds
  s_waitcnt lgkmcnt(6)
  v_mfma_f32_32x32x16_bf16 v[160:175], v[60:63], v[152:155], v[160:175]
  ds_read_b64_tr_b16 v[40:41], v248 offset:24576
  ds_read_b64_tr_b16 v[42:43], v248 offset:26624
  s_waitcnt lgkmcnt(6)
  v_mfma_f32_32x32x16_bf16 v[72:87], v[44:47], v[144:147], v[72:87]
  s_xor_b32 s100, s8, 24576
  buffer_load_dwordx4 v[120:123], v234, s[44:47], s100 offen offset:0 sc1
  s_waitcnt lgkmcnt(4)
  v_mfma_f32_32x32x16_bf16 v[160:175], v[88:91], v[156:159], v[160:175]
  ds_read_b64_tr_b16 v[44:45], v247 offset:24576
  ds_read_b64_tr_b16 v[46:47], v247 offset:26624
  s_waitcnt lgkmcnt(4)
  v_mfma_f32_32x32x16_bf16 v[72:87], v[48:51], v[148:151], v[72:87]
  s_nop 7
  ds_write_b128 v230, v[160:163] offset:0
  ds_write_b128 v230, v[164:167] offset:1024
  ds_write_b128 v230, v[168:171] offset:2048
  ds_write_b128 v230, v[172:175] offset:3072
  s_xor_b32 s100, s8, 24576
  buffer_load_dwordx4 v[124:127], v234, s[44:47], s100 offen offset:1024 sc1
  s_waitcnt lgkmcnt(6)
  v_mfma_f32_32x32x16_bf16 v[72:87], v[40:43], v[152:155], v[72:87]
  s_xor_b32 s100, s8, 32768
  buffer_load_dwordx4 v[128:131], v234, s[44:47], s100 offen offset:0 sc1
  s_waitcnt lgkmcnt(4)
  v_mfma_f32_32x32x16_bf16 v[72:87], v[44:47], v[156:159], v[72:87]
  s_xor_b32 s100, s8, 32768
  buffer_load_dwordx4 v[132:135], v234, s[44:47], s100 offen offset:1024 sc1
  s_waitcnt vmcnt(18)
  s_waitcnt vmcnt(16)
  s_waitcnt lgkmcnt(0)
  s_barrier
  v_xor_b32 v230, 4096, v230
  ds_read_b128 v[160:163], v230 offset:0
  ds_read_b128 v[164:167], v230 offset:1024
  ds_read_b128 v[168:171], v230 offset:2048
  ds_read_b128 v[172:175], v230 offset:3072
  ds_read_b128 v[36:39], v226 offset:32768
  ds_read_b128 v[40:43], v226 offset:36864
  s_waitcnt vmcnt(5)
  s_mov_b64 exec, 1
  s_cmp_eq_u32 s80, 0
  s_cbranch_scc1 L_du_S3_2_f
  buffer_store_dword v233, off, s[44:47], s9 sc1
  s_branch L_du_S3_2_d
L_du_S3_2_f:
  buffer_store_dword v233, off, s[44:47], s9
L_du_S3_2_d:
  s_mov_b64 exec, -1
  s_add_u32 s9, s9, 512
  s_add_u32 m0, s75, 65536
  s_xor_b32 s100, s3, 640
  buffer_load_dwordx4 v253, s[56:59], s100 offen lds
  s_add_u32 m0, s75, 73728
  s_xor_b32 s100, s3, 640
  buffer_load_dwordx4 v253, s[48:51], s100 offen lds
  ds_read_b128 v[44:47], v225 offset:32768
  ds_read_b128 v[48:51], v225 offset:36864
  s_add_u32 m0, s75, 98304
  s_xor_b32 s100, s3, 768
  buffer_load_dwordx4 v253, s[56:59], s100 offen lds
  s_waitcnt lgkmcnt(3)
  v_mfma_f32_32x32x16_bf16 v[4:19], v[36:39], v[96:99], 0
  v_add_f32 v72, v72, v160
  v_add_f32 v73, v73, v161
  v_add_f32 v74, v74, v162
  v_add_f32 v75, v75, v163
  v_add_f32 v76, v76, v164
  v_add_f32 v77, v77, v165
  v_add_f32 v78, v78, v166
  v_add_f32 v79, v79, v167
  v_mul_f32 v160, v72, v72
  v_mul_f32 v161, v73, v73
  v_mul_f32 v162, v74, v74
  v_mul_f32 v163, v75, v75
  v_mul_f32 v164, v76, v76
  v_mul_f32 v165, v77, v77
  s_waitcnt lgkmcnt(2)
  v_mfma_f32_32x32x16_bf16 v[20:35], v[40:43], v[96:99], 0
  v_mul_f32 v166, v78, v78
  v_mul_f32 v167, v79, v79
  v_fma_f32 v160, v160, v176, v177
  v_fma_f32 v161, v161, v176, v177
  v_fma_f32 v162, v162, v176, v177
  v_fma_f32 v163, v163, v176, v177
  v_fma_f32 v164, v164, v176, v177
  v_fma_f32 v165, v165, v176, v177
  v_fma_f32 v166, v166, v176, v177
  v_fma_f32 v167, v167, v176, v177
  v_mul_f32 v160, v160, v72
  v_mul_f32 v161, v161, v73
  v_mul_f32 v162, v162, v74
  v_mul_f32 v163, v163, v75
  s_add_u32 m0, s75, 106496
  s_xor_b32 s100, s3, 768
  buffer_load_dwordx4 v253, s[48:51], s100 offen lds
  ds_read_b128 v[52:55], v226 offset:16384
  ds_read_b128 v[56:59], v226 offset:20480
  s_xor_b32 s100, s8, 40960
  buffer_load_dwordx4 v[136:139], v234, s[44:47], s100 offen offset:0 sc1
  s_waitcnt lgkmcnt(3)
  v_mfma_f32_32x32x16_bf16 v[4:19], v[44:47], v[100:103], v[4:19]
  v_mul_f32 v164, v164, v76
  v_mul_f32 v165, v165, v77
  v_mul_f32 v166, v166, v78
  v_mul_f32 v167, v167, v79
  v_exp_f32 v160, v160
  v_exp_f32 v161, v161
  v_exp_f32 v162, v162
  v_exp_f32 v163, v163
  v_exp_f32 v164, v164
  s_waitcnt lgkmcnt(2)
  v_mfma_f32_32x32x16_bf16 v[20:35], v[48:51], v[100:103], v[20:35]
  v_exp_f32 v165, v165
  v_exp_f32 v166, v166
  v_exp_f32 v167, v167
  v_fma_f32 v160, v160, v178, v178
  v_fma_f32 v161, v161, v178, v178
  v_fma_f32 v162, v162, v178, v178
  v_fma_f32 v163, v163, v178, v178
  v_fma_f32 v164, v164, v178, v178
  v_fma_f32 v165, v165, v178, v178
  v_fma_f32 v166, v166, v178, v178
  v_fma_f32 v167, v167, v178, v178
  s_xor_b32 s100, s8, 40960
  buffer_load_dwordx4 v[140:143], v234, s[44:47], s100 offen offset:1024 sc1
  ds_read_b128 v[36:39], v225 offset:16384
  ds_read_b128 v[40:43], v225 offset:20480
  s_xor_b32 s100, s8, 49152
  buffer_load_dwordx4 v[144:147], v234, s[44:47], s100 offen offset:0 sc1
  s_waitcnt lgkmcnt(3)
  v_mfma_f32_32x32x16_bf16 v[4:19], v[52:55], v[104:107], v[4:19]
  v_rcp_f32 v160, v160
  v_rcp_f32 v161, v161
  v_rcp_f32 v162, v162
  v_rcp_f32 v163, v163
  v_rcp_f32 v164, v164
  v_rcp_f32 v165, v165
  v_rcp_f32 v166, v166
  s_waitcnt lgkmcnt(2)
  v_mfma_f32_32x32x16_bf16 v[20:35], v[56:59], v[104:107], v[20:35]
  v_rcp_f32 v167, v167
  v_mul_f32 v72, v72, v160
  v_mul_f32 v73, v73, v161
  v_mul_f32 v74, v74, v162
  v_mul_f32 v75, v75, v163
  v_mul_f32 v76, v76, v164
  v_mul_f32 v77, v77, v165
  v_mul_f32 v78, v78, v166
  v_mul_f32 v79, v79, v167
  v_cvt_pk_bf16_f32 v160, v72, v73
  v_cvt_pk_bf16_f32 v161, v74, v75
  v_cvt_pk_bf16_f32 v162, v76, v77
  v_cvt_pk_bf16_f32 v163, v78, v79
  s_xor_b32 s100, s8, 49152
  buffer_load_dwordx4 v[148:151], v234, s[44:47], s100 offen offset:1024 sc1
  ds_read_b128 v[44:47], v219
  ds_read_b128 v[48:51], v219 offset:4096
  s_xor_b32 s100, s8, 57344
  buffer_load_dwordx4 v[152:155], v234, s[44:47], s100 offen offset:0 sc1
  s_waitcnt lgkmcnt(3)
  v_mfma_f32_32x32x16_bf16 v[4:19], v[36:39], v[108:111], v[4:19]
  buffer_store_dwordx4 v[160:163], v234, s[44:47], s18 offen offset:0 sc1
  v_add_f32 v80, v80, v168
  v_add_f32 v81, v81, v169
  v_add_f32 v82, v82, v170
  v_add_f32 v83, v83, v171
  v_add_f32 v84, v84, v172
  v_add_f32 v85, v85, v173
  v_add_f32 v86, v86, v174
  v_add_f32 v87, v87, v175
  v_mul_f32 v168, v80, v80
  v_mul_f32 v169, v81, v81
  v_mul_f32 v170, v82, v82
  v_mul_f32 v171, v83, v83
  v_mul_f32 v172, v84, v84
  s_waitcnt lgkmcnt(2)
  v_mfma_f32_32x32x16_bf16 v[20:35], v[40:43], v[108:111], v[20:35]
  v_mul_f32 v173, v85, v85
  v_mul_f32 v174, v86, v86
  v_mul_f32 v175, v87, v87
  v_fma_f32 v168, v168, v176, v177
  v_fma_f32 v169, v169, v176, v177
  v_fma_f32 v170, v170, v176, v177
  v_fma_f32 v171, v171, v176, v177
  v_fma_f32 v172, v172, v176, v177
  v_fma_f32 v173, v173, v176, v177
  v_fma_f32 v174, v174, v176, v177
  v_fma_f32 v175, v175, v176, v177
  v_mul_f32 v168, v168, v80
  v_mul_f32 v169, v169, v81
  v_mul_f32 v170, v170, v82
  s_xor_b32 s100, s8, 57344
  buffer_load_dwordx4 v[156:159], v234, s[44:47], s100 offen offset:1024 sc1
  ds_read_b128 v[52:55], v217
  ds_read_b128 v[56:59], v217 offset:4096
  s_waitcnt lgkmcnt(3)
  v_mfma_f32_32x32x16_bf16 v[4:19], v[44:47], v[112:115], v[4:19]
  v_mul_f32 v171, v171, v83
  v_mul_f32 v172, v172, v84
  v_mul_f32 v173, v173, v85
  v_mul_f32 v174, v174, v86
  v_mul_f32 v175, v175, v87
  v_exp_f32 v168, v168
  v_exp_f32 v169, v169
  v_exp_f32 v170, v170
  v_exp_f32 v171, v171
  v_exp_f32 v172, v172
  s_waitcnt lgkmcnt(2)
  v_mfma_f32_32x32x16_bf16 v[20:35], v[48:51], v[112:115], v[20:35]
  v_exp_f32 v173, v173
  v_exp_f32 v174, v174
  v_exp_f32 v175, v175
  v_fma_f32 v168, v168, v178, v178
  v_fma_f32 v169, v169, v178, v178
  v_fma_f32 v170, v170, v178, v178
  v_fma_f32 v171, v171, v178, v178
  v_fma_f32 v172, v172, v178, v178
  v_fma_f32 v173, v173, v178, v178
  v_fma_f32 v174, v174, v178, v178
  v_fma_f32 v175, v175, v178, v178
  v_rcp_f32 v168, v168
  v_rcp_f32 v169, v169
  v_rcp_f32 v170, v170
  v_rcp_f32 v171, v171
  v_rcp_f32 v172, v172
  v_rcp_f32 v173, v173
  v_rcp_f32 v174, v174
  v_rcp_f32 v175, v175
  v_mul_f32 v80, v80, v168
  v_mul_f32 v81, v81, v169
  v_mul_f32 v82, v82, v170
  v_mul_f32 v83, v83, v171
  v_mul_f32 v84, v84, v172
  v_mul_f32 v85, v85, v173
  v_mul_f32 v86, v86, v174
  v_mul_f32 v87, v87, v175
  v_cvt_pk_bf16_f32 v168, v80, v81
  v_cvt_pk_bf16_f32 v169, v82, v83
  v_cvt_pk_bf16_f32 v170, v84, v85
  v_cvt_pk_bf16_f32 v171, v86, v87
  buffer_store_dwordx4 v[168:171], v234, s[44:47], s18 offen offset:1024 sc1
  s_waitcnt vmcnt(17)
  s_waitcnt lgkmcnt(0)
  s_barrier
  ds_read_b128 v[36:39], v226
  ds_read_b128 v[40:43], v226 offset:4096
  s_mov_b64 exec, 0x3fff
  buffer_load_dword v251, v235, s[44:47], s6 offen sc1
  s_mov_b64 exec, -1
  s_add_u32 m0, s75, 16384
  s_xor_b32 s100, s3, 896
  buffer_load_dwordx4 v253, s[56:59], s100 offen lds
  v_mfma_f32_32x32x16_bf16 v[4:19], v[52:55], v[116:119], v[4:19]
  v_mfma_f32_32x32x16_bf16 v[20:35], v[56:59], v[116:119], v[20:35]
  ds_read_b128 v[44:47], v225
  ds_read_b128 v[48:51], v225 offset:4096
  s_add_u32 m0, s75, 24576
  s_xor_b32 s100, s3, 896
  buffer_load_dwordx4 v253, s[48:51], s100 offen lds
  s_waitcnt vmcnt(19) lgkmcnt(3)
  v_mfma_f32_32x32x16_bf16 v[4:19], v[36:39], v[120:123], v[4:19]
  s_waitcnt lgkmcnt(2)
  v_mfma_f32_32x32x16_bf16 v[20:35], v[40:43], v[120:123], v[20:35]
  ds_read_b128 v[52:55], v220 offset:49152
  ds_read_b128 v[56:59], v220 offset:53248
  s_add_u32 m0, s75, 32768
  s_lshl4_add_u32 s100, s11, s74
  buffer_load_dwordx4 v252, s[52:55], s100 offen lds
  s_waitcnt vmcnt(19) lgkmcnt(3)
  v_mfma_f32_32x32x16_bf16 v[4:19], v[44:47], v[124:127], v[4:19]
  s_waitcnt lgkmcnt(2)
  v_mfma_f32_32x32x16_bf16 v[20:35], v[48:51], v[124:127], v[20:35]
  ds_read_b128 v[36:39], v218 offset:49152
  ds_read_b128 v[40:43], v218 offset:53248
  s_waitcnt vmcnt(4)
  s_mov_b64 exec, 1
  s_cmp_eq_u32 s80, 0
  s_cbranch_scc1 L_du_S3_3_f
  buffer_store_dword v233, off, s[44:47], s9 sc1
  s_branch L_du_S3_3_d
L_du_S3_3_f:
  buffer_store_dword v233, off, s[44:47], s9
L_du_S3_3_d:
  s_mov_b64 exec, -1
  s_add_u32 m0, s75, 40960
  s_lshl4_add_u32 s100, s12, s74
  buffer_load_dwordx4 v252, s[52:55], s100 offen lds
  s_waitcnt lgkmcnt(3)
  v_mfma_f32_32x32x16_bf16 v[4:19], v[52:55], v[128:131], v[4:19]
  s_waitcnt lgkmcnt(2)
  v_mfma_f32_32x32x16_bf16 v[20:35], v[56:59], v[128:131], v[20:35]
  s_waitcnt vmcnt(3)
  s_waitcnt lgkmcnt(0)
  s_barrier
  ds_read_b128 v[44:47], v220
  ds_read_b128 v[48:51], v220 offset:4096
  s_add_u32 m0, s75, 0
  s_lshl4_add_u32 s100, s14, s74
  buffer_load_dwordx4 v252, s[52:55], s100 offen lds
  v_mfma_f32_32x32x16_bf16 v[4:19], v[36:39], v[132:135], v[4:19]
  v_mfma_f32_32x32x16_bf16 v[20:35], v[40:43], v[132:135], v[20:35]
  ds_read_b128 v[52:55], v218
  ds_read_b128 v[56:59], v218 offset:4096
  v_mov_b32 v251, v251
  s_mov_b32 s101, 200000
  s_mov_b64 exec, 0x3fff
  s_nop 6
L_pl_S3_15013:
  v_cmp_ne_u32 vcc, s72, v251
  s_nop 4
  s_cbranch_vccz L_pd_S3_15014
  buffer_load_dword v251, v235, s[44:47], s6 offen sc1
  s_waitcnt vmcnt(0)
  s_sub_u32 s101, s101, 1
  s_cmp_lg_u32 s101, 0
  s_cbranch_scc1 L_pl_S3_15013
L_pd_S3_15014:
  s_mov_b64 exec, -1
  buffer_load_dwordx4 v[60:63], v254, s[44:47], s10 offen sc1
  s_waitcnt lgkmcnt(3)
  v_mfma_f32_32x32x16_bf16 v[4:19], v[44:47], v[136:139], v[4:19]
  s_waitcnt lgkmcnt(2)
  v_mfma_f32_32x32x16_bf16 v[20:35], v[48:51], v[136:139], v[20:35]
  ds_read_b128 v[36:39], v220 offset:32768
  ds_read_b128 v[40:43], v220 offset:36864
  buffer_load_dwordx4 v[68:71], v254, s[44:47], s11 offen sc1
  s_waitcnt lgkmcnt(3)
  v_mfma_f32_32x32x16_bf16 v[4:19], v[52:55], v[140:143], v[4:19]
  s_waitcnt lgkmcnt(2)
  v_mfma_f32_32x32x16_bf16 v[20:35], v[56:59], v[140:143], v[20:35]
  ds_read_b128 v[44:47], v218 offset:32768
  ds_read_b128 v[48:51], v218 offset:36864
  buffer_load_dwordx4 v[88:91], v254, s[44:47], s12 offen sc1
  s_waitcnt lgkmcnt(3)
  v_mfma_f32_32x32x16_bf16 v[4:19], v[36:39], v[144:147], v[4:19]
  s_waitcnt lgkmcnt(2)
  v_mfma_f32_32x32x16_bf16 v[20:35], v[40:43], v[144:147], v[20:35]
  ds_read_b128 v[52:55], v226 offset:16384
  ds_read_b128 v[56:59], v226 offset:20480
  buffer_load_dwordx4 v[92:95], v254, s[44:47], s14 offen sc1
  s_waitcnt lgkmcnt(3)
  v_mfma_f32_32x32x16_bf16 v[4:19], v[44:47], v[148:151], v[4:19]
  s_waitcnt lgkmcnt(2)
  v_mfma_f32_32x32x16_bf16 v[20:35], v[48:51], v[148:151], v[20:35]
  ds_read_b128 v[36:39], v225 offset:16384
  ds_read_b128 v[40:43], v225 offset:20480
  s_add_u32 m0, s75, 8192
  s_lshl4_add_u32 s100, s15, s74
  buffer_load_dwordx4 v252, s[52:55], s100 offen lds
  s_waitcnt lgkmcnt(3)
  v_mfma_f32_32x32x16_bf16 v[4:19], v[52:55], v[152:155], v[4:19]
  s_waitcnt lgkmcnt(2)
  v_mfma_f32_32x32x16_bf16 v[20:35], v[56:59], v[152:155], v[20:35]
  s_waitcnt vmcnt(8)
  s_waitcnt vmcnt(6)
  s_waitcnt vmcnt(5)
  s_waitcnt lgkmcnt(0)
  s_barrier
  ds_read_b64_tr_b16 v[44:45], v215 offset:16384
  ds_read_b64_tr_b16 v[46:47], v215 offset:17408
  ds_read_b64_tr_b16 v[48:49], v213 offset:16384
  ds_read_b64_tr_b16 v[50:51], v213 offset:17408
  s_add_u32 m0, s75, 16384
  s_lshl4_add_u32 s100, s16, s74
  buffer_load_dwordx4 v252, s[52:55], s100 offen lds
  v_mfma_f32_32x32x16_bf16 v[4:19], v[36:39], v[156:159], v[4:19]
  v_mfma_f32_32x32x16_bf16 v[20:35], v[40:43], v[156:159], v[20:35]
  s_add_u32 m0, s75, 24576
  s_lshl4_add_u32 s100, s17, s74
  buffer_load_dwordx4 v252, s[52:55], s100 offen lds
  ds_read_b64_tr_b16 v[52:53], v224 offset:32768
  ds_read_b64_tr_b16 v[54:55], v224 offset:33792
  ds_read_b64_tr_b16 v[56:57], v223 offset:32768
  ds_read_b64_tr_b16 v[58:59], v223 offset:33792
  s_add_u32 m0, s75, 49152
  s_lshl4_add_u32 s100, s30, s74
  buffer_load_dwordx4 v252, s[52:55], s100 offen lds
  s_waitcnt vmcnt(7) lgkmcnt(6)
  v_mfma_f32_32x32x16_bf16 v[160:175], v[44:47], v[60:63], 0
  s_waitcnt lgkmcnt(4)
  v_mfma_f32_32x32x16_bf16 v[236:251], v[48:51], v[60:63], 0
  buffer_load_dwordx4 v[96:99], v254, s[44:47], s15 offen sc1
  ds_read_b64_tr_b16 v[36:37], v224 offset:40960
  ds_read_b64_tr_b16 v[38:39], v224 offset:41984
  ds_read_b64_tr_b16 v[40:41], v223 offset:40960
  ds_read_b64_tr_b16 v[42:43], v223 offset:41984
  buffer_load_dwordx2 v[176:177], v206, s[44:47], s69 offen sc1
  buffer_load_dwordx2 v[178:179], v206, s[44:47], s69 offen offset:2048 sc1
  buffer_load_dwordx4 v[100:103], v254, s[44:47], s16 offen sc1
  s_waitcnt vmcnt(10) lgkmcnt(6)
  v_mfma_f32_32x32x16_bf16 v[160:175], v[52:55], v[68:71], v[160:175]
  s_waitcnt lgkmcnt(4)
  v_mfma_f32_32x32x16_bf16 v[236:251], v[56:59], v[68:71], v[236:251]
  buffer_load_dwordx4 v[104:107], v254, s[44:47], s17 offen sc1
  ds_read_b64_tr_b16 v[44:45], v224
  ds_read_b64_tr_b16 v[46:47], v224 offset:1024
  ds_read_b64_tr_b16 v[48:49], v223
  ds_read_b64_tr_b16 v[50:51], v223 offset:1024
  buffer_load_dwordx4 v[108:111], v254, s[44:47], s30 offen sc1
  s_waitcnt vmcnt(11) lgkmcnt(6)
  v_mfma_f32_32x32x16_bf16 v[160:175], v[36:39], v[88:91], v[160:175]
  s_waitcnt lgkmcnt(4)
  v_mfma_f32_32x32x16_bf16 v[236:251], v[40:43], v[88:91], v[236:251]
  s_add_u32 m0, s75, 57344
  s_lshl4_add_u32 s100, s31, s74
  buffer_load_dwordx4 v252, s[52:55], s100 offen lds
  s_waitcnt vmcnt(10)
  s_waitcnt vmcnt(9)
  s_waitcnt vmcnt(8)
  s_waitcnt vmcnt(7)
  s_waitcnt lgkmcnt(0)
  s_barrier
  ds_read_b64_tr_b16 v[52:53], v224 offset:8192
  ds_read_b64_tr_b16 v[54:55], v224 offset:9216
  ds_read_b64_tr_b16 v[56:57], v223 offset:8192
  ds_read_b64_tr_b16 v[58:59], v223 offset:9216
  s_add_u32 s6, s6, 512
  s_mov_b64 exec, 0x3fff
  buffer_load_dword v231, v235, s[44:47], s6 offen sc1
  s_mov_b64 exec, -1
  s_add_u32 m0, s75, 73728
  s_lshl4_add_u32 s100, s89, s74
  buffer_load_dwordx4 v252, s[52:55], s100 offen lds
  v_mfma_f32_32x32x16_bf16 v[160:175], v[44:47], v[92:95], v[160:175]
  v_mfma_f32_32x32x16_bf16 v[236:251], v[48:51], v[92:95], v[236:251]
  s_mov_b32 s92, 0
  s_cmp_eq_u32 s83, 1
  s_cselect_b32 s92, 32768, s92
  s_cmp_eq_u32 s83, 2
  s_cselect_b32 s92, 40960, s92
  s_add_u32 m0, s75, 81920
  s_lshl4_add_u32 s100, s90, s74
  buffer_load_dwordx4 v252, s[52:55], s100 offen lds
  ds_read_b64_tr_b16 v[36:37], v224 offset:16384
  ds_read_b64_tr_b16 v[38:39], v224 offset:17408
  ds_read_b64_tr_b16 v[40:41], v223 offset:16384
  ds_read_b64_tr_b16 v[42:43], v223 offset:17408
  s_add_u32 m0, s75, 90112
  s_lshl4_add_u32 s100, s91, s74
  buffer_load_dwordx4 v252, s[52:55], s100 offen lds
  s_waitcnt vmcnt(10) lgkmcnt(6)
  v_mfma_f32_32x32x16_bf16 v[160:175], v[52:55], v[96:99], v[160:175]
  s_cmp_eq_u32 s83, 3
  s_cselect_b32 s92, 65536, s92
  v_add_u32 v180, s92, v222
  v_xor_b32 v181, 32, v180
  v_xor_b32 v182, 64, v180
  s_waitcnt lgkmcnt(4)
  v_mfma_f32_32x32x16_bf16 v[236:251], v[56:59], v[96:99], v[236:251]
  v_xor_b32 v183, 96, v180
  ds_write_b128 v180, v[4:7]
  ds_write_b128 v181, v[8:11]
  ds_write_b128 v182, v[12:15]
  ds_write_b128 v183, v[16:19]
  buffer_load_dwordx4 v[112:115], v254, s[44:47], s31 offen sc1
  ds_read_b64_tr_b16 v[44:45], v224 offset:24576
  ds_read_b64_tr_b16 v[46:47], v224 offset:25600
  ds_read_b64_tr_b16 v[48:49], v223 offset:24576
  ds_read_b64_tr_b16 v[50:51], v223 offset:25600
  buffer_load_dwordx4 v[72:75], v254, s[44:47], s89 offen sc1
  s_waitcnt vmcnt(9) lgkmcnt(10)
  v_mfma_f32_32x32x16_bf16 v[160:175], v[36:39], v[100:103], v[160:175]
  s_waitcnt lgkmcnt(8)
  v_mfma_f32_32x32x16_bf16 v[236:251], v[40:43], v[100:103], v[236:251]
  buffer_load_dwordx4 v[76:79], v254, s[44:47], s90 offen sc1
  ds_read_b64_tr_b16 v[52:53], v224 offset:49152
  ds_read_b64_tr_b16 v[54:55], v224 offset:50176
  ds_read_b64_tr_b16 v[56:57], v223 offset:49152
  ds_read_b64_tr_b16 v[58:59], v223 offset:50176
  buffer_load_dwordx4 v[80:83], v254, s[44:47], s91 offen sc1
  s_waitcnt vmcnt(10) lgkmcnt(6)
  v_mfma_f32_32x32x16_bf16 v[160:175], v[44:47], v[104:107], v[160:175]
  s_waitcnt lgkmcnt(4)
  v_mfma_f32_32x32x16_bf16 v[236:251], v[48:51], v[104:107], v[236:251]
  s_add_u32 m0, s75, 98304
  s_lshl4_add_u32 s100, s87, s74
  buffer_load_dwordx4 v252, s[52:55], s100 offen lds
  s_waitcnt vmcnt(9)
  s_waitcnt vmcnt(7)
  s_waitcnt vmcnt(6)
  s_waitcnt vmcnt(5)
  s_waitcnt lgkmcnt(0)
  s_barrier
  ds_read_b64_tr_b16 v[36:37], v224 offset:57344
  ds_read_b64_tr_b16 v[38:39], v224 offset:58368
  ds_read_b64_tr_b16 v[40:41], v223 offset:57344
  ds_read_b64_tr_b16 v[42:43], v223 offset:58368
  s_add_u32 m0, s75, 106496
  s_lshl4_add_u32 s100, s82, s74
  buffer_load_dwordx4 v252, s[52:55], s100 offen lds
  v_mfma_f32_32x32x16_bf16 v[160:175], v[52:55], v[108:111], v[160:175]
  v_mfma_f32_32x32x16_bf16 v[236:251], v[56:59], v[108:111], v[236:251]
  ds_read_b128 v[4:7], v221
  ds_read_b128 v[8:11], v221 offset:32768
  ds_read_b128 v[12:15], v221 offset:40960
  ds_read_b128 v[16:19], v211
  s_waitcnt lgkmcnt(2)
  v_add_f32 v4, v4, v8
  s_add_u32 m0, s75, 114688
  v_add_u32 v252, 0x10000, v252
  s_lshl4_add_u32 s100, s10, s74
  buffer_load_dwordx4 v252, s[52:55], s100 offen lds
  ds_read_b64_tr_b16 v[44:45], v216 offset:8192
  ds_read_b64_tr_b16 v[46:47], v216 offset:9216
  ds_read_b64_tr_b16 v[48:49], v214 offset:8192
  ds_read_b64_tr_b16 v[50:51], v214 offset:9216
  v_mov_b32 v231, v231
  s_mov_b32 s101, 200000
  s_mov_b64 exec, 0x3fff
  s_nop 0
L_pl_S3_21015:
  v_cmp_ne_u32 vcc, s72, v231
  s_nop 4
  s_cbranch_vccz L_pd_S3_21016
  buffer_load_dword v231, v235, s[44:47], s6 offen sc1
  s_waitcnt vmcnt(0)
  s_sub_u32 s101, s101, 1
  s_cmp_lg_u32 s101, 0
  s_cbranch_scc1 L_pl_S3_21015
L_pd_S3_21016:
  s_mov_b64 exec, -1
  s_add_u32 m0, s75, 122880
  s_lshl4_add_u32 s100, s11, s74
  buffer_load_dwordx4 v252, s[52:55], s100 offen lds
  s_waitcnt vmcnt(7)
  v_mfma_f32_32x32x16_bf16 v[160:175], v[36:39], v[112:115], v[160:175]
  s_waitcnt lgkmcnt(4)
  v_add_f32 v12, v12, v16
  v_add_f32 v5, v5, v9
  v_add_f32 v13, v13, v17
  v_add_f32 v6, v6, v10
  v_add_f32 v14, v14, v18
  v_mfma_f32_32x32x16_bf16 v[236:251], v[40:43], v[112:115], v[236:251]
  v_add_f32 v7, v7, v11
  v_add_f32 v15, v15, v19
  v_add_f32 v4, v4, v12
  v_add_f32 v5, v5, v13
  v_add_f32 v6, v6, v14
  buffer_load_dwordx4 v[84:87], v254, s[44:47], s87 offen sc1
  ds_read_b64_tr_b16 v[52:53], v216 offset:16384
  ds_read_b64_tr_b16 v[54:55], v216 offset:17408
  ds_read_b64_tr_b16 v[56:57], v214 offset:16384
  ds_read_b64_tr_b16 v[58:59], v214 offset:17408
  buffer_load_dwordx4 v[116:119], v254, s[44:47], s82 offen sc1
  s_waitcnt vmcnt(8) lgkmcnt(6)
  v_mfma_f32_32x32x16_bf16 v[160:175], v[44:47], v[72:75], v[160:175]
  v_add_f32 v7, v7, v15
  v_add_f32 v4, v4, v184
  v_add_f32 v5, v5, v185
  v_add_f32 v6, v6, v186
  v_add_f32 v7, v7, v187
  s_waitcnt lgkmcnt(4)
  v_mfma_f32_32x32x16_bf16 v[236:251], v[48:51], v[72:75], v[236:251]
  v_lshlrev_b32 v8, 16, v64
  v_and_b32 v9, 0xffff0000, v64
  v_lshlrev_b32 v12, 16, v176
  v_and_b32 v13, 0xffff0000, v176
  v_lshlrev_b32 v10, 16, v65
  v_add_u32 v254, 0x1000, v254
  buffer_load_dwordx4 v[120:123], v254, s[44:47], s10 offen sc1
  ds_read_b64_tr_b16 v[36:37], v216 offset:24576
  ds_read_b64_tr_b16 v[38:39], v216 offset:25600
  ds_read_b64_tr_b16 v[40:41], v214 offset:24576
  ds_read_b64_tr_b16 v[42:43], v214 offset:25600
  buffer_load_dwordx4 v[124:127], v254, s[44:47], s11 offen sc1
  s_waitcnt vmcnt(9) lgkmcnt(6)
  v_mfma_f32_32x32x16_bf16 v[160:175], v[52:55], v[76:79], v[160:175]
  v_and_b32 v11, 0xffff0000, v65
  v_lshlrev_b32 v14, 16, v177
  v_and_b32 v15, 0xffff0000, v177
  s_mov_b32 s92, 8192
  s_cmp_eq_u32 s83, 1
  s_cselect_b32 s92, 16384, s92
  s_waitcnt lgkmcnt(4)
  v_mfma_f32_32x32x16_bf16 v[236:251], v[56:59], v[76:79], v[236:251]
  s_cmp_eq_u32 s83, 2
  s_cselect_b32 s92, 24576, s92
  s_cmp_eq_u32 s83, 3
  s_cselect_b32 s92, 49152, s92
  v_add_u32 v180, s92, v222
  s_add_u32 m0, s75, 131072
  s_lshl4_add_u32 s100, s12, s74
  buffer_load_dwordx4 v252, s[52:55], s100 offen lds
  v_xor_b32 v181, 32, v180
  v_xor_b32 v182, 64, v180
  v_xor_b32 v183, 96, v180
  ds_write_b128 v180, v[20:23]
  ds_write_b128 v181, v[24:27]
  ds_write_b128 v182, v[28:31]
  ds_write_b128 v183, v[32:35]
  s_waitcnt vmcnt(8)
  s_waitcnt vmcnt(7)
  s_waitcnt vmcnt(6)
  s_waitcnt vmcnt(5)
  s_waitcnt lgkmcnt(0)
  s_barrier
  ds_read_b64_tr_b16 v[44:45], v216 offset:32768
  ds_read_b64_tr_b16 v[46:47], v216 offset:33792
  ds_read_b64_tr_b16 v[48:49], v214 offset:32768
  ds_read_b64_tr_b16 v[50:51], v214 offset:33792
  s_add_u32 m0, s75, 0
  s_lshl4_add_u32 s100, s14, s74
  buffer_load_dwordx4 v252, s[52:55], s100 offen lds
  v_mfma_f32_32x32x16_bf16 v[160:175], v[36:39], v[80:83], v[160:175]
  v_mfma_f32_32x32x16_bf16 v[236:251], v[40:43], v[80:83], v[236:251]
  ds_read_b128 v[20:23], v221 offset:8192
  ds_read_b128 v[24:27], v221 offset:16384
  ds_read_b128 v[28:31], v221 offset:24576
  ds_read_b128 v[32:35], v221 offset:49152
  s_waitcnt lgkmcnt(2)
  v_add_f32 v20, v20, v24
  s_add_u32 m0, s75, 32768
  s_lshl4_add_u32 s100, s15, s74
  buffer_load_dwordx4 v252, s[52:55], s100 offen lds
  ds_read_b64_tr_b16 v[52:53], v216 offset:40960
  ds_read_b64_tr_b16 v[54:55], v216 offset:41984
  ds_read_b64_tr_b16 v[56:57], v214 offset:40960
  ds_read_b64_tr_b16 v[58:59], v214 offset:41984
  s_add_u32 m0, s75, 40960
  s_lshl4_add_u32 s100, s16, s74
  buffer_load_dwordx4 v252, s[52:55], s100 offen lds
  s_waitcnt vmcnt(7)
  v_mfma_f32_32x32x16_bf16 v[160:175], v[44:47], v[84:87], v[160:175]
  s_waitcnt lgkmcnt(4)
  v_add_f32 v28, v28, v32
  v_add_f32 v21, v21, v25
  v_add_f32 v29, v29, v33
  v_add_f32 v22, v22, v26
  v_add_f32 v30, v30, v34
  v_mfma_f32_32x32x16_bf16 v[236:251], v[48:51], v[84:87], v[236:251]
  v_add_f32 v23, v23, v27
  v_add_f32 v31, v31, v35
  v_add_f32 v20, v20, v28
  v_add_f32 v21, v21, v29
  v_add_f32 v22, v22, v30
  buffer_load_dwordx4 v[128:131], v254, s[44:47], s12 offen sc1
  ds_read_b64_tr_b16 v[36:37], v216 offset:49152
  ds_read_b64_tr_b16 v[38:39], v216 offset:50176
  ds_read_b64_tr_b16 v[40:41], v214 offset:49152
  ds_read_b64_tr_b16 v[42:43], v214 offset:50176
  buffer_load_dwordx4 v[132:135], v254, s[44:47], s14 offen sc1
  s_waitcnt vmcnt(8) lgkmcnt(6)
  v_mfma_f32_32x32x16_bf16 v[160:175], v[52:55], v[116:119], v[160:175]
  v_add_f32 v23, v23, v31
  v_add_f32 v20, v20, v188
  v_add_f32 v21, v21, v189
  v_add_f32 v22, v22, v190
  v_add_f32 v23, v23, v191
  s_waitcnt lgkmcnt(4)
  v_mfma_f32_32x32x16_bf16 v[236:251], v[56:59], v[116:119], v[236:251]
  v_lshlrev_b32 v24, 16, v66
  v_and_b32 v25, 0xffff0000, v66
  v_lshlrev_b32 v28, 16, v178
  v_and_b32 v29, 0xffff0000, v178
  v_lshlrev_b32 v26, 16, v67
  buffer_load_dwordx4 v[136:139], v254, s[44:47], s15 offen sc1
  ds_read_b64_tr_b16 v[44:45], v216 offset:57344
  ds_read_b64_tr_b16 v[46:47], v216 offset:58368
  ds_read_b64_tr_b16 v[48:49], v214 offset:57344
  ds_read_b64_tr_b16 v[50:51], v214 offset:58368
  buffer_load_dwordx4 v[140:143], v254, s[44:47], s16 offen sc1
  s_waitcnt vmcnt(9) lgkmcnt(6)
  v_mfma_f32_32x32x16_bf16 v[160:175], v[36:39], v[120:123], v[160:175]
  v_and_b32 v27, 0xffff0000, v67
  v_lshlrev_b32 v30, 16, v179
  v_and_b32 v31, 0xffff0000, v179
  s_waitcnt lgkmcnt(4)
  v_mfma_f32_32x32x16_bf16 v[236:251], v[40:43], v[120:123], v[236:251]
  s_add_u32 m0, s75, 57344
  s_lshl4_add_u32 s100, s17, s74
  buffer_load_dwordx4 v252, s[52:55], s100 offen lds
  s_waitcnt vmcnt(8)
  s_waitcnt vmcnt(7)
  s_waitcnt vmcnt(6)
  s_waitcnt vmcnt(5)
  s_waitcnt lgkmcnt(0)
  s_barrier
  ds_read_b64_tr_b16 v[52:53], v215
  ds_read_b64_tr_b16 v[54:55], v215 offset:1024
  ds_read_b64_tr_b16 v[56:57], v213
  ds_read_b64_tr_b16 v[58:59], v213 offset:1024
  s_add_u32 m0, s75, 8192
  s_lshl4_add_u32 s100, s30, s74
  buffer_load_dwordx4 v252, s[52:55], s100 offen lds
  v_mfma_f32_32x32x16_bf16 v[160:175], v[44:47], v[124:127], v[160:175]
  v_mfma_f32_32x32x16_bf16 v[236:251], v[48:51], v[124:127], v[236:251]
  s_add_u32 m0, s75, 16384
  s_lshl4_add_u32 s100, s31, s74
  buffer_load_dwordx4 v252, s[52:55], s100 offen lds
  ds_read_b64_tr_b16 v[36:37], v224
  ds_read_b64_tr_b16 v[38:39], v224 offset:1024
  ds_read_b64_tr_b16 v[40:41], v223
  ds_read_b64_tr_b16 v[42:43], v223 offset:1024
  s_add_u32 m0, s75, 24576
  s_lshl4_add_u32 s100, s89, s74
  buffer_load_dwordx4 v252, s[52:55], s100 offen lds
  s_waitcnt vmcnt(7) lgkmcnt(6)
  v_mfma_f32_32x32x16_bf16 v[160:175], v[52:55], v[128:131], v[160:175]
  s_waitcnt lgkmcnt(4)
  v_mfma_f32_32x32x16_bf16 v[236:251], v[56:59], v[128:131], v[236:251]
  buffer_load_dwordx4 v[144:147], v254, s[44:47], s17 offen sc1
  ds_read_b64_tr_b16 v[44:45], v224 offset:32768
  ds_read_b64_tr_b16 v[46:47], v224 offset:33792
  ds_read_b64_tr_b16 v[48:49], v223 offset:32768
  ds_read_b64_tr_b16 v[50:51], v223 offset:33792
  buffer_load_dwordx4 v[148:151], v254, s[44:47], s30 offen sc1
  s_waitcnt vmcnt(8) lgkmcnt(6)
  v_mfma_f32_32x32x16_bf16 v[160:175], v[36:39], v[132:135], v[160:175]
  s_waitcnt lgkmcnt(4)
  v_mfma_f32_32x32x16_bf16 v[236:251], v[40:43], v[132:135], v[236:251]
  buffer_load_dwordx4 v[152:155], v254, s[44:47], s31 offen sc1
  ds_read_b64_tr_b16 v[52:53], v224 offset:40960
  ds_read_b64_tr_b16 v[54:55], v224 offset:41984
  ds_read_b64_tr_b16 v[56:57], v223 offset:40960
  ds_read_b64_tr_b16 v[58:59], v223 offset:41984
  buffer_load_dwordx4 v[156:159], v254, s[44:47], s89 offen sc1
  s_waitcnt vmcnt(9) lgkmcnt(6)
  v_mfma_f32_32x32x16_bf16 v[160:175], v[44:47], v[136:139], v[160:175]
  s_waitcnt lgkmcnt(4)
  v_mfma_f32_32x32x16_bf16 v[236:251], v[48:51], v[136:139], v[236:251]
  s_add_u32 m0, s75, 49152
  s_lshl4_add_u32 s100, s90, s74
  buffer_load_dwordx4 v252, s[52:55], s100 offen lds
  s_waitcnt vmcnt(8)
  s_waitcnt vmcnt(7)
  s_waitcnt vmcnt(6)
  s_waitcnt vmcnt(5)
  s_waitcnt lgkmcnt(0)
  s_barrier
  ds_read_b64_tr_b16 v[36:37], v224 offset:57344
  ds_read_b64_tr_b16 v[38:39], v224 offset:58368
  ds_read_b64_tr_b16 v[40:41], v223 offset:57344
  ds_read_b64_tr_b16 v[42:43], v223 offset:58368
  s_add_u32 m0, s75, 0
  s_lshl4_add_u32 s100, s91, s74
  buffer_load_dwordx4 v252, s[52:55], s100 offen lds
  v_mfma_f32_32x32x16_bf16 v[160:175], v[52:55], v[140:143], v[160:175]
  v_mfma_f32_32x32x16_bf16 v[236:251], v[56:59], v[140:143], v[236:251]
  s_add_u32 m0, s75, 32768
  s_lshl4_add_u32 s100, s87, s74
  buffer_load_dwordx4 v252, s[52:55], s100 offen lds
  ds_read_b64_tr_b16 v[44:45], v224 offset:8192
  ds_read_b64_tr_b16 v[46:47], v224 offset:9216
  ds_read_b64_tr_b16 v[48:49], v223 offset:8192
  ds_read_b64_tr_b16 v[50:51], v223 offset:9216
  s_add_u32 m0, s75, 40960
  s_lshl4_add_u32 s100, s82, s74
  buffer_load_dwordx4 v252, s[52:55], s100 offen lds
  s_waitcnt vmcnt(7) lgkmcnt(6)
  v_mfma_f32_32x32x16_bf16 v[160:175], v[36:39], v[144:147], v[160:175]
  s_waitcnt lgkmcnt(4)
  v_mfma_f32_32x32x16_bf16 v[236:251], v[40:43], v[144:147], v[236:251]
  buffer_load_dwordx4 v[60:63], v254, s[44:47], s90 offen sc1
  ds_read_b64_tr_b16 v[52:53], v224 offset:16384
  ds_read_b64_tr_b16 v[54:55], v224 offset:17408
  ds_read_b64_tr_b16 v[56:57], v223 offset:16384
  ds_read_b64_tr_b16 v[58:59], v223 offset:17408
  buffer_load_dwordx4 v[68:71], v254, s[44:47], s91 offen sc1
  s_waitcnt vmcnt(8) lgkmcnt(6)
  v_mfma_f32_32x32x16_bf16 v[160:175], v[44:47], v[148:151], v[160:175]
  s_waitcnt lgkmcnt(4)
  v_mfma_f32_32x32x16_bf16 v[236:251], v[48:51], v[148:151], v[236:251]
  buffer_load_dwordx4 v[88:91], v254, s[44:47], s87 offen sc1
  ds_read_b64_tr_b16 v[36:37], v224 offset:24576
  ds_read_b64_tr_b16 v[38:39], v224 offset:25600
  ds_read_b64_tr_b16 v[40:41], v223 offset:24576
  ds_read_b64_tr_b16 v[42:43], v223 offset:25600
  buffer_load_dwordx4 v[92:95], v254, s[44:47], s82 offen sc1
  s_waitcnt vmcnt(9) lgkmcnt(6)
  v_mfma_f32_32x32x16_bf16 v[160:175], v[52:55], v[152:155], v[160:175]
  s_waitcnt lgkmcnt(4)
  v_mfma_f32_32x32x16_bf16 v[236:251], v[56:59], v[152:155], v[236:251]
  s_waitcnt vmcnt(7)
  s_waitcnt vmcnt(6)
  s_waitcnt vmcnt(5)
  s_waitcnt vmcnt(4)
  s_waitcnt lgkmcnt(0)
  s_barrier
  ds_read_b64_tr_b16 v[44:45], v224 offset:49152
  ds_read_b64_tr_b16 v[46:47], v224 offset:50176
  ds_read_b64_tr_b16 v[48:49], v223 offset:49152
  ds_read_b64_tr_b16 v[50:51], v223 offset:50176
  v_mfma_f32_32x32x16_bf16 v[160:175], v[36:39], v[156:159], v[160:175]
  v_mfma_f32_32x32x16_bf16 v[236:251], v[40:43], v[156:159], v[236:251]
  s_mov_b32 s92, 8192
  s_cmp_eq_u32 s83, 1
  s_cselect_b32 s92, 16384, s92
  s_cmp_eq_u32 s83, 2
  s_cselect_b32 s92, 24576, s92
  ds_read_b64_tr_b16 v[52:53], v224
  ds_read_b64_tr_b16 v[54:55], v224 offset:1024
  ds_read_b64_tr_b16 v[56:57], v223
  ds_read_b64_tr_b16 v[58:59], v223 offset:1024
  s_waitcnt vmcnt(3) lgkmcnt(6)
  v_mfma_f32_32x32x16_bf16 v[160:175], v[44:47], v[60:63], v[160:175]
  s_cmp_eq_u32 s83, 3
  s_cselect_b32 s92, 57344, s92
  v_add_u32 v180, s92, v222
  v_xor_b32 v181, 32, v180
  v_xor_b32 v182, 64, v180
  s_waitcnt lgkmcnt(4)
  v_mfma_f32_32x32x16_bf16 v[236:251], v[48:51], v[60:63], v[236:251]
  v_xor_b32 v183, 96, v180
  s_mov_b32 s92, 65536
  s_cmp_eq_u32 s83, 1
  s_cselect_b32 s92, 73728, s92
  s_cmp_eq_u32 s83, 2
  s_cselect_b32 s92, 81920, s92
  ds_read_b64_tr_b16 v[36:37], v224 offset:32768
  ds_read_b64_tr_b16 v[38:39], v224 offset:33792
  ds_read_b64_tr_b16 v[40:41], v223 offset:32768
  ds_read_b64_tr_b16 v[42:43], v223 offset:33792
  s_waitcnt vmcnt(2) lgkmcnt(6)
  v_mfma_f32_32x32x16_bf16 v[160:175], v[52:55], v[68:71], v[160:175]
  s_cmp_eq_u32 s83, 3
  s_cselect_b32 s92, 90112, s92
  v_add_u32 v192, s92, v222
  v_xor_b32 v193, 32, v192
  v_xor_b32 v194, 64, v192
  s_waitcnt lgkmcnt(4)
  v_mfma_f32_32x32x16_bf16 v[236:251], v[56:59], v[68:71], v[236:251]
  v_xor_b32 v195, 96, v192
  ds_read_b64_tr_b16 v[44:45], v224 offset:40960
  ds_read_b64_tr_b16 v[46:47], v224 offset:41984
  ds_read_b64_tr_b16 v[48:49], v223 offset:40960
  ds_read_b64_tr_b16 v[50:51], v223 offset:41984
  s_waitcnt vmcnt(1) lgkmcnt(6)
  v_mfma_f32_32x32x16_bf16 v[160:175], v[36:39], v[88:91], v[160:175]
  s_waitcnt lgkmcnt(4)
  v_mfma_f32_32x32x16_bf16 v[236:251], v[40:43], v[88:91], v[236:251]
  s_waitcnt vmcnt(0) lgkmcnt(2)
  v_mfma_f32_32x32x16_bf16 v[160:175], v[44:47], v[92:95], v[160:175]
  s_waitcnt lgkmcnt(0)
  v_mfma_f32_32x32x16_bf16 v[236:251], v[48:51], v[92:95], v[236:251]
  s_nop 9
  ds_write_b128 v180, v[160:163]
  ds_write_b128 v181, v[164:167]
  ds_write_b128 v182, v[168:171]
  ds_write_b128 v183, v[172:175]
  ds_write_b128 v192, v[236:239]
  ds_write_b128 v193, v[240:243]
  ds_write_b128 v194, v[244:247]
  ds_write_b128 v195, v[248:251]
  s_waitcnt lgkmcnt(0)
  s_barrier
  ds_read_b128 v[160:163], v221 offset:8192
  ds_read_b128 v[164:167], v221 offset:16384
  ds_read_b128 v[168:171], v221 offset:24576
  ds_read_b128 v[172:175], v221 offset:57344
  s_waitcnt lgkmcnt(2)
  v_add_f32 v160, v160, v164
  s_waitcnt lgkmcnt(0)
  v_add_f32 v168, v168, v172
  v_add_f32 v161, v161, v165
  v_add_f32 v169, v169, v173
  v_add_f32 v162, v162, v166
  v_add_f32 v170, v170, v174
  v_add_f32 v163, v163, v167
  v_add_f32 v171, v171, v175
  v_add_f32 v160, v160, v168
  v_add_f32 v161, v161, v169
  v_add_f32 v162, v162, v170
  v_add_f32 v163, v163, v171
  ds_read_b128 v[236:239], v211
  ds_read_b128 v[240:243], v211 offset:8192
  ds_read_b128 v[244:247], v211 offset:16384
  ds_read_b128 v[248:251], v211 offset:24576
  s_waitcnt lgkmcnt(2)
  v_add_f32 v236, v236, v240
  s_waitcnt lgkmcnt(0)
  v_add_f32 v244, v244, v248
  v_add_f32 v237, v237, v241
  v_add_f32 v245, v245, v249
  v_add_f32 v238, v238, v242
  v_add_f32 v246, v246, v250
  v_add_f32 v239, v239, v243
  v_add_f32 v247, v247, v251
  v_add_f32 v236, v236, v244
  v_add_f32 v237, v237, v245
  v_add_f32 v238, v238, v246
  v_add_f32 v239, v239, v247
  v_add_f32 v160, v160, v12
  v_add_f32 v161, v161, v13
  v_add_f32 v162, v162, v14
  v_add_f32 v163, v163, v15
  v_mul_f32 v164, 0xbfb8aa3b, v160
  v_mul_f32 v165, 0xbfb8aa3b, v161
  v_mul_f32 v166, 0xbfb8aa3b, v162
  v_mul_f32 v167, 0xbfb8aa3b, v163
  v_exp_f32 v164, v164
  v_exp_f32 v165, v165
  v_exp_f32 v166, v166
  v_exp_f32 v167, v167
  v_mul_f32 v160, v160, v4
  v_mul_f32 v161, v161, v5
  v_mul_f32 v162, v162, v6
  v_mul_f32 v163, v163, v7
  v_add_f32 v164, 1.0, v164
  v_add_f32 v165, 1.0, v165
  v_add_f32 v166, 1.0, v166
  v_add_f32 v167, 1.0, v167
  v_rcp_f32 v164, v164
  v_rcp_f32 v165, v165
  v_rcp_f32 v166, v166
  v_rcp_f32 v167, v167
  v_fma_f32 v164, v160, v164, v8
  v_fma_f32 v165, v161, v165, v9
  v_fma_f32 v166, v162, v166, v10
  v_fma_f32 v167, v163, v167, v11
  buffer_store_dwordx4 v[164:167], v207, s[64:67], s88 offen offset:0 sc0 sc1 nt
  v_add_f32 v236, v236, v28
  v_add_f32 v237, v237, v29
  v_add_f32 v238, v238, v30
  v_add_f32 v239, v239, v31
  v_mul_f32 v240, 0xbfb8aa3b, v236
  v_mul_f32 v241, 0xbfb8aa3b, v237
  v_mul_f32 v242, 0xbfb8aa3b, v238
  v_mul_f32 v243, 0xbfb8aa3b, v239
  v_exp_f32 v240, v240
  v_exp_f32 v241, v241
  v_exp_f32 v242, v242
  v_exp_f32 v243, v243
  v_mul_f32 v236, v236, v20
  v_mul_f32 v237, v237, v21
  v_mul_f32 v238, v238, v22
  v_mul_f32 v239, v239, v23
  v_add_f32 v240, 1.0, v240
  v_add_f32 v241, 1.0, v241
  v_add_f32 v242, 1.0, v242
  v_add_f32 v243, 1.0, v243
  v_rcp_f32 v240, v240
  v_rcp_f32 v241, v241
  v_rcp_f32 v242, v242
  v_rcp_f32 v243, v243
  v_fma_f32 v240, v236, v240, v24
  v_fma_f32 v241, v237, v241, v25
  v_fma_f32 v242, v238, v242, v26
  v_fma_f32 v243, v239, v243, v27
  buffer_store_dwordx4 v[240:243], v207, s[64:67], s88 offen offset:128 sc0 sc1 nt
  s_cmp_lg_u32 s2, 143
  s_nop 0
  s_cbranch_scc1 L_nn_S3_29017
  s_cmp_lg_u32 s70, 0
  s_cbranch_scc1 L_nn_S3_29017
  s_mov_b32 s92, 18874368
  s_mov_b64 exec, 1
  buffer_store_dword v233, off, s[44:47], s92 sc1
L_nn_S3_29017:
  s_endpgm
L_pathS0:
  v_and_b32 v244, 31, v1
  v_lshrrev_b32 v243, 5, v1
  s_lshl_b32 s92, s84, 6
  s_add_u32 s92, s92, s79
  v_lshlrev_b32 v242, 1, v244
  s_mov_b32 s64, s6
  s_mov_b32 s65, s7
  s_mov_b32 s66, 1024
  s_mov_b32 s67, 0x00020000
  buffer_load_ushort v240, v242, s[64:67], s92 offen
  s_mov_b32 s64, s8
  s_mov_b32 s65, s9
  s_mov_b32 s66, 1024
  s_mov_b32 s67, 0x00020000
  buffer_load_ushort v239, v242, s[64:67], s92 offen
  s_mov_b32 s64, s18
  s_mov_b32 s65, s19
  s_mov_b32 s66, 1024
  s_mov_b32 s67, 0x00020000
  buffer_load_ushort v238, v242, s[64:67], s92 offen
  s_mov_b32 s76, 0x3b000000
  s_mov_b32 s77, 0xbdd2d3e8
  s_mov_b32 s78, 0x3f803f80
  s_lshl_b32 s81, s68, 12
  s_add_u32 s81, s81, 17825792
  s_getreg_b32 s82, hwreg(HW_REG_XCC_ID)
  s_and_b32 s82, s82, 7
  s_min_u32 s85, s69, 13
  s_lshl_b32 s85, s85, 8
  v_lshlrev_b32 v235, 2, v1
  v_lshlrev_b32 v234, 4, v1
  s_lshr_b32 s92, s2, 5
  s_and_b32 s92, s92, 4
  s_and_b32 s93, s2, 7
  s_xor_b32 s92, s92, s93
  s_lshr_b32 s23, s92, 2
  s_xor_b32 s23, s23, s84
  s_lshr_b32 s93, s69, 2
  s_xor_b32 s34, s92, s93
  s_and_b32 s93, s69, 3
  s_xor_b32 s35, s93, s83
  s_and_b32 s93, s34, 3
  s_lshl_b32 s93, s93, 2
  s_or_b32 s35, s35, s93
  v_bfe_u32 v237, v250, 1, 1
  v_lshlrev_b32 v237, 2, v237
  v_bfe_u32 v236, v250, 2, 1
  v_lshl_add_u32 v237, v236, 1, v237
  v_xor_b32 v237, v237, v249
  v_lshlrev_b32 v237, 4, v237
  v_lshl_add_u32 v252, v248, 10, v237
  s_mov_b32 s56, s14
  s_mov_b32 s57, s15
  s_mov_b32 s58, 524288
  s_mov_b32 s59, 0x00020000
  s_mov_b32 s60, s16
  s_mov_b32 s61, s17
  s_mov_b32 s62, 524288
  s_mov_b32 s63, 0x00020000
  v_lshrrev_b32 v242, 2, v244
  v_and_b32 v242, 1, v242
  v_lshlrev_b32 v242, 4, v242
  v_lshrrev_b32 v241, 3, v244
  v_lshl_add_u32 v242, v241, 2, v242
  v_and_b32 v241, 3, v244
  v_add_u32 v242, v242, v241
  v_bfe_u32 v241, v242, 1, 3
  v_xor_b32 v241, v241, v243
  v_lshlrev_b32 v241, 4, v241
  v_lshl_add_u32 v250, v242, 7, v241
  s_lshl_b32 s92, s83, 12
  v_add_u32 v250, s92, v250
  v_bfe_u32 v241, v244, 1, 3
  v_xor_b32 v241, v241, v243
  v_lshlrev_b32 v241, 4, v241
  v_lshl_add_u32 v236, v244, 7, v241
  s_lshl_b32 s92, s84, 12
  v_add_u32 v236, s92, v236
  s_lshl_b32 s92, s83, 5
  v_xor_b32 v250, s92, v250
  v_xor_b32 v236, s92, v236
  v_xor_b32 v249, 32, v250
  v_xor_b32 v232, 32, v236
  v_xor_b32 v248, 64, v250
  v_xor_b32 v231, 64, v236
  v_xor_b32 v237, 96, v250
  v_xor_b32 v230, 96, v236
  v_add_u32 v229, 65536, v250
  v_add_u32 v228, 131072, v250
  v_add_u32 v227, 65536, v249
  v_add_u32 v226, 131072, v249
  v_add_u32 v225, 65536, v248
  v_add_u32 v224, 131072, v248
  v_add_u32 v223, 65536, v237
  v_add_u32 v222, 131072, v237
  v_add_u32 v221, 65536, v236
  v_add_u32 v220, 131072, v236
  v_add_u32 v219, 65536, v232
  v_add_u32 v218, 131072, v232
  v_add_u32 v217, 65536, v231
  v_add_u32 v216, 131072, v231
  v_add_u32 v215, 65536, v230
  v_add_u32 v214, 131072, v230
  v_lshrrev_b32 v213, 4, v1
  v_xor_b32 v213, v213, v1
  v_and_b32 v213, 1, v213
  v_cmp_eq_u32 vcc, 0, v213
  v_mov_b32 v213, s78
  s_nop 0
  v_cndmask_b32 v8, 0, v213, vcc
  v_cndmask_b32 v9, 0, v213, vcc
  v_cndmask_b32 v10, 0, v213, vcc
  v_cndmask_b32 v11, 0, v213, vcc
  v_mov_b32 v213, 0
  v_mov_b32 v212, 0
  s_waitcnt vmcnt(8)
  v_dot2c_f32_bf16 v213, s78, v4
  v_dot2c_f32_bf16 v212, v4, v4
  v_dot2c_f32_bf16 v213, s78, v5
  v_dot2c_f32_bf16 v212, v5, v5
  v_dot2c_f32_bf16 v213, s78, v6
  v_dot2c_f32_bf16 v212, v6, v6
  v_dot2c_f32_bf16 v213, s78, v7
  v_dot2c_f32_bf16 v212, v7, v7
  s_nop 1
  v_add_f32_dpp v213, v213, v213 quad_perm:[1,0,3,2] row_mask:0xf bank_mask:0xf
  v_add_f32_dpp v212, v212, v212 quad_perm:[1,0,3,2] row_mask:0xf bank_mask:0xf
  s_nop 0
  v_add_f32_dpp v213, v213, v213 quad_perm:[2,3,0,1] row_mask:0xf bank_mask:0xf
  v_add_f32_dpp v212, v212, v212 quad_perm:[2,3,0,1] row_mask:0xf bank_mask:0xf
  s_nop 0
  v_add_f32_dpp v213, v213, v213 row_half_mirror row_mask:0xf bank_mask:0xf
  v_add_f32_dpp v212, v212, v212 row_half_mirror row_mask:0xf bank_mask:0xf
  s_nop 0
  v_add_f32_dpp v213, v213, v213 row_mirror row_mask:0xf bank_mask:0xf
  v_add_f32_dpp v212, v212, v212 row_mirror row_mask:0xf bank_mask:0xf
  v_mov_b32 v12, v213
  v_mov_b32 v13, v212
  s_nop 0
  v_permlane16_swap_b32 v213, v12
  v_permlane16_swap_b32 v212, v13
  v_add_f32 v213, v213, v12
  v_add_f32 v212, v212, v13
  v_mov_b32 v12, v213
  v_mov_b32 v13, v212
  s_nop 0
  v_permlane32_swap_b32 v213, v12
  v_permlane32_swap_b32 v212, v13
  v_add_f32 v213, v213, v12
  v_add_f32 v212, v212, v13
  v_mul_f32 v12, 0x3b000000, v213
  v_mul_f32 v19, v12, v12
  v_fma_f32 v13, v212, s76, -v19
  v_max_f32 v13, 0, v13
  v_cvt_pk_bf16_f32 v14, v12, v12
  v_and_b32 v14, 0xffff0000, v14
  v_cvt_pk_bf16_f32 v19, v13, v13
  v_and_b32 v19, 0xffff0000, v19
  v_add_f32 v19, 0x3727c5ac, v19
  v_cvt_pk_bf16_f32 v19, v19, v19
  v_and_b32 v19, 0xffff0000, v19
  v_sqrt_f32 v19, v19
  s_nop 0
  v_cvt_pk_bf16_f32 v15, v19, v19
  v_and_b32 v15, 0xffff0000, v15
  v_rcp_f32 v16, v15
  v_sub_f32 v19, v12, v14
  v_mul_f32 v17, v19, v16
  v_mul_f32 v19, v13, v16
  v_mul_f32 v19, v19, v16
  v_cvt_pk_bf16_f32 v19, v19, v19
  v_and_b32 v19, 0xffff0000, v19
  v_add_f32 v19, 0x3727c5ac, v19
  v_cvt_pk_bf16_f32 v19, v19, v19
  v_and_b32 v19, 0xffff0000, v19
  v_sqrt_f32 v18, v19
  v_cvt_pk_bf16_f32 v20, v14, v15
  v_cvt_pk_bf16_f32 v22, v17, v18
  s_waitcnt vmcnt(7)
  v_readfirstlane_b32 s72, v251
  s_add_u32 s72, s72, 1
  s_lshl_b32 s92, s82, 29
  s_xor_b32 s92, s92, s72
  v_mov_b32 v21, s72
  v_mov_b32 v23, s92
  v_mov_b32 v233, s72
  s_lshl_b32 s92, s89, 4
  s_add_u32 s92, s92, 17563648
  s_mov_b64 exec, 1
  buffer_store_dwordx4 v[20:23], off, s[44:47], s92 sc1
  s_mov_b64 exec, -1
  s_add_u32 m0, s75, 106496
  s_add_u32 s100, s22, 128
  s_and_b32 s100, s100, 0x380
  buffer_load_dwordx4 v247, s[40:43], s100 offen lds
  s_add_u32 m0, s75, 114688
  s_add_u32 s100, s22, 128
  s_and_b32 s100, s100, 0x380
  buffer_load_dwordx4 v246, s[40:43], s100 offen lds
  s_add_u32 m0, s75, 122880
  s_add_u32 s100, s22, 128
  s_and_b32 s100, s100, 0x380
  s_add_u32 s100, s100, s86
  buffer_load_dwordx4 v253, s[48:51], s100 offen lds
  s_add_u32 m0, s75, 131072
  s_add_u32 s100, s22, 128
  s_and_b32 s100, s100, 0x380
  s_add_u32 s100, s100, s86
  buffer_load_dwordx4 v253, s[52:55], s100 offen lds
  s_mov_b32 s4, 0
  s_mov_b32 s5, -1
  s_bitcmp1_b32 s83, 0
  s_cselect_b64 s[6:7], -1, 0
  s_bitcmp1_b32 s83, 1
  s_cselect_b64 s[8:9], -1, 0
  s_waitcnt vmcnt(8)
  s_waitcnt lgkmcnt(0)
  s_barrier
  ds_read_b128 v[48:51], v229 offset:8192
  ds_read_b128 v[60:63], v221 offset:24576
  ds_read_b128 v[72:75], v221 offset:32768
  s_add_u32 m0, s75, 139264
  s_add_u32 s100, s22, 256
  s_and_b32 s100, s100, 0x380
  buffer_load_dwordx4 v247, s[40:43], s100 offen lds
  s_add_u32 m0, s75, 147456
  s_add_u32 s100, s22, 256
  s_and_b32 s100, s100, 0x380
  buffer_load_dwordx4 v246, s[40:43], s100 offen lds
  ds_read_b128 v[52:55], v227 offset:8192
  ds_read_b128 v[64:67], v219 offset:24576
  ds_read_b128 v[76:79], v219 offset:32768
  s_waitcnt lgkmcnt(4)
  v_mfma_f32_32x32x16_bf16 v[12:27], v[48:51], v[60:63], 0
  s_waitcnt vmcnt(9)
  v_lshlrev_b32 v240, 16, v240
  s_waitcnt vmcnt(8)
  v_lshlrev_b32 v239, 16, v239
  s_waitcnt vmcnt(7)
  v_lshlrev_b32 v238, 16, v238
  s_waitcnt lgkmcnt(3)
  v_mfma_f32_32x32x16_bf16 v[28:43], v[48:51], v[72:75], 0
  v_mul_f32 v210, 0x3fb8aa3b, v238
  v_exp_f32 v210, v210
  v_mfma_f32_16x16x32_bf16 v[4:7], v[60:63], v[8:11], 0
  v_cvt_pk_bf16_f32 v210, v210, v210
  v_and_b32 v210, 0xffff0000, v210
  v_mul_f32 v209, v210, v240
  v_mfma_f32_16x16x32_bf16 v[44:47], v[72:75], v[8:11], 0
  v_mul_f32 v209, 0x3fb8aa3b, v209
  v_exp_f32 v209, v209
  s_add_u32 m0, s75, 0
  s_add_u32 s100, s22, 256
  s_and_b32 s100, s100, 0x380
  s_add_u32 s100, s100, s86
  buffer_load_dwordx4 v253, s[48:51], s100 offen lds
  s_add_u32 m0, s75, 8192
  s_add_u32 s100, s22, 256
  s_and_b32 s100, s100, 0x380
  s_add_u32 s100, s100, s86
  buffer_load_dwordx4 v253, s[52:55], s100 offen lds
  ds_read_b128 v[56:59], v225 offset:8192
  ds_read_b128 v[68:71], v217 offset:24576
  ds_read_b128 v[80:83], v217 offset:32768
  s_waitcnt lgkmcnt(4)
  v_mfma_f32_32x32x16_bf16 v[12:27], v[52:55], v[64:67], v[12:27]
  v_mul_f32 v208, v210, v239
  v_mul_f32 v208, 0x3e22f983, v208
  v_cos_f32 v251, v208
  s_waitcnt lgkmcnt(3)
  v_mfma_f32_32x32x16_bf16 v[28:43], v[52:55], v[76:79], v[28:43]
  v_sin_f32 v213, v208
  v_mul_f32 v251, v251, v209
  s_add_u32 m0, s75, 16384
  s_add_u32 s100, s22, 384
  s_and_b32 s100, s100, 0x380
  buffer_load_dwordx4 v247, s[40:43], s100 offen lds
  ds_read_b128 v[48:51], v223 offset:8192
  ds_read_b128 v[60:63], v215 offset:24576
  ds_read_b128 v[72:75], v215 offset:32768
  s_waitcnt lgkmcnt(4)
  v_mfma_f32_32x32x16_bf16 v[12:27], v[56:59], v[68:71], v[12:27]
  v_mul_f32 v213, v213, v209
  v_mul_f32 v209, v240, v240
  v_fma_f32 v209, v239, v239, v209
  s_waitcnt lgkmcnt(3)
  v_mfma_f32_32x32x16_bf16 v[28:43], v[56:59], v[80:83], v[28:43]
  v_rcp_f32 v209, v209
  v_add_f32 v208, -1.0, v251
  s_add_u32 m0, s75, 24576
  s_add_u32 s100, s22, 384
  s_and_b32 s100, s100, 0x380
  buffer_load_dwordx4 v246, s[40:43], s100 offen lds
  s_waitcnt vmcnt(6)
  s_waitcnt lgkmcnt(0)
  s_barrier
  ds_read_b128 v[52:55], v229 offset:40960
  ds_read_b128 v[64:67], v221 offset:57344
  ds_read_b128 v[76:79], v220
  v_mfma_f32_32x32x16_bf16 v[12:27], v[48:51], v[60:63], v[12:27]
  v_mul_f32 v212, v208, v240
  v_fma_f32 v212, v213, v239, v212
  v_mul_f32 v211, v213, v240
  v_mfma_f32_32x32x16_bf16 v[28:43], v[48:51], v[72:75], v[28:43]
  v_fma_f32 v211, -v208, v239, v211
  v_add_f32 v209, v209, v209
  v_mul_f32 v212, v212, v209
  s_add_u32 m0, s75, 32768
  s_add_u32 s100, s22, 384
  s_and_b32 s100, s100, 0x380
  s_add_u32 s100, s100, s86
  buffer_load_dwordx4 v253, s[48:51], s100 offen lds
  s_add_u32 m0, s75, 40960
  s_add_u32 s100, s22, 384
  s_and_b32 s100, s100, 0x380
  s_add_u32 s100, s100, s86
  buffer_load_dwordx4 v253, s[52:55], s100 offen lds
  ds_read_b128 v[56:59], v227 offset:40960
  ds_read_b128 v[68:71], v219 offset:57344
  ds_read_b128 v[80:83], v218
  s_waitcnt lgkmcnt(4)
  v_mfma_f32_32x32x16_bf16 v[12:27], v[52:55], v[64:67], v[12:27]
  v_mul_f32 v211, v211, v209
  v_mul_f32 v2, v213, v213
  v_mul_f32 v3, v251, v213
  s_waitcnt lgkmcnt(3)
  v_mfma_f32_32x32x16_bf16 v[28:43], v[52:55], v[76:79], v[28:43]
  v_fma_f32 v2, v251, v251, -v2
  v_add_f32 v3, v3, v3
  v_mul_f32 v84, v3, v3
  v_mfma_f32_16x16x32_bf16 v[4:7], v[64:67], v[8:11], v[4:7]
  v_mul_f32 v85, v2, v3
  v_fma_f32 v84, v2, v2, -v84
  v_add_f32 v85, v85, v85
  v_mfma_f32_16x16x32_bf16 v[44:47], v[76:79], v[8:11], v[44:47]
  v_mul_f32 v2, v85, v85
  v_mul_f32 v3, v84, v85
  v_fma_f32 v2, v84, v84, -v2
  s_add_u32 m0, s75, 73728
  s_add_u32 s100, s22, 512
  s_and_b32 s100, s100, 0x380
  buffer_load_dwordx4 v247, s[40:43], s100 offen lds
  ds_read_b128 v[48:51], v225 offset:40960
  ds_read_b128 v[60:63], v217 offset:57344
  ds_read_b128 v[72:75], v216
  s_waitcnt lgkmcnt(4)
  v_mfma_f32_32x32x16_bf16 v[12:27], v[56:59], v[68:71], v[12:27]
  v_add_f32 v3, v3, v3
  v_mul_f32 v86, v3, v3
  v_mul_f32 v87, v2, v3
  s_waitcnt lgkmcnt(3)
  v_mfma_f32_32x32x16_bf16 v[28:43], v[56:59], v[80:83], v[28:43]
  v_fma_f32 v86, v2, v2, -v86
  v_add_f32 v87, v87, v87
  v_cndmask_b32 v90, 1.0, v86, s[4:5]
  s_add_u32 m0, s75, 81920
  s_add_u32 s100, s22, 512
  s_and_b32 s100, s100, 0x380
  buffer_load_dwordx4 v246, s[40:43], s100 offen lds
  ds_read_b128 v[52:55], v223 offset:40960
  ds_read_b128 v[64:67], v215 offset:57344
  ds_read_b128 v[76:79], v214
  s_waitcnt lgkmcnt(4)
  v_mfma_f32_32x32x16_bf16 v[12:27], v[48:51], v[60:63], v[12:27]
  v_cndmask_b32 v91, 0, v87, s[4:5]
  v_mul_f32 v2, v87, v87
  v_mul_f32 v3, v86, v87
  s_waitcnt lgkmcnt(3)
  v_mfma_f32_32x32x16_bf16 v[28:43], v[48:51], v[72:75], v[28:43]
  v_fma_f32 v2, v86, v86, -v2
  v_add_f32 v3, v3, v3
  v_mul_f32 v209, v90, v2
  s_add_u32 m0, s75, 90112
  s_add_u32 s100, s22, 512
  s_and_b32 s100, s100, 0x380
  s_add_u32 s100, s100, s86
  buffer_load_dwordx4 v253, s[48:51], s100 offen lds
  s_sub_u32 s92, s70, 4
  s_lshl_b32 s92, s92, 7
  s_lshl_b32 s93, s68, 3
  s_add_u32 s92, s92, s93
  s_add_u32 s92, s92, s74
  s_cmp_ge_u32 s92, 288
  s_cbranch_scc1 L_w2m_S0_2001
  s_mov_b32 s64, s28
  s_mov_b32 s65, s29
  s_mov_b32 s66, 1835008
  s_mov_b32 s94, 0
  s_cmp_ge_u32 s92, 224
  s_cselect_b32 s64, s26, s64
  s_cselect_b32 s65, s27, s65
  s_cselect_b32 s66, 524288, s66
  s_cselect_b32 s94, 224, s94
  s_mov_b32 s67, 0x00020000
  s_sub_u32 s94, s92, s94
  s_lshl_b32 s94, s94, 13
  v_lshlrev_b32 v206, 7, v1
  buffer_load_dword v207, v206, s[64:67], s94 offen
  s_nop 1
L_w2m_S0_2001:
  s_waitcnt vmcnt(7)
  s_waitcnt lgkmcnt(0)
  s_barrier
  ds_read_b128 v[56:59], v228 offset:8192
  ds_read_b128 v[68:71], v236
  ds_read_b128 v[80:83], v236 offset:8192
  v_mfma_f32_32x32x16_bf16 v[12:27], v[52:55], v[64:67], v[12:27]
  v_mul_f32 v208, v90, v3
  v_fma_f32 v209, -v91, v3, v209
  v_fma_f32 v208, v91, v2, v208
  v_mfma_f32_32x32x16_bf16 v[28:43], v[52:55], v[76:79], v[28:43]
  v_cndmask_b32 v90, v90, v209, s[6:7]
  v_cndmask_b32 v91, v91, v208, s[6:7]
  v_mul_f32 v84, v3, v3
  s_add_u32 m0, s75, 98304
  s_add_u32 s100, s22, 512
  s_and_b32 s100, s100, 0x380
  s_add_u32 s100, s100, s86
  buffer_load_dwordx4 v253, s[52:55], s100 offen lds
  ds_read_b128 v[48:51], v226 offset:8192
  ds_read_b128 v[60:63], v232
  ds_read_b128 v[72:75], v232 offset:8192
  s_waitcnt lgkmcnt(4)
  v_mfma_f32_32x32x16_bf16 v[12:27], v[56:59], v[68:71], v[12:27]
  v_mul_f32 v85, v2, v3
  v_fma_f32 v84, v2, v2, -v84
  v_add_f32 v85, v85, v85
  s_waitcnt lgkmcnt(3)
  v_mfma_f32_32x32x16_bf16 v[28:43], v[56:59], v[80:83], v[28:43]
  v_mul_f32 v209, v90, v84
  v_mul_f32 v208, v90, v85
  v_fma_f32 v209, -v91, v85, v209
  v_mfma_f32_16x16x32_bf16 v[4:7], v[68:71], v[8:11], v[4:7]
  v_fma_f32 v208, v91, v84, v208
  v_cndmask_b32 v90, v90, v209, s[8:9]
  v_cndmask_b32 v91, v91, v208, s[8:9]
  v_mfma_f32_16x16x32_bf16 v[44:47], v[80:83], v[8:11], v[44:47]
  v_mul_f32 v88, v85, v85
  v_mul_f32 v89, v84, v85
  v_fma_f32 v88, v84, v84, -v88
  s_add_u32 m0, s75, 106496
  s_add_u32 s100, s22, 640
  s_and_b32 s100, s100, 0x380
  buffer_load_dwordx4 v247, s[40:43], s100 offen lds
  ds_read_b128 v[52:55], v224 offset:8192
  ds_read_b128 v[64:67], v231
  ds_read_b128 v[76:79], v231 offset:8192
  s_waitcnt lgkmcnt(4)
  v_mfma_f32_32x32x16_bf16 v[12:27], v[48:51], v[60:63], v[12:27]
  v_add_f32 v89, v89, v89
  v_mul_f32 v94, v89, v89
  v_mul_f32 v95, v88, v89
  s_waitcnt lgkmcnt(3)
  v_mfma_f32_32x32x16_bf16 v[28:43], v[48:51], v[72:75], v[28:43]
  v_fma_f32 v94, v88, v88, -v94
  v_add_f32 v95, v95, v95
  v_cndmask_b32 v92, 1.0, v94, s[4:5]
  s_add_u32 m0, s75, 114688
  s_add_u32 s100, s22, 640
  s_and_b32 s100, s100, 0x380
  buffer_load_dwordx4 v246, s[40:43], s100 offen lds
  ds_read_b128 v[56:59], v222 offset:8192
  ds_read_b128 v[68:71], v230
  ds_read_b128 v[80:83], v230 offset:8192
  s_waitcnt lgkmcnt(4)
  v_mfma_f32_32x32x16_bf16 v[12:27], v[52:55], v[64:67], v[12:27]
  v_cndmask_b32 v93, 0, v95, s[4:5]
  v_mul_f32 v2, v95, v95
  v_mul_f32 v3, v94, v95
  s_waitcnt lgkmcnt(3)
  v_mfma_f32_32x32x16_bf16 v[28:43], v[52:55], v[76:79], v[28:43]
  v_fma_f32 v2, v94, v94, -v2
  v_add_f32 v3, v3, v3
  v_mul_f32 v209, v92, v2
  s_add_u32 m0, s75, 122880
  s_add_u32 s100, s22, 640
  s_and_b32 s100, s100, 0x380
  s_add_u32 s100, s100, s86
  buffer_load_dwordx4 v253, s[48:51], s100 offen lds
  s_waitcnt vmcnt(7)
  s_waitcnt lgkmcnt(0)
  s_barrier
  ds_read_b128 v[48:51], v250 offset:16384
  ds_read_b128 v[60:63], v236 offset:32768
  ds_read_b128 v[72:75], v236 offset:40960
  v_mfma_f32_32x32x16_bf16 v[12:27], v[56:59], v[68:71], v[12:27]
  v_mul_f32 v208, v92, v3
  v_fma_f32 v209, -v93, v3, v209
  v_fma_f32 v208, v93, v2, v208
  v_mfma_f32_32x32x16_bf16 v[28:43], v[56:59], v[80:83], v[28:43]
  v_cndmask_b32 v92, v92, v209, s[6:7]
  v_cndmask_b32 v93, v93, v208, s[6:7]
  v_mul_f32 v84, v3, v3
  s_add_u32 m0, s75, 131072
  s_add_u32 s100, s22, 640
  s_and_b32 s100, s100, 0x380
  s_add_u32 s100, s100, s86
  buffer_load_dwordx4 v253, s[52:55], s100 offen lds
  ds_read_b128 v[52:55], v249 offset:16384
  ds_read_b128 v[64:67], v232 offset:32768
  ds_read_b128 v[76:79], v232 offset:40960
  s_waitcnt lgkmcnt(4)
  v_mfma_f32_32x32x16_bf16 v[12:27], v[48:51], v[60:63], v[12:27]
  v_mul_f32 v85, v2, v3
  v_fma_f32 v84, v2, v2, -v84
  v_add_f32 v85, v85, v85
  s_waitcnt lgkmcnt(3)
  v_mfma_f32_32x32x16_bf16 v[28:43], v[48:51], v[72:75], v[28:43]
  v_mul_f32 v209, v92, v84
  v_mul_f32 v208, v92, v85
  v_fma_f32 v209, -v93, v85, v209
  v_mfma_f32_16x16x32_bf16 v[4:7], v[60:63], v[8:11], v[4:7]
  v_fma_f32 v208, v93, v84, v208
  v_cndmask_b32 v92, v92, v209, s[8:9]
  v_cndmask_b32 v93, v93, v208, s[8:9]
  v_mfma_f32_16x16x32_bf16 v[44:47], v[72:75], v[8:11], v[44:47]
  s_add_u32 m0, s75, 139264
  s_add_u32 s100, s22, 768
  s_and_b32 s100, s100, 0x380
  buffer_load_dwordx4 v247, s[40:43], s100 offen lds
  ds_read_b128 v[56:59], v248 offset:16384
  ds_read_b128 v[68:71], v231 offset:32768
  ds_read_b128 v[80:83], v231 offset:40960
  s_waitcnt lgkmcnt(4)
  v_mfma_f32_32x32x16_bf16 v[12:27], v[52:55], v[64:67], v[12:27]
  s_waitcnt lgkmcnt(3)
  v_mfma_f32_32x32x16_bf16 v[28:43], v[52:55], v[76:79], v[28:43]
  s_add_u32 m0, s75, 147456
  s_add_u32 s100, s22, 768
  s_and_b32 s100, s100, 0x380
  buffer_load_dwordx4 v246, s[40:43], s100 offen lds
  ds_read_b128 v[48:51], v237 offset:16384
  ds_read_b128 v[60:63], v230 offset:32768
  ds_read_b128 v[72:75], v230 offset:40960
  s_waitcnt lgkmcnt(4)
  v_mfma_f32_32x32x16_bf16 v[12:27], v[56:59], v[68:71], v[12:27]
  s_waitcnt lgkmcnt(3)
  v_mfma_f32_32x32x16_bf16 v[28:43], v[56:59], v[80:83], v[28:43]
  s_add_u32 m0, s75, 0
  s_add_u32 s100, s22, 768
  s_and_b32 s100, s100, 0x380
  s_add_u32 s100, s100, s86
  buffer_load_dwordx4 v253, s[48:51], s100 offen lds
  v_mov_b32 v206, 0
  s_cmp_lt_u32 s70, 5
  s_nop 4
  s_cbranch_scc1 L_si_S0_2002
  s_sub_u32 s92, s70, 5
  s_lshl_b32 s92, s92, 6
  v_add_u32 v205, s92, v1
  v_min_u32 v205, 131, v205
  s_sub_u32 s92, s71, 2
  v_add_u32 v204, s92, v205
  v_max_i32 v204, 0, v204
  v_min_i32 v204, 2047, v204
  v_lshlrev_b32 v206, 4, v204
  s_mov_b32 s92, 17563648
  buffer_load_dwordx4 v[128:131], v206, s[44:47], s92 offen sc1
  s_nop 0
L_si_S0_2002:
  s_waitcnt vmcnt(7)
  s_waitcnt lgkmcnt(0)
  s_barrier
  ds_read_b128 v[52:55], v229 offset:8192
  ds_read_b128 v[64:67], v221 offset:24576
  ds_read_b128 v[76:79], v221 offset:32768
  v_mfma_f32_32x32x16_bf16 v[12:27], v[48:51], v[60:63], v[12:27]
  v_mfma_f32_32x32x16_bf16 v[28:43], v[48:51], v[72:75], v[28:43]
  s_add_u32 m0, s75, 8192
  s_add_u32 s100, s22, 768
  s_and_b32 s100, s100, 0x380
  s_add_u32 s100, s100, s86
  buffer_load_dwordx4 v253, s[52:55], s100 offen lds
  ds_read_b128 v[56:59], v227 offset:8192
  ds_read_b128 v[68:71], v219 offset:24576
  ds_read_b128 v[80:83], v219 offset:32768
  s_waitcnt lgkmcnt(4)
  v_mfma_f32_32x32x16_bf16 v[12:27], v[52:55], v[64:67], v[12:27]
  s_waitcnt lgkmcnt(3)
  v_mfma_f32_32x32x16_bf16 v[28:43], v[52:55], v[76:79], v[28:43]
  v_mfma_f32_16x16x32_bf16 v[4:7], v[64:67], v[8:11], v[4:7]
  v_mfma_f32_16x16x32_bf16 v[44:47], v[76:79], v[8:11], v[44:47]
  s_add_u32 m0, s75, 16384
  s_add_u32 s100, s22, 896
  s_and_b32 s100, s100, 0x380
  buffer_load_dwordx4 v247, s[40:43], s100 offen lds
  ds_read_b128 v[48:51], v225 offset:8192
  ds_read_b128 v[60:63], v217 offset:24576
  ds_read_b128 v[72:75], v217 offset:32768
  s_waitcnt lgkmcnt(4)
  v_mfma_f32_32x32x16_bf16 v[12:27], v[56:59], v[68:71], v[12:27]
  s_waitcnt lgkmcnt(3)
  v_mfma_f32_32x32x16_bf16 v[28:43], v[56:59], v[80:83], v[28:43]
  s_add_u32 m0, s75, 24576
  s_add_u32 s100, s22, 896
  s_and_b32 s100, s100, 0x380
  buffer_load_dwordx4 v246, s[40:43], s100 offen lds
  ds_read_b128 v[52:55], v223 offset:8192
  ds_read_b128 v[64:67], v215 offset:24576
  ds_read_b128 v[76:79], v215 offset:32768
  s_waitcnt lgkmcnt(4)
  v_mfma_f32_32x32x16_bf16 v[12:27], v[48:51], v[60:63], v[12:27]
  s_waitcnt lgkmcnt(3)
  v_mfma_f32_32x32x16_bf16 v[28:43], v[48:51], v[72:75], v[28:43]
  s_add_u32 m0, s75, 32768
  s_add_u32 s100, s22, 896
  s_and_b32 s100, s100, 0x380
  s_add_u32 s100, s100, s86
  buffer_load_dwordx4 v253, s[48:51], s100 offen lds
  s_waitcnt vmcnt(7)
  s_waitcnt lgkmcnt(0)
  s_barrier
  ds_read_b128 v[56:59], v229 offset:40960
  ds_read_b128 v[68:71], v221 offset:57344
  ds_read_b128 v[80:83], v220
  v_mfma_f32_32x32x16_bf16 v[12:27], v[52:55], v[64:67], v[12:27]
  v_mfma_f32_32x32x16_bf16 v[28:43], v[52:55], v[76:79], v[28:43]
  s_add_u32 m0, s75, 40960
  s_add_u32 s100, s22, 896
  s_and_b32 s100, s100, 0x380
  s_add_u32 s100, s100, s86
  buffer_load_dwordx4 v253, s[52:55], s100 offen lds
  ds_read_b128 v[48:51], v227 offset:40960
  ds_read_b128 v[60:63], v219 offset:57344
  ds_read_b128 v[72:75], v218
  s_waitcnt lgkmcnt(4)
  v_mfma_f32_32x32x16_bf16 v[12:27], v[56:59], v[68:71], v[12:27]
  s_waitcnt lgkmcnt(3)
  v_mfma_f32_32x32x16_bf16 v[28:43], v[56:59], v[80:83], v[28:43]
  v_mfma_f32_16x16x32_bf16 v[4:7], v[68:71], v[8:11], v[4:7]
  v_mfma_f32_16x16x32_bf16 v[44:47], v[80:83], v[8:11], v[44:47]
  s_mov_b32 s52, s30
  s_mov_b32 s53, s31
  s_mov_b32 s54, 1835008
  s_mov_b32 s55, 0x00020000
  s_lshr_b32 s92, s2, 7
  s_lshl_b32 s3, s92, 1
  s_add_u32 s3, s3, s73
  s_lshl_b32 s3, s3, 1
  s_add_u32 s3, s3, s74
  s_add_u32 s3, s3, s2
  s_lshl_b32 s3, s3, 7
  s_and_b32 s3, s3, 0x380
  s_add_u32 s3, s3, s86
  s_mul_i32 s92, s92, 7
  s_mul_i32 s93, s73, 3
  s_add_u32 s92, s92, s93
  s_lshl_b32 s93, s74, 1
  s_add_u32 s92, s92, s93
  s_sub_u32 s93, s92, 14
  s_min_u32 s92, s92, s93
  s_and_b32 s93, s2, 7
  s_lshl_b32 s93, s93, 1
  s_add_u32 s92, s92, s93
  s_sub_u32 s93, s92, 14
  s_min_u32 s92, s92, s93
  s_sub_u32 s93, s92, 14
  s_min_u32 s92, s92, s93
  s_lshl_b32 s1, s92, 13
  s_lshl_b32 s0, s92, 17
  s_add_u32 s0, s0, s79
  ds_read_b128 v[52:55], v225 offset:40960
  ds_read_b128 v[64:67], v217 offset:57344
  ds_read_b128 v[76:79], v216
  s_waitcnt lgkmcnt(4)
  v_mfma_f32_32x32x16_bf16 v[12:27], v[48:51], v[60:63], v[12:27]
  s_waitcnt lgkmcnt(3)
  v_mfma_f32_32x32x16_bf16 v[28:43], v[48:51], v[72:75], v[28:43]
  ds_read_b128 v[56:59], v223 offset:40960
  ds_read_b128 v[68:71], v215 offset:57344
  ds_read_b128 v[80:83], v214
  s_waitcnt lgkmcnt(4)
  v_mfma_f32_32x32x16_bf16 v[12:27], v[52:55], v[64:67], v[12:27]
  s_waitcnt lgkmcnt(3)
  v_mfma_f32_32x32x16_bf16 v[28:43], v[52:55], v[76:79], v[28:43]
  s_add_u32 m0, s75, 49152
  s_xor_b32 s100, s3, 0
  buffer_load_dwordx4 v253, s[56:59], s100 offen lds
  s_add_u32 m0, s75, 57344
  s_xor_b32 s100, s3, 0
  buffer_load_dwordx4 v253, s[60:63], s100 offen lds
  s_waitcnt vmcnt(6)
  s_waitcnt lgkmcnt(0)
  s_barrier
  ds_read_b128 v[48:51], v228 offset:8192
  ds_read_b128 v[60:63], v236
  ds_read_b128 v[72:75], v236 offset:8192
  v_mfma_f32_32x32x16_bf16 v[12:27], v[56:59], v[68:71], v[12:27]
  v_mfma_f32_32x32x16_bf16 v[28:43], v[56:59], v[80:83], v[28:43]
  ds_read_b128 v[52:55], v226 offset:8192
  ds_read_b128 v[64:67], v232
  ds_read_b128 v[76:79], v232 offset:8192
  s_waitcnt lgkmcnt(4)
  v_mfma_f32_32x32x16_bf16 v[12:27], v[48:51], v[60:63], v[12:27]
  s_waitcnt lgkmcnt(3)
  v_mfma_f32_32x32x16_bf16 v[28:43], v[48:51], v[72:75], v[28:43]
  v_mfma_f32_16x16x32_bf16 v[4:7], v[60:63], v[8:11], v[4:7]
  v_mfma_f32_16x16x32_bf16 v[44:47], v[72:75], v[8:11], v[44:47]
  ds_read_b128 v[56:59], v224 offset:8192
  ds_read_b128 v[68:71], v231
  ds_read_b128 v[80:83], v231 offset:8192
  s_waitcnt lgkmcnt(4)
  v_mfma_f32_32x32x16_bf16 v[12:27], v[52:55], v[64:67], v[12:27]
  s_waitcnt lgkmcnt(3)
  v_mfma_f32_32x32x16_bf16 v[28:43], v[52:55], v[76:79], v[28:43]
  ds_read_b128 v[48:51], v222 offset:8192
  ds_read_b128 v[60:63], v230
  ds_read_b128 v[72:75], v230 offset:8192
  s_waitcnt lgkmcnt(4)
  v_mfma_f32_32x32x16_bf16 v[12:27], v[56:59], v[68:71], v[12:27]
  s_waitcnt lgkmcnt(3)
  v_mfma_f32_32x32x16_bf16 v[28:43], v[56:59], v[80:83], v[28:43]
  s_add_u32 m0, s75, 65536
  s_add_u32 s100, s0, 0
  s_sub_u32 s99, s100, 1835008
  s_min_u32 s100, s100, s99
  buffer_load_dwordx4 v252, s[52:55], s100 offen lds
  s_add_u32 m0, s75, 73728
  s_xor_b32 s100, s3, 128
  buffer_load_dwordx4 v253, s[56:59], s100 offen lds
  s_cmp_lt_u32 s70, 5
  s_nop 2
  s_cbranch_scc1 L_sc_S0_2003
  v_mov_b32 v138, v129
  s_mov_b32 s93, 200000
  s_mov_b32 s92, 17563648
  s_nop 0
L_sl_S0_2004:
  v_xor_b32 v138, s72, v129
  v_xor_b32 v139, s72, v131
  v_lshlrev_b32 v136, 3, v139
  v_or_b32 v138, v138, v136
  v_cmp_ne_u32 vcc, 0, v138
  s_nop 4
  s_cbranch_vccz L_sd_S0_2005
  buffer_load_dwordx4 v[128:131], v206, s[44:47], s92 offen sc1
  s_waitcnt vmcnt(0)
  s_sub_u32 s93, s93, 1
  s_cmp_lg_u32 s93, 0
  s_cbranch_scc1 L_sl_S0_2004
L_sd_S0_2005:
  v_lshrrev_b32 v139, 29, v139
  v_subrev_u32 v138, 2, v205
  v_cmp_gt_u32 vcc, 128, v138
  v_cmp_ne_u32 s[94:95], s82, v139
  s_and_b64 vcc, vcc, s[94:95]
  s_cselect_b32 s94, 1, 0
  s_lshl_b32 s95, s70, 2
  s_add_u32 s95, s95, 162892
  v_mov_b32 v138, s94
  v_mov_b32 v139, s95
  ds_write_b32 v139, v138
  s_sub_u32 s92, s71, 2
  v_add_u32 v138, s92, v205
  v_cmp_gt_u32 vcc, 2048, v138
  s_nop 1
  v_cndmask_b32 v204, 0, 1.0, vcc
  v_lshlrev_b32 v132, 16, v128
  v_and_b32 v133, 0xffff0000, v128
  v_lshlrev_b32 v134, 16, v130
  v_and_b32 v135, 0xffff0000, v130
  v_rcp_f32 v136, v133
  v_rcp_f32 v137, v135
  v_mul_f32 v132, v132, v204
  v_mul_f32 v134, v134, v204
  v_mov_b32 v140, v136
  v_mul_f32 v141, v132, v136
  v_mul_f32 v142, v136, v137
  v_fma_f32 v138, v134, v133, v132
  v_mul_f32 v143, v138, v142
  v_mov_b32 v144, v132
  v_mov_b32 v145, v136
  v_lshlrev_b32 v139, 3, v205
  v_add_u32 v139, 155648, v139
  ds_write_b64 v139, v[140:141] offset:0
  ds_write_b64 v139, v[142:143] offset:1056
  ds_write_b64 v139, v[144:145] offset:2112
L_sc_S0_2003:
  s_waitcnt vmcnt(4)
  s_waitcnt lgkmcnt(0)
  s_barrier
  ds_read_b128 v[52:55], v250 offset:16384
  ds_read_b128 v[64:67], v236 offset:32768
  ds_read_b128 v[76:79], v236 offset:40960
  v_mfma_f32_32x32x16_bf16 v[12:27], v[48:51], v[60:63], v[12:27]
  v_mfma_f32_32x32x16_bf16 v[28:43], v[48:51], v[72:75], v[28:43]
  ds_read_b128 v[56:59], v249 offset:16384
  ds_read_b128 v[68:71], v232 offset:32768
  ds_read_b128 v[80:83], v232 offset:40960
  s_waitcnt lgkmcnt(4)
  v_mfma_f32_32x32x16_bf16 v[12:27], v[52:55], v[64:67], v[12:27]
  s_waitcnt lgkmcnt(3)
  v_mfma_f32_32x32x16_bf16 v[28:43], v[52:55], v[76:79], v[28:43]
  v_mfma_f32_16x16x32_bf16 v[4:7], v[64:67], v[8:11], v[4:7]
  v_mfma_f32_16x16x32_bf16 v[44:47], v[76:79], v[8:11], v[44:47]
  ds_read_b128 v[48:51], v248 offset:16384
  ds_read_b128 v[60:63], v231 offset:32768
  ds_read_b128 v[72:75], v231 offset:40960
  s_waitcnt lgkmcnt(4)
  v_mfma_f32_32x32x16_bf16 v[12:27], v[56:59], v[68:71], v[12:27]
  s_waitcnt lgkmcnt(3)
  v_mfma_f32_32x32x16_bf16 v[28:43], v[56:59], v[80:83], v[28:43]
  ds_read_b128 v[52:55], v237 offset:16384
  ds_read_b128 v[64:67], v230 offset:32768
  ds_read_b128 v[76:79], v230 offset:40960
  s_waitcnt lgkmcnt(4)
  v_mfma_f32_32x32x16_bf16 v[12:27], v[48:51], v[60:63], v[12:27]
  s_waitcnt lgkmcnt(3)
  v_mfma_f32_32x32x16_bf16 v[28:43], v[48:51], v[72:75], v[28:43]
  s_add_u32 m0, s75, 81920
  s_xor_b32 s100, s3, 128
  buffer_load_dwordx4 v253, s[60:63], s100 offen lds
  s_add_u32 m0, s75, 90112
  s_xor_b32 s100, s3, 256
  buffer_load_dwordx4 v253, s[56:59], s100 offen lds
  s_lshl_b32 s92, s83, 8
  s_add_u32 s92, s92, 155664
  v_lshl_add_u32 v241, v243, 7, s92
  ds_read_b128 v[96:99], v241 offset:0
  ds_read_b128 v[100:103], v241 offset:16
  ds_read_b128 v[104:107], v241 offset:32
  ds_read_b128 v[108:111], v241 offset:48
  ds_read_b128 v[112:115], v241 offset:64
  ds_read_b128 v[116:119], v241 offset:80
  ds_read_b128 v[120:123], v241 offset:96
  ds_read_b128 v[124:127], v241 offset:112
  s_waitcnt lgkmcnt(9)
  v_mfma_f32_32x32x16_bf16 v[12:27], v[52:55], v[64:67], v[12:27]
  s_waitcnt lgkmcnt(8)
  v_mfma_f32_32x32x16_bf16 v[28:43], v[52:55], v[76:79], v[28:43]
  v_lshrrev_b32 v242, 4, v1
  v_and_b32 v241, 1, v1
  v_lshl_add_u32 v242, v241, 2, v242
  s_lshl_b32 s92, s84, 10
  s_add_u32 s92, s92, 158816
  s_lshl_b32 s93, s83, 3
  s_add_u32 s93, s93, s92
  v_lshl_add_u32 v241, v242, 7, s93
  v_lshl_add_u32 v242, v244, 5, s92
  s_mov_b32 exec_lo, 0x30003
  s_mov_b32 exec_hi, 0x30003
  ds_write2_b32 v241, v4, v44 offset0:0 offset1:1
  ds_write2_b32 v241, v5, v45 offset0:8 offset1:9
  ds_write2_b32 v241, v6, v46 offset0:16 offset1:17
  ds_write2_b32 v241, v7, v47 offset0:24 offset1:25
  s_mov_b64 exec, -1
  s_waitcnt lgkmcnt(11)
  v_mul_f32 v12, v96, v12
  v_mul_f32 v28, v96, v28
  v_mul_f32 v13, v98, v13
  v_mul_f32 v29, v98, v29
  s_waitcnt lgkmcnt(10)
  v_mul_f32 v14, v100, v14
  v_mul_f32 v30, v100, v30
  v_mul_f32 v15, v102, v15
  v_mul_f32 v31, v102, v31
  s_waitcnt lgkmcnt(9)
  v_mul_f32 v16, v104, v16
  v_mul_f32 v32, v104, v32
  v_mul_f32 v17, v106, v17
  v_mul_f32 v33, v106, v33
  s_waitcnt lgkmcnt(8)
  v_mul_f32 v18, v108, v18
  v_mul_f32 v34, v108, v34
  v_mul_f32 v19, v110, v19
  v_mul_f32 v35, v110, v35
  s_waitcnt lgkmcnt(7)
  v_mul_f32 v20, v112, v20
  v_mul_f32 v36, v112, v36
  v_mul_f32 v21, v114, v21
  v_mul_f32 v37, v114, v37
  s_waitcnt lgkmcnt(6)
  v_mul_f32 v22, v116, v22
  v_mul_f32 v38, v116, v38
  v_mul_f32 v23, v118, v23
  v_mul_f32 v39, v118, v39
  s_waitcnt lgkmcnt(5)
  v_mul_f32 v24, v120, v24
  v_mul_f32 v40, v120, v40
  v_mul_f32 v25, v122, v25
  v_mul_f32 v41, v122, v41
  s_waitcnt lgkmcnt(4)
  v_mul_f32 v26, v124, v26
  v_mul_f32 v42, v124, v42
  v_mul_f32 v27, v126, v27
  v_mul_f32 v43, v126, v43
  s_add_u32 m0, s75, 98304
  s_xor_b32 s100, s3, 256
  buffer_load_dwordx4 v253, s[60:63], s100 offen lds
  s_waitcnt lgkmcnt(0)
  s_barrier
  ds_read_b128 v[48:51], v242
  ds_read_b128 v[52:55], v242 offset:16
  s_add_u32 m0, s75, 106496
  s_xor_b32 s100, s3, 384
  buffer_load_dwordx4 v253, s[56:59], s100 offen lds
  s_waitcnt lgkmcnt(1)
  v_add_f32 v4, v48, v50
  v_add_f32 v44, v49, v51
  s_waitcnt lgkmcnt(0)
  v_add_f32 v52, v52, v54
  v_add_f32 v53, v53, v55
  v_add_f32 v4, v4, v52
  v_add_f32 v44, v44, v53
  v_fma_f32 v12, -v97, v4, v12
  v_fma_f32 v28, -v97, v44, v28
  v_fma_f32 v13, -v99, v4, v13
  v_fma_f32 v29, -v99, v44, v29
  v_fma_f32 v14, -v101, v4, v14
  v_fma_f32 v30, -v101, v44, v30
  v_fma_f32 v15, -v103, v4, v15
  v_fma_f32 v31, -v103, v44, v31
  v_fma_f32 v16, -v105, v4, v16
  v_fma_f32 v32, -v105, v44, v32
  v_fma_f32 v17, -v107, v4, v17
  v_fma_f32 v33, -v107, v44, v33
  v_fma_f32 v18, -v109, v4, v18
  v_fma_f32 v34, -v109, v44, v34
  v_fma_f32 v19, -v111, v4, v19
  v_fma_f32 v35, -v111, v44, v35
  v_fma_f32 v20, -v113, v4, v20
  v_fma_f32 v36, -v113, v44, v36
  v_fma_f32 v21, -v115, v4, v21
  v_fma_f32 v37, -v115, v44, v37
  v_fma_f32 v22, -v117, v4, v22
  v_fma_f32 v38, -v117, v44, v38
  v_fma_f32 v23, -v119, v4, v23
  v_fma_f32 v39, -v119, v44, v39
  v_fma_f32 v24, -v121, v4, v24
  v_fma_f32 v40, -v121, v44, v40
  v_fma_f32 v25, -v123, v4, v25
  v_fma_f32 v41, -v123, v44, v41
  v_fma_f32 v26, -v125, v4, v26
  v_fma_f32 v42, -v125, v44, v42
  v_fma_f32 v27, -v127, v4, v27
  v_fma_f32 v43, -v127, v44, v43
  s_add_u32 m0, s75, 114688
  s_xor_b32 s100, s3, 384
  buffer_load_dwordx4 v253, s[60:63], s100 offen lds
  v_fma_f32 v4, v251, v12, v13
  v_fma_f32 v5, v251, v28, v29
  v_fma_f32 v4, -v213, v28, v4
  v_fma_f32 v5, v213, v12, v5
  v_fma_f32 v2, v251, v4, v14
  v_fma_f32 v3, v251, v5, v30
  v_fma_f32 v2, -v213, v5, v2
  v_fma_f32 v3, v213, v4, v3
  v_fma_f32 v4, v251, v2, v15
  v_fma_f32 v5, v251, v3, v31
  v_fma_f32 v4, -v213, v3, v4
  v_fma_f32 v5, v213, v2, v5
  v_fma_f32 v2, v251, v4, v16
  v_fma_f32 v3, v251, v5, v32
  v_fma_f32 v2, -v213, v5, v2
  v_fma_f32 v3, v213, v4, v3
  v_fma_f32 v4, v251, v2, v17
  v_fma_f32 v5, v251, v3, v33
  v_fma_f32 v4, -v213, v3, v4
  v_fma_f32 v5, v213, v2, v5
  v_fma_f32 v2, v251, v4, v18
  v_fma_f32 v3, v251, v5, v34
  v_fma_f32 v2, -v213, v5, v2
  v_fma_f32 v3, v213, v4, v3
  v_fma_f32 v4, v251, v2, v19
  v_fma_f32 v5, v251, v3, v35
  v_fma_f32 v4, -v213, v3, v4
  v_fma_f32 v5, v213, v2, v5
  v_fma_f32 v2, v251, v4, v20
  v_fma_f32 v3, v251, v5, v36
  v_fma_f32 v2, -v213, v5, v2
  v_fma_f32 v3, v213, v4, v3
  v_fma_f32 v4, v251, v2, v21
  v_fma_f32 v5, v251, v3, v37
  v_fma_f32 v4, -v213, v3, v4
  v_fma_f32 v5, v213, v2, v5
  v_fma_f32 v2, v251, v4, v22
  v_fma_f32 v3, v251, v5, v38
  v_fma_f32 v2, -v213, v5, v2
  v_fma_f32 v3, v213, v4, v3
  v_fma_f32 v4, v251, v2, v23
  v_fma_f32 v5, v251, v3, v39
  v_fma_f32 v4, -v213, v3, v4
  v_fma_f32 v5, v213, v2, v5
  v_fma_f32 v2, v251, v4, v24
  v_fma_f32 v3, v251, v5, v40
  v_fma_f32 v2, -v213, v5, v2
  v_fma_f32 v3, v213, v4, v3
  v_fma_f32 v4, v251, v2, v25
  v_fma_f32 v5, v251, v3, v41
  v_fma_f32 v4, -v213, v3, v4
  v_fma_f32 v5, v213, v2, v5
  v_fma_f32 v2, v251, v4, v26
  v_fma_f32 v3, v251, v5, v42
  v_fma_f32 v2, -v213, v5, v2
  v_fma_f32 v3, v213, v4, v3
  v_fma_f32 v4, v251, v2, v27
  v_fma_f32 v5, v251, v3, v43
  v_fma_f32 v4, -v213, v3, v4
  v_fma_f32 v5, v213, v2, v5
  s_lshl_b32 s92, s84, 8
  s_add_u32 s92, s92, 147456
  v_lshl_add_u32 v242, v244, 3, s92
  v_lshl_add_u32 v241, v243, 9, v242
  s_lshl_b32 s92, s83, 10
  v_add_u32 v241, s92, v241
  ds_write_b64 v241, v[4:5]
  s_lshl_b32 s92, s83, 2
  s_sub_u32 s92, s68, s92
  s_sub_u32 s92, s92, 1
  s_lshl_b32 s92, s92, 13
  s_lshl_b32 s93, s74, 10
  s_add_u32 s92, s92, s93
  s_lshl_b32 s93, s84, 9
  s_add_u32 s92, s92, s93
  v_lshl_add_u32 v6, v244, 4, s92
  v_lshlrev_b32 v7, 14, v243
  v_sub_u32 v6, v6, v7
  v_subrev_u32 v7, 8192, v6
  s_add_u32 m0, s75, 122880
  s_xor_b32 s100, s3, 512
  buffer_load_dwordx4 v253, s[56:59], s100 offen lds
  s_waitcnt lgkmcnt(0)
  s_barrier
  ds_read_b64 v[52:53], v242 offset:0
  ds_read_b64 v[54:55], v242 offset:512
  ds_read_b64 v[56:57], v242 offset:1024
  ds_read_b64 v[58:59], v242 offset:1536
  ds_read_b64 v[60:61], v242 offset:2048
  ds_read_b64 v[62:63], v242 offset:2560
  ds_read_b64 v[64:65], v242 offset:3072
  ds_read_b64 v[66:67], v242 offset:3584
  s_lshl_b32 s92, s83, 1
  v_add_u32 v241, s92, v243
  v_mov_b32 v8, 0
  v_mov_b32 v9, 0
  v_cmp_eq_u32 vcc, 1, v241
  s_waitcnt lgkmcnt(7)
  s_nop 0
  v_cndmask_b32 v8, v8, v52, vcc
  v_cndmask_b32 v9, v9, v53, vcc
  s_waitcnt lgkmcnt(6)
  v_fma_f32 v4, v86, v52, v54
  v_fma_f32 v5, v86, v53, v55
  v_fma_f32 v4, -v87, v53, v4
  v_fma_f32 v5, v87, v52, v5
  v_cmp_eq_u32 vcc, 2, v241
  s_nop 1
  v_cndmask_b32 v8, v8, v4, vcc
  v_cndmask_b32 v9, v9, v5, vcc
  s_waitcnt lgkmcnt(5)
  v_fma_f32 v2, v86, v4, v56
  v_fma_f32 v3, v86, v5, v57
  v_fma_f32 v2, -v87, v5, v2
  v_fma_f32 v3, v87, v4, v3
  v_cmp_eq_u32 vcc, 3, v241
  s_nop 1
  v_cndmask_b32 v8, v8, v2, vcc
  v_cndmask_b32 v9, v9, v3, vcc
  s_waitcnt lgkmcnt(4)
  v_fma_f32 v4, v86, v2, v58
  v_fma_f32 v5, v86, v3, v59
  v_fma_f32 v4, -v87, v3, v4
  v_fma_f32 v5, v87, v2, v5
  v_cmp_eq_u32 vcc, 4, v241
  s_nop 1
  v_cndmask_b32 v8, v8, v4, vcc
  v_cndmask_b32 v9, v9, v5, vcc
  s_waitcnt lgkmcnt(3)
  v_fma_f32 v2, v86, v4, v60
  v_fma_f32 v3, v86, v5, v61
  v_fma_f32 v2, -v87, v5, v2
  v_fma_f32 v3, v87, v4, v3
  v_cmp_eq_u32 vcc, 5, v241
  s_nop 1
  v_cndmask_b32 v8, v8, v2, vcc
  v_cndmask_b32 v9, v9, v3, vcc
  s_waitcnt lgkmcnt(2)
  v_fma_f32 v4, v86, v2, v62
  v_fma_f32 v5, v86, v3, v63
  v_fma_f32 v4, -v87, v3, v4
  v_fma_f32 v5, v87, v2, v5
  v_cmp_eq_u32 vcc, 6, v241
  s_nop 1
  v_cndmask_b32 v8, v8, v4, vcc
  v_cndmask_b32 v9, v9, v5, vcc
  s_waitcnt lgkmcnt(1)
  v_fma_f32 v2, v86, v4, v64
  v_fma_f32 v3, v86, v5, v65
  v_fma_f32 v2, -v87, v5, v2
  v_fma_f32 v3, v87, v4, v3
  v_cmp_eq_u32 vcc, 7, v241
  s_nop 1
  v_cndmask_b32 v8, v8, v2, vcc
  v_cndmask_b32 v9, v9, v3, vcc
  s_waitcnt lgkmcnt(0)
  v_fma_f32 v4, v86, v2, v66
  v_fma_f32 v5, v86, v3, v67
  v_fma_f32 v4, -v87, v3, v4
  v_fma_f32 v5, v87, v2, v5
  s_cmp_lg_u32 s83, 0
  s_nop 1
  s_cbranch_scc1 L_es_S0_2006
  v_mov_b32 v52, v4
  v_mov_b32 v53, s72
  v_mov_b32 v54, v5
  v_mov_b32 v55, s72
  s_lshl_b32 s92, s68, 13
  s_lshl_b32 s93, s74, 10
  s_add_u32 s92, s92, s93
  s_lshl_b32 s93, s84, 9
  s_add_u32 s92, s92, s93
  s_add_u32 s92, s92, 16777216
  s_mov_b64 exec, 0xffffffff
  buffer_store_dwordx4 v[52:55], v234, s[44:47], s92 offen sc1
  s_mov_b64 exec, -1
  s_nop 0
L_es_S0_2006:
  v_mov_b32 v250, 162912
  ds_read_b96 v[52:54], v250
  s_waitcnt lgkmcnt(0)
  v_or3_b32 v52, v52, v53, v54
  s_nop 0
  v_readfirstlane_b32 s80, v52
  v_mov_b32 v245, 0
  v_mov_b32 v207, 0
  v_mov_b32 v254, 0
  v_mul_f32 v254, v212, v12
  v_fma_f32 v254, -v211, v28, v254
  v_mul_f32 v28, v212, v28
  v_fma_f32 v28, v211, v12, v28
  v_mul_f32 v12, v212, v13
  v_fma_f32 v12, -v211, v29, v12
  v_mul_f32 v29, v212, v29
  v_fma_f32 v29, v211, v13, v29
  v_mul_f32 v13, v212, v14
  v_fma_f32 v13, -v211, v30, v13
  v_mul_f32 v30, v212, v30
  v_fma_f32 v30, v211, v14, v30
  v_mul_f32 v14, v212, v15
  v_fma_f32 v14, -v211, v31, v14
  v_mul_f32 v31, v212, v31
  v_fma_f32 v31, v211, v15, v31
  s_add_u32 m0, s75, 131072
  s_xor_b32 s100, s3, 512
  buffer_load_dwordx4 v253, s[60:63], s100 offen lds
  v_mul_f32 v15, v212, v16
  v_fma_f32 v15, -v211, v32, v15
  v_mul_f32 v32, v212, v32
  v_fma_f32 v32, v211, v16, v32
  v_mul_f32 v16, v212, v17
  v_fma_f32 v16, -v211, v33, v16
  v_mul_f32 v33, v212, v33
  v_fma_f32 v33, v211, v17, v33
  v_mul_f32 v17, v212, v18
  v_fma_f32 v17, -v211, v34, v17
  v_mul_f32 v34, v212, v34
  v_fma_f32 v34, v211, v18, v34
  v_mul_f32 v18, v212, v19
  v_fma_f32 v18, -v211, v35, v18
  v_mul_f32 v35, v212, v35
  v_fma_f32 v35, v211, v19, v35
  s_add_u32 m0, s75, 0
  s_xor_b32 s100, s3, 640
  buffer_load_dwordx4 v253, s[56:59], s100 offen lds
  v_mul_f32 v19, v212, v20
  v_fma_f32 v19, -v211, v36, v19
  v_mul_f32 v36, v212, v36
  v_fma_f32 v36, v211, v20, v36
  v_mul_f32 v20, v212, v21
  v_fma_f32 v20, -v211, v37, v20
  v_mul_f32 v37, v212, v37
  v_fma_f32 v37, v211, v21, v37
  v_mul_f32 v21, v212, v22
  v_fma_f32 v21, -v211, v38, v21
  v_mul_f32 v38, v212, v38
  v_fma_f32 v38, v211, v22, v38
  v_mul_f32 v22, v212, v23
  v_fma_f32 v22, -v211, v39, v22
  v_mul_f32 v39, v212, v39
  v_fma_f32 v39, v211, v23, v39
  s_add_u32 m0, s75, 8192
  s_xor_b32 s100, s3, 640
  buffer_load_dwordx4 v253, s[60:63], s100 offen lds
  v_mul_f32 v23, v212, v24
  v_fma_f32 v23, -v211, v40, v23
  v_mul_f32 v40, v212, v40
  v_fma_f32 v40, v211, v24, v40
  v_mul_f32 v24, v212, v25
  v_fma_f32 v24, -v211, v41, v24
  v_mul_f32 v41, v212, v41
  v_fma_f32 v41, v211, v25, v41
  v_mul_f32 v25, v212, v26
  v_fma_f32 v25, -v211, v42, v25
  v_mul_f32 v42, v212, v42
  v_fma_f32 v42, v211, v26, v42
  v_mul_f32 v26, v212, v27
  v_fma_f32 v26, -v211, v43, v26
  v_mul_f32 v43, v212, v43
  v_fma_f32 v43, v211, v27, v43
  s_add_u32 m0, s75, 139264
  s_add_u32 s100, s0, 131072
  s_sub_u32 s99, s100, 1835008
  s_min_u32 s100, s100, s99
  buffer_load_dwordx4 v252, s[52:55], s100 offen lds
  s_add_u32 m0, s75, 16384
  s_xor_b32 s100, s3, 768
  buffer_load_dwordx4 v253, s[56:59], s100 offen lds
  v_mul_f32 v2, v212, v8
  v_mul_f32 v3, v212, v9
  v_fma_f32 v2, -v211, v9, v2
  v_fma_f32 v3, v211, v8, v3
  v_mul_f32 v8, v212, v90
  v_mul_f32 v9, v212, v91
  v_fma_f32 v8, -v211, v91, v8
  v_fma_f32 v9, v211, v90, v9
  s_lshl_b32 s28, s83, 10
  s_lshl_b32 s13, s84, 12
  s_lshr_b32 s92, s71, 5
  s_lshl_b32 s93, s73, 1
  s_add_u32 s93, s93, s84
  s_add_u32 s92, s92, s93
  s_mul_i32 s4, s92, 114688
  s_add_u32 s4, s4, 8388608
  s_add_u32 s4, s4, s28
  s_lshl_b32 s8, s92, 16
  s_lshl_b32 s94, s83, 11
  s_add_u32 s8, s8, s94
  s_add_u32 s8, s8, 4194304
  s_and_b32 s94, s3, 0x380
  s_lshl_b32 s94, s94, 6
  s_add_u32 s8, s8, s94
  s_lshl_b32 s93, s93, 1
  s_lshr_b32 s94, s70, 2
  s_add_u32 s93, s93, s94
  s_lshl_b32 s94, s93, 5
  s_add_u32 s94, s94, s81
  s_add_u32 s5, s94, 2048
  s_lshl_b32 s94, s93, 6
  s_add_u32 s94, s94, s81
  s_add_u32 s6, s94, 3072
  s_add_u32 s64, s36, 16777216
  s_addc_u32 s65, s37, 0
  s_mov_b32 s66, 131072
  s_mov_b32 s67, 0x00020000
  buffer_load_dwordx4 v[44:47], v6, s[64:67], 0 offen sc1
  buffer_load_dwordx4 v[48:51], v7, s[64:67], 0 offen sc1
  s_waitcnt vmcnt(0)
  v_mov_b32 v250, v51
  s_mov_b32 s93, 200000
  s_nop 1
L_el_S0_2007:
  v_mov_b32 v250, 0
  v_cmp_le_i32 vcc, 0, v6
  s_nop 1
  v_cndmask_b32 v249, 0, v233, vcc
  v_xor_b32 v248, v249, v45
  v_xor_b32 v247, v249, v47
  v_or3_b32 v250, v250, v248, v247
  v_cmp_le_i32 vcc, 0, v7
  s_nop 1
  v_cndmask_b32 v249, 0, v233, vcc
  v_xor_b32 v248, v249, v49
  v_xor_b32 v247, v249, v51
  v_or3_b32 v250, v250, v248, v247
  v_cmp_ne_u32 vcc, 0, v250
  s_nop 4
  s_cbranch_vccz L_ed_S0_2008
  s_add_u32 s64, s36, 16777216
  s_addc_u32 s65, s37, 0
  s_mov_b32 s66, 131072
  s_mov_b32 s67, 0x00020000
  buffer_load_dwordx4 v[44:47], v6, s[64:67], 0 offen sc1
  buffer_load_dwordx4 v[48:51], v7, s[64:67], 0 offen sc1
  s_waitcnt vmcnt(0)
  s_sub_u32 s93, s93, 1
  s_cmp_lg_u32 s93, 0
  s_cbranch_scc1 L_el_S0_2007
L_ed_S0_2008:
  v_fma_f32 v248, v88, v48, v44
  v_fma_f32 v247, v88, v50, v46
  v_fma_f32 v248, -v89, v50, v248
  v_fma_f32 v247, v89, v48, v247
  v_mul_f32 v4, v92, v248
  v_mul_f32 v5, v92, v247
  v_fma_f32 v4, -v93, v247, v4
  v_fma_f32 v5, v93, v248, v5
  v_mov_b32 v248, v4
  v_mov_b32 v247, v5
  s_nop 0
  v_permlane32_swap_b32 v4, v248
  v_permlane32_swap_b32 v5, v247
  v_add_f32 v4, v4, v248
  v_add_f32 v5, v5, v247
  s_lshl_b32 s92, s84, 8
  s_add_u32 s92, s92, 151552
  v_lshl_add_u32 v249, v244, 3, s92
  s_lshl_b32 s92, s83, 9
  v_add_u32 v250, s92, v249
  ds_write_b64 v250, v[4:5]
  s_add_u32 m0, s75, 24576
  s_xor_b32 s100, s3, 768
  buffer_load_dwordx4 v253, s[60:63], s100 offen lds
  s_waitcnt lgkmcnt(0)
  s_barrier
  ds_read_b64 v[44:45], v249 offset:0
  ds_read_b64 v[46:47], v249 offset:512
  ds_read_b64 v[48:49], v249 offset:1024
  ds_read_b64 v[50:51], v249 offset:1536
  s_xor_b32 s92, s70, 1
  s_lshl_b32 s92, s92, 11
  s_add_u32 s92, s92, 32768
  v_lshl_add_u32 v250, v244, 5, s92
  v_lshl_add_u32 v250, v243, 4, v250
  v_lshl_add_u32 v249, v243, 10, s92
  v_bfe_u32 v247, v1, 4, 1
  v_lshl_add_u32 v249, v247, 8, v249
  v_lshlrev_b32 v248, 10, v247
  v_and_b32 v247, 15, v1
  v_lshl_add_u32 v249, v247, 3, v249
  v_lshl_add_u32 v248, v243, 9, v248
  v_bfe_u32 v247, v1, 3, 1
  v_lshl_add_u32 v248, v247, 8, v248
  v_and_b32 v247, 7, v1
  v_lshl_add_u32 v248, v247, 4, v248
  s_lshr_b32 s92, s71, 5
  s_add_u32 s92, s92, s83
  s_lshl_b32 s92, s92, 16
  s_lshl_b32 s93, s74, 13
  s_add_u32 s92, s92, s93
  s_lshl_b32 s93, s84, 12
  s_add_u32 s92, s92, s93
  s_add_u32 s87, s92, 4194304
  s_lshl_b32 s92, s70, 3
  s_add_u32 s92, s92, s74
  s_lshl_b32 s92, s92, 2
  s_add_u32 s92, s92, s81
  s_add_u32 s36, s92, 2048
  s_waitcnt lgkmcnt(2)
  v_add_f32 v44, v44, v46
  v_add_f32 v45, v45, v47
  s_waitcnt lgkmcnt(0)
  v_add_f32 v48, v48, v50
  v_add_f32 v49, v49, v51
  v_add_f32 v44, v44, v48
  v_add_f32 v45, v45, v49
  v_fma_f32 v46, v8, v44, v2
  v_fma_f32 v47, v8, v45, v3
  v_fma_f32 v46, -v9, v45, v46
  v_fma_f32 v47, v9, v44, v47
  v_fma_f32 v254, v251, v46, v254
  v_fma_f32 v28, v251, v47, v28
  v_fma_f32 v254, -v213, v47, v254
  v_fma_f32 v28, v213, v46, v28
  v_fma_f32 v12, v251, v254, v12
  v_fma_f32 v29, v251, v28, v29
  v_fma_f32 v12, -v213, v28, v12
  v_fma_f32 v29, v213, v254, v29
  v_cvt_pk_bf16_f32 v4, v254, v12
  v_cvt_pk_bf16_f32 v52, -v28, -v29
  v_fma_f32 v13, v251, v12, v13
  v_fma_f32 v30, v251, v29, v30
  v_fma_f32 v13, -v213, v29, v13
  v_fma_f32 v30, v213, v12, v30
  v_fma_f32 v14, v251, v13, v14
  v_fma_f32 v31, v251, v30, v31
  v_fma_f32 v14, -v213, v30, v14
  v_fma_f32 v31, v213, v13, v31
  v_cvt_pk_bf16_f32 v5, v13, v14
  v_cvt_pk_bf16_f32 v53, -v30, -v31
  v_fma_f32 v15, v251, v14, v15
  v_fma_f32 v32, v251, v31, v32
  v_fma_f32 v15, -v213, v31, v15
  v_fma_f32 v32, v213, v14, v32
  v_fma_f32 v16, v251, v15, v16
  v_fma_f32 v33, v251, v32, v33
  v_fma_f32 v16, -v213, v32, v16
  v_fma_f32 v33, v213, v15, v33
  v_cvt_pk_bf16_f32 v6, v15, v16
  v_cvt_pk_bf16_f32 v54, -v32, -v33
  v_fma_f32 v17, v251, v16, v17
  v_fma_f32 v34, v251, v33, v34
  v_fma_f32 v17, -v213, v33, v17
  v_fma_f32 v34, v213, v16, v34
  v_fma_f32 v18, v251, v17, v18
  v_fma_f32 v35, v251, v34, v35
  v_fma_f32 v18, -v213, v34, v18
  v_fma_f32 v35, v213, v17, v35
  v_cvt_pk_bf16_f32 v7, v17, v18
  v_cvt_pk_bf16_f32 v55, -v34, -v35
  ds_write_b128 v250, v[4:7]
  ds_write_b128 v250, v[52:55] offset:1024
  ds_read_b64_tr_b16 v[56:57], v249 offset:0
  ds_read_b64_tr_b16 v[58:59], v249 offset:128
  ds_read_b64_tr_b16 v[60:61], v249 offset:512
  ds_read_b64_tr_b16 v[62:63], v249 offset:640
  v_fma_f32 v19, v251, v18, v19
  v_fma_f32 v36, v251, v35, v36
  v_fma_f32 v19, -v213, v35, v19
  v_fma_f32 v36, v213, v18, v36
  v_fma_f32 v20, v251, v19, v20
  v_fma_f32 v37, v251, v36, v37
  v_fma_f32 v20, -v213, v36, v20
  v_fma_f32 v37, v213, v19, v37
  v_cvt_pk_bf16_f32 v4, v19, v20
  v_cvt_pk_bf16_f32 v52, -v36, -v37
  v_fma_f32 v21, v251, v20, v21
  v_fma_f32 v38, v251, v37, v38
  v_fma_f32 v21, -v213, v37, v21
  v_fma_f32 v38, v213, v20, v38
  v_fma_f32 v22, v251, v21, v22
  v_fma_f32 v39, v251, v38, v39
  v_fma_f32 v22, -v213, v38, v22
  v_fma_f32 v39, v213, v21, v39
  v_cvt_pk_bf16_f32 v5, v21, v22
  v_cvt_pk_bf16_f32 v53, -v38, -v39
  s_waitcnt lgkmcnt(2)
  buffer_store_dwordx4 v[56:59], v248, s[44:47], s87 offen offset:0 sc1
  s_waitcnt lgkmcnt(0)
  buffer_store_dwordx4 v[60:63], v248, s[44:47], s87 offen offset:2048 sc1
  v_fma_f32 v23, v251, v22, v23
  v_fma_f32 v40, v251, v39, v40
  v_fma_f32 v23, -v213, v39, v23
  v_fma_f32 v40, v213, v22, v40
  v_fma_f32 v24, v251, v23, v24
  v_fma_f32 v41, v251, v40, v41
  v_fma_f32 v24, -v213, v40, v24
  v_fma_f32 v41, v213, v23, v41
  v_cvt_pk_bf16_f32 v6, v23, v24
  v_cvt_pk_bf16_f32 v54, -v40, -v41
  v_fma_f32 v25, v251, v24, v25
  v_fma_f32 v42, v251, v41, v42
  v_fma_f32 v25, -v213, v41, v25
  v_fma_f32 v42, v213, v24, v42
  v_fma_f32 v26, v251, v25, v26
  v_fma_f32 v43, v251, v42, v43
  v_fma_f32 v26, -v213, v42, v26
  v_fma_f32 v43, v213, v25, v43
  v_cvt_pk_bf16_f32 v7, v25, v26
  v_cvt_pk_bf16_f32 v55, -v42, -v43
  ds_write_b128 v250, v[4:7]
  ds_write_b128 v250, v[52:55] offset:1024
  ds_read_b64_tr_b16 v[64:65], v249 offset:0
  ds_read_b64_tr_b16 v[66:67], v249 offset:128
  ds_read_b64_tr_b16 v[68:69], v249 offset:512
  ds_read_b64_tr_b16 v[70:71], v249 offset:640
  s_waitcnt lgkmcnt(2)
  buffer_store_dwordx4 v[64:67], v248, s[44:47], s87 offen offset:128 sc1
  s_waitcnt lgkmcnt(0)
  buffer_store_dwordx4 v[68:71], v248, s[44:47], s87 offen offset:2176 sc1
  s_lshl_b32 s92, s68, 1
  s_and_b32 s93, s74, 1
  s_add_u32 s92, s92, s93
  s_lshl_b32 s92, s92, 3
  s_add_u32 s92, s92, s70
  s_sub_u32 s92, 351, s92
  s_mov_b32 s64, s30
  s_mov_b32 s65, s31
  s_mov_b32 s66, 1835008
  s_mov_b32 s94, 0
  s_cmp_ge_u32 s92, 224
  s_cselect_b32 s64, s14, s64
  s_cselect_b32 s65, s15, s65
  s_cselect_b32 s66, 524288, s66
  s_cselect_b32 s94, 224, s94
  s_cmp_ge_u32 s92, 288
  s_cselect_b32 s64, s16, s64
  s_cselect_b32 s65, s17, s65
  s_cselect_b32 s66, 524288, s66
  s_cselect_b32 s94, 288, s94
  s_mov_b32 s67, 0x00020000
  s_sub_u32 s94, s92, s94
  s_lshl_b32 s94, s94, 13
  v_lshlrev_b32 v254, 7, v1
  s_mov_b32 m0, 163456
  s_nop 0
  buffer_load_dword v254, s[64:67], s94 offen lds
  s_sub_u32 s92, s92, 256
  s_cmp_ge_u32 s92, 96
  s_cbranch_scc1 L_wm_S0_2009
  s_mov_b32 s64, s30
  s_mov_b32 s65, s31
  s_mov_b32 s66, 1835008
  s_mov_b32 s94, 0
  s_mov_b32 s67, 0x00020000
  s_sub_u32 s94, s92, s94
  s_lshl_b32 s94, s94, 13
  v_lshlrev_b32 v254, 7, v1
  s_mov_b32 m0, 163456
  s_nop 0
  buffer_load_dword v254, s[64:67], s94 offen lds
L_wm_S0_2009:
  s_waitcnt vmcnt(1)
  s_mov_b64 exec, 1
  s_cmp_eq_u32 s80, 0
  s_cbranch_scc1 L_du_S0_1_f
  buffer_store_dword v233, off, s[44:47], s36 sc1
  s_branch L_du_S0_1_d
L_du_S0_1_f:
  buffer_store_dword v233, off, s[44:47], s36
L_du_S0_1_d:
  s_mov_b64 exec, -1
  v_lshrrev_b32 v249, 5, v1
  v_bfe_u32 v251, v1, 2, 2
  v_lshl_add_u32 v250, v249, 2, v251
  v_lshlrev_b32 v254, 7, v250
  v_lshrrev_b32 v251, 1, v251
  v_lshlrev_b32 v251, 2, v251
  v_lshl_add_u32 v251, v249, 1, v251
  v_bfe_u32 v250, v1, 4, 1
  v_bfe_u32 v249, v1, 1, 1
  v_lshl_add_u32 v250, v250, 1, v249
  v_xor_b32 v250, v250, v251
  v_lshl_add_u32 v254, v250, 4, v254
  v_and_b32 v250, 1, v1
  v_lshl_add_u32 v254, v250, 3, v254
  v_lshl_add_u32 v249, s83, 11, v254
  v_xor_b32 v248, 64, v249
  v_and_b32 v245, 31, v1
  v_bfe_u32 v243, v1, 1, 3
  s_lshl_b32 s92, s83, 1
  v_xor_b32 v244, s92, v243
  v_lshlrev_b32 v244, 4, v244
  v_lshl_add_u32 v251, v245, 7, v244
  v_lshrrev_b32 v244, 5, v1
  v_lshl_add_u32 v251, v244, 13, v251
  v_xor_b32 v250, 16, v251
  v_xor_b32 v244, v244, v243
  v_lshlrev_b32 v244, 4, v244
  v_lshl_add_u32 v247, v245, 7, v244
  v_add_u32 v247, s13, v247
  v_lshrrev_b32 v245, 3, v1
  v_lshl_add_u32 v245, s83, 3, v245
  v_bfe_u32 v244, v245, 1, 3
  v_xor_b32 v244, v244, v1
  v_and_b32 v244, 7, v244
  v_lshlrev_b32 v244, 4, v244
  v_lshl_add_u32 v246, v245, 7, v244
  v_add_u32 v246, s13, v246
  v_add_u32 v245, 65536, v251
  v_add_u32 v244, 131072, v251
  v_add_u32 v243, 65536, v250
  v_add_u32 v242, 131072, v250
  v_add_u32 v241, 65536, v249
  v_add_u32 v240, 131072, v249
  v_add_u32 v239, 65536, v248
  v_add_u32 v238, 131072, v248
  v_add_u32 v237, 65536, v246
  v_add_u32 v236, 131072, v246
  s_mov_b64 exec, 0xff
  buffer_load_dword v254, v235, s[44:47], s5 offen sc1
  s_mov_b64 exec, -1
  s_mov_b32 s64, s20
  s_mov_b32 s65, s21
  s_mov_b32 s66, 1024
  s_mov_b32 s67, 0x00020000
  v_lshrrev_b32 v232, 3, v1
  v_and_b32 v229, 7, v1
  v_lshlrev_b32 v231, 3, v229
  buffer_load_dwordx2 v[8:9], v231, s[64:67], s79 offen
  buffer_load_dwordx2 v[10:11], v231, s[64:67], s79 offen offset:64
  v_lshl_add_u32 v230, v232, 10, v231
  s_lshl_b32 s92, s73, 6
  s_lshl_b32 s93, s84, 5
  s_add_u32 s92, s92, s93
  s_lshl_b32 s93, s83, 3
  s_add_u32 s92, s92, s93
  s_add_u32 s93, s92, s71
  s_lshl_b32 s93, s93, 10
  s_add_u32 s88, s93, s79
  buffer_load_dwordx2 v[4:5], v230, s[40:43], s88 offen
  buffer_load_dwordx2 v[6:7], v230, s[40:43], s88 offen offset:64
  s_lshl_b32 s92, s92, 3
  s_add_u32 s92, s92, 157776
  v_lshl_add_u32 v231, v232, 3, s92
  ds_read_b64 v[2:3], v231
  v_lshlrev_b32 v232, 4, v232
  v_and_b32 v231, 1, v229
  v_lshl_add_u32 v232, v231, 9, v232
  v_bfe_u32 v231, v229, 1, 1
  v_lshl_add_u32 v232, v231, 10, v232
  v_lshrrev_b32 v231, 2, v229
  v_lshl_add_u32 v229, v231, 3, v232
  s_lshr_b32 s92, s71, 5
  s_lshl_b32 s93, s73, 1
  s_add_u32 s92, s92, s93
  s_add_u32 s92, s92, s84
  s_lshl_b32 s92, s92, 15
  s_lshl_b32 s93, s79, 5
  s_add_u32 s92, s92, s93
  s_lshl_b32 s93, s83, 7
  s_add_u32 s92, s92, s93
  s_add_u32 s69, s92, 2097152
  v_lshlrev_b32 v230, 1, v230
  s_lshl_b32 s88, s88, 1
  s_mov_b32 s64, s32
  s_mov_b32 s65, s33
  s_mov_b32 s66, 4194304
  s_mov_b32 s67, 0x00020000
  s_lshl_b32 s97, s4, 4
  s_sub_u32 s74, s79, s97
  s_add_u32 s10, s1, s4
  v_mov_b32 v232, v234
  s_add_u32 s97, s1, 8192
  s_sub_u32 s98, s97, 114688
  s_min_u32 s97, s97, s98
  s_add_u32 s11, s97, s4
  s_add_u32 s97, s1, 16384
  s_sub_u32 s98, s97, 114688
  s_min_u32 s97, s97, s98
  s_add_u32 s12, s97, s4
  s_add_u32 s97, s1, 24576
  s_sub_u32 s98, s97, 114688
  s_min_u32 s97, s97, s98
  s_add_u32 s14, s97, s4
  s_add_u32 s97, s1, 32768
  s_sub_u32 s98, s97, 114688
  s_min_u32 s97, s97, s98
  s_add_u32 s15, s97, s4
  s_add_u32 s97, s1, 40960
  s_sub_u32 s98, s97, 114688
  s_min_u32 s97, s97, s98
  s_add_u32 s16, s97, s4
  s_add_u32 s97, s1, 49152
  s_sub_u32 s98, s97, 114688
  s_min_u32 s97, s97, s98
  s_add_u32 s17, s97, s4
  s_add_u32 s97, s1, 57344
  s_sub_u32 s98, s97, 114688
  s_min_u32 s97, s97, s98
  s_add_u32 s30, s97, s4
  s_add_u32 s97, s1, 65536
  s_sub_u32 s98, s97, 114688
  s_min_u32 s97, s97, s98
  s_add_u32 s31, s97, s4
  s_add_u32 s97, s1, 73728
  s_sub_u32 s98, s97, 114688
  s_min_u32 s97, s97, s98
  s_add_u32 s89, s97, s4
  s_add_u32 s97, s1, 81920
  s_sub_u32 s98, s97, 114688
  s_min_u32 s97, s97, s98
  s_add_u32 s90, s97, s4
  s_add_u32 s97, s1, 90112
  s_sub_u32 s98, s97, 114688
  s_min_u32 s97, s97, s98
  s_add_u32 s91, s97, s4
  s_add_u32 s97, s1, 98304
  s_sub_u32 s98, s97, 114688
  s_min_u32 s97, s97, s98
  s_add_u32 s87, s97, s4
  s_add_u32 s97, s1, 106496
  s_sub_u32 s98, s97, 114688
  s_min_u32 s97, s97, s98
  s_add_u32 s82, s97, s4
  s_waitcnt vmcnt(4)
  v_mov_b32 v254, v254
  s_mov_b32 s101, 200000
  s_mov_b64 exec, 0xff
  s_nop 0
L_pl_S0_2010:
  v_cmp_ne_u32 vcc, s72, v254
  s_nop 4
  s_cbranch_vccz L_pd_S0_2011
  buffer_load_dword v254, v235, s[44:47], s5 offen sc1
  s_waitcnt vmcnt(0)
  s_sub_u32 s101, s101, 1
  s_cmp_lg_u32 s101, 0
  s_cbranch_scc1 L_pl_S0_2010
L_pd_S0_2011:
  s_mov_b64 exec, -1
  s_xor_b32 s100, s8, 0
  buffer_load_dwordx4 v[12:15], v234, s[44:47], s100 offen offset:0 sc1
  s_xor_b32 s100, s8, 0
  buffer_load_dwordx4 v[16:19], v234, s[44:47], s100 offen offset:1024 sc1
  s_xor_b32 s100, s8, 8192
  buffer_load_dwordx4 v[20:23], v234, s[44:47], s100 offen offset:0 sc1
  s_xor_b32 s100, s8, 8192
  buffer_load_dwordx4 v[24:27], v234, s[44:47], s100 offen offset:1024 sc1
  s_xor_b32 s100, s8, 16384
  buffer_load_dwordx4 v[28:31], v234, s[44:47], s100 offen offset:0 sc1
  s_xor_b32 s100, s8, 16384
  buffer_load_dwordx4 v[32:35], v234, s[44:47], s100 offen offset:1024 sc1
  s_xor_b32 s100, s8, 24576
  buffer_load_dwordx4 v[36:39], v234, s[44:47], s100 offen offset:0 sc1
  s_xor_b32 s100, s8, 24576
  buffer_load_dwordx4 v[40:43], v234, s[44:47], s100 offen offset:1024 sc1
  s_xor_b32 s100, s8, 32768
  buffer_load_dwordx4 v[44:47], v234, s[44:47], s100 offen offset:0 sc1
  s_xor_b32 s100, s8, 32768
  buffer_load_dwordx4 v[48:51], v234, s[44:47], s100 offen offset:1024 sc1
  s_xor_b32 s100, s8, 40960
  buffer_load_dwordx4 v[52:55], v234, s[44:47], s100 offen offset:0 sc1
  s_xor_b32 s100, s8, 40960
  buffer_load_dwordx4 v[56:59], v234, s[44:47], s100 offen offset:1024 sc1
  s_xor_b32 s100, s8, 49152
  buffer_load_dwordx4 v[60:63], v234, s[44:47], s100 offen offset:0 sc1
  s_xor_b32 s100, s8, 49152
  buffer_load_dwordx4 v[64:67], v234, s[44:47], s100 offen offset:1024 sc1
  s_xor_b32 s100, s8, 57344
  buffer_load_dwordx4 v[68:71], v234, s[44:47], s100 offen offset:0 sc1
  s_xor_b32 s100, s8, 57344
  buffer_load_dwordx4 v[72:75], v234, s[44:47], s100 offen offset:1024 sc1
  s_waitcnt vmcnt(17)
  v_lshlrev_b32 v254, 16, v4
  v_and_b32 v231, 0xffff0000, v4
  s_waitcnt lgkmcnt(0)
  v_sub_f32 v254, v254, v2
  v_sub_f32 v231, v231, v2
  v_cvt_pk_bf16_f32 v84, v254, v231
  v_lshlrev_b32 v254, 16, v84
  v_and_b32 v231, 0xffff0000, v84
  v_mul_f32 v254, v254, v3
  v_mul_f32 v231, v231, v3
  v_cvt_pk_bf16_f32 v84, v254, v231
  v_lshlrev_b32 v254, 16, v5
  v_and_b32 v231, 0xffff0000, v5
  v_sub_f32 v254, v254, v2
  v_sub_f32 v231, v231, v2
  v_cvt_pk_bf16_f32 v85, v254, v231
  v_lshlrev_b32 v254, 16, v85
  v_and_b32 v231, 0xffff0000, v85
  v_mul_f32 v254, v254, v3
  v_mul_f32 v231, v231, v3
  v_cvt_pk_bf16_f32 v85, v254, v231
  s_waitcnt vmcnt(16)
  v_lshlrev_b32 v254, 16, v6
  v_and_b32 v231, 0xffff0000, v6
  v_sub_f32 v254, v254, v2
  v_sub_f32 v231, v231, v2
  v_cvt_pk_bf16_f32 v86, v254, v231
  v_lshlrev_b32 v254, 16, v86
  v_and_b32 v231, 0xffff0000, v86
  v_mul_f32 v254, v254, v3
  v_mul_f32 v231, v231, v3
  v_cvt_pk_bf16_f32 v86, v254, v231
  v_lshlrev_b32 v254, 16, v7
  v_and_b32 v231, 0xffff0000, v7
  v_sub_f32 v254, v254, v2
  v_sub_f32 v231, v231, v2
  v_cvt_pk_bf16_f32 v87, v254, v231
  v_lshlrev_b32 v254, 16, v87
  v_and_b32 v231, 0xffff0000, v87
  v_mul_f32 v254, v254, v3
  v_mul_f32 v231, v231, v3
  v_cvt_pk_bf16_f32 v87, v254, v231
  v_lshlrev_b32 v254, 16, v84
  v_and_b32 v231, 0xffff0000, v84
  v_lshlrev_b32 v76, 16, v8
  v_and_b32 v77, 0xffff0000, v8
  v_mul_f32 v254, v254, v76
  v_mul_f32 v231, v231, v77
  v_cvt_pk_bf16_f32 v77, v254, v231
  v_lshlrev_b32 v76, 16, v77
  v_and_b32 v77, 0xffff0000, v77
  v_lshlrev_b32 v254, 16, v85
  v_and_b32 v231, 0xffff0000, v85
  v_lshlrev_b32 v78, 16, v9
  v_and_b32 v79, 0xffff0000, v9
  v_mul_f32 v254, v254, v78
  v_mul_f32 v231, v231, v79
  v_cvt_pk_bf16_f32 v79, v254, v231
  v_lshlrev_b32 v78, 16, v79
  v_and_b32 v79, 0xffff0000, v79
  v_lshlrev_b32 v254, 16, v86
  v_and_b32 v231, 0xffff0000, v86
  v_lshlrev_b32 v80, 16, v10
  v_and_b32 v81, 0xffff0000, v10
  v_mul_f32 v254, v254, v80
  v_mul_f32 v231, v231, v81
  v_cvt_pk_bf16_f32 v81, v254, v231
  v_lshlrev_b32 v80, 16, v81
  v_and_b32 v81, 0xffff0000, v81
  v_lshlrev_b32 v254, 16, v87
  v_and_b32 v231, 0xffff0000, v87
  v_lshlrev_b32 v82, 16, v11
  v_and_b32 v83, 0xffff0000, v11
  v_mul_f32 v254, v254, v82
  v_mul_f32 v231, v231, v83
  v_cvt_pk_bf16_f32 v83, v254, v231
  v_lshlrev_b32 v82, 16, v83
  v_and_b32 v83, 0xffff0000, v83
  s_waitcnt lgkmcnt(0)
  s_barrier
  ds_read_b128 v[116:119], v251 offset:49152
  ds_read_b128 v[120:123], v251 offset:53248
  s_add_u32 m0, s75, 32768
  s_xor_b32 s100, s3, 896
  buffer_load_dwordx4 v253, s[56:59], s100 offen lds
  s_add_u32 m0, s75, 40960
  s_xor_b32 s100, s3, 896
  buffer_load_dwordx4 v253, s[60:63], s100 offen lds
  ds_read_b128 v[124:127], v250 offset:49152
  ds_read_b128 v[128:131], v250 offset:53248
  s_add_u32 m0, s75, 147456
  s_lshl4_add_u32 s100, s12, s74
  buffer_load_dwordx4 v252, s[52:55], s100 offen lds
  s_waitcnt vmcnt(18) lgkmcnt(3)
  v_mfma_f32_32x32x16_bf16 v[84:99], v[116:119], v[12:15], 0
  s_waitcnt lgkmcnt(2)
  v_mfma_f32_32x32x16_bf16 v[100:115], v[120:123], v[12:15], 0
  ds_read_b128 v[132:135], v245 offset:8192
  ds_read_b128 v[136:139], v245 offset:12288
  s_waitcnt vmcnt(17) lgkmcnt(3)
  v_mfma_f32_32x32x16_bf16 v[84:99], v[124:127], v[16:19], v[84:99]
  s_waitcnt lgkmcnt(2)
  v_mfma_f32_32x32x16_bf16 v[100:115], v[128:131], v[16:19], v[100:115]
  ds_read_b128 v[116:119], v243 offset:8192
  ds_read_b128 v[120:123], v243 offset:12288
  s_waitcnt vmcnt(16) lgkmcnt(3)
  v_mfma_f32_32x32x16_bf16 v[84:99], v[132:135], v[20:23], v[84:99]
  s_waitcnt lgkmcnt(2)
  v_mfma_f32_32x32x16_bf16 v[100:115], v[136:139], v[20:23], v[100:115]
  s_waitcnt lgkmcnt(0)
  s_barrier
  ds_read_b128 v[124:127], v245 offset:24576
  ds_read_b128 v[128:131], v245 offset:28672
  s_add_u32 m0, s75, 49152
  s_lshl4_add_u32 s100, s14, s74
  buffer_load_dwordx4 v252, s[52:55], s100 offen lds
  s_waitcnt vmcnt(16)
  v_mfma_f32_32x32x16_bf16 v[84:99], v[116:119], v[24:27], v[84:99]
  v_mfma_f32_32x32x16_bf16 v[100:115], v[120:123], v[24:27], v[100:115]
  s_add_u32 m0, s75, 57344
  s_lshl4_add_u32 s100, s15, s74
  buffer_load_dwordx4 v252, s[52:55], s100 offen lds
  ds_read_b128 v[132:135], v243 offset:24576
  ds_read_b128 v[136:139], v243 offset:28672
  s_add_u32 m0, s75, 73728
  s_lshl4_add_u32 s100, s16, s74
  buffer_load_dwordx4 v252, s[52:55], s100 offen lds
  s_waitcnt vmcnt(17) lgkmcnt(3)
  v_mfma_f32_32x32x16_bf16 v[84:99], v[124:127], v[28:31], v[84:99]
  s_waitcnt lgkmcnt(2)
  v_mfma_f32_32x32x16_bf16 v[100:115], v[128:131], v[28:31], v[100:115]
  s_add_u32 m0, s75, 81920
  s_lshl4_add_u32 s100, s17, s74
  buffer_load_dwordx4 v252, s[52:55], s100 offen lds
  ds_read_b128 v[116:119], v245 offset:40960
  ds_read_b128 v[120:123], v245 offset:45056
  s_waitcnt vmcnt(17) lgkmcnt(3)
  v_mfma_f32_32x32x16_bf16 v[84:99], v[132:135], v[32:35], v[84:99]
  s_waitcnt lgkmcnt(2)
  v_mfma_f32_32x32x16_bf16 v[100:115], v[136:139], v[32:35], v[100:115]
  ds_read_b128 v[124:127], v243 offset:40960
  ds_read_b128 v[128:131], v243 offset:45056
  s_waitcnt vmcnt(16) lgkmcnt(3)
  v_mfma_f32_32x32x16_bf16 v[84:99], v[116:119], v[36:39], v[84:99]
  s_waitcnt lgkmcnt(2)
  v_mfma_f32_32x32x16_bf16 v[100:115], v[120:123], v[36:39], v[100:115]
  s_waitcnt lgkmcnt(0)
  s_barrier
  ds_read_b128 v[132:135], v245 offset:57344
  ds_read_b128 v[136:139], v245 offset:61440
  s_add_u32 m0, s75, 90112
  s_lshl4_add_u32 s100, s30, s74
  buffer_load_dwordx4 v252, s[52:55], s100 offen lds
  s_waitcnt vmcnt(16)
  v_mfma_f32_32x32x16_bf16 v[84:99], v[124:127], v[40:43], v[84:99]
  v_mfma_f32_32x32x16_bf16 v[100:115], v[128:131], v[40:43], v[100:115]
  ds_read_b128 v[116:119], v243 offset:57344
  ds_read_b128 v[120:123], v243 offset:61440
  s_add_u32 m0, s75, 98304
  s_lshl4_add_u32 s100, s31, s74
  buffer_load_dwordx4 v252, s[52:55], s100 offen lds
  s_waitcnt vmcnt(16) lgkmcnt(3)
  v_mfma_f32_32x32x16_bf16 v[84:99], v[132:135], v[44:47], v[84:99]
  s_waitcnt lgkmcnt(2)
  v_mfma_f32_32x32x16_bf16 v[100:115], v[136:139], v[44:47], v[100:115]
  ds_read_b128 v[124:127], v251
  ds_read_b128 v[128:131], v251 offset:4096
  s_add_u32 m0, s75, 106496
  s_lshl4_add_u32 s100, s89, s74
  buffer_load_dwordx4 v252, s[52:55], s100 offen lds
  s_waitcnt vmcnt(16) lgkmcnt(3)
  v_mfma_f32_32x32x16_bf16 v[84:99], v[116:119], v[48:51], v[84:99]
  s_waitcnt lgkmcnt(2)
  v_mfma_f32_32x32x16_bf16 v[100:115], v[120:123], v[48:51], v[100:115]
  ds_read_b128 v[132:135], v250
  ds_read_b128 v[136:139], v250 offset:4096
  s_add_u32 m0, s75, 114688
  s_lshl4_add_u32 s100, s90, s74
  buffer_load_dwordx4 v252, s[52:55], s100 offen lds
  s_waitcnt vmcnt(16) lgkmcnt(3)
  v_mfma_f32_32x32x16_bf16 v[84:99], v[124:127], v[52:55], v[84:99]
  s_waitcnt lgkmcnt(2)
  v_mfma_f32_32x32x16_bf16 v[100:115], v[128:131], v[52:55], v[100:115]
  s_waitcnt vmcnt(9)
  s_waitcnt lgkmcnt(0)
  s_barrier
  ds_read_b128 v[116:119], v251 offset:16384
  ds_read_b128 v[120:123], v251 offset:20480
  s_add_u32 m0, s75, 0
  s_lshl4_add_u32 s100, s91, s74
  buffer_load_dwordx4 v252, s[52:55], s100 offen lds
  v_mfma_f32_32x32x16_bf16 v[84:99], v[132:135], v[56:59], v[84:99]
  v_mfma_f32_32x32x16_bf16 v[100:115], v[136:139], v[56:59], v[100:115]
  ds_read_b128 v[124:127], v250 offset:16384
  ds_read_b128 v[128:131], v250 offset:20480
  s_add_u32 m0, s75, 8192
  s_lshl4_add_u32 s100, s87, s74
  buffer_load_dwordx4 v252, s[52:55], s100 offen lds
  s_waitcnt lgkmcnt(3)
  v_mfma_f32_32x32x16_bf16 v[84:99], v[116:119], v[60:63], v[84:99]
  s_waitcnt lgkmcnt(2)
  v_mfma_f32_32x32x16_bf16 v[100:115], v[120:123], v[60:63], v[100:115]
  ds_read_b128 v[132:135], v251 offset:32768
  ds_read_b128 v[136:139], v251 offset:36864
  s_add_u32 m0, s75, 122880
  s_lshl4_add_u32 s100, s82, s74
  buffer_load_dwordx4 v252, s[52:55], s100 offen lds
  s_waitcnt lgkmcnt(3)
  v_mfma_f32_32x32x16_bf16 v[84:99], v[124:127], v[64:67], v[84:99]
  s_waitcnt lgkmcnt(2)
  v_mfma_f32_32x32x16_bf16 v[100:115], v[128:131], v[64:67], v[100:115]
  ds_read_b128 v[116:119], v250 offset:32768
  ds_read_b128 v[120:123], v250 offset:36864
  s_mov_b64 exec, 0x3fff
  buffer_load_dword v254, v235, s[44:47], s6 offen sc1
  s_mov_b64 exec, -1
  s_add_u32 m0, s75, 131072
  v_add_u32 v252, 0x10000, v252
  s_lshl4_add_u32 s100, s10, s74
  buffer_load_dwordx4 v252, s[52:55], s100 offen lds
  s_waitcnt lgkmcnt(3)
  v_mfma_f32_32x32x16_bf16 v[84:99], v[132:135], v[68:71], v[84:99]
  s_waitcnt lgkmcnt(2)
  v_mfma_f32_32x32x16_bf16 v[100:115], v[136:139], v[68:71], v[100:115]
  s_waitcnt vmcnt(13)
  s_waitcnt vmcnt(12)
  s_waitcnt lgkmcnt(0)
  s_barrier
  ds_read_b64_tr_b16 v[124:125], v241
  ds_read_b64_tr_b16 v[126:127], v241 offset:1024
  ds_read_b64_tr_b16 v[128:129], v239
  ds_read_b64_tr_b16 v[130:131], v239 offset:1024
  s_waitcnt vmcnt(1)
  v_mov_b32 v254, v254
  s_mov_b32 s101, 200000
  s_mov_b64 exec, 0x3fff
  s_nop 0
L_pl_S0_12012:
  v_cmp_ne_u32 vcc, s72, v254
  s_nop 4
  s_cbranch_vccz L_pd_S0_12013
  buffer_load_dword v254, v235, s[44:47], s6 offen sc1
  s_waitcnt vmcnt(0)
  s_sub_u32 s101, s101, 1
  s_cmp_lg_u32 s101, 0
  s_cbranch_scc1 L_pl_S0_12012
L_pd_S0_12013:
  s_mov_b64 exec, -1
  buffer_load_dwordx4 v[8:11], v232, s[44:47], s10 offen sc1
  v_mfma_f32_32x32x16_bf16 v[84:99], v[116:119], v[72:75], v[84:99]
  v_mfma_f32_32x32x16_bf16 v[100:115], v[120:123], v[72:75], v[100:115]
  buffer_load_dwordx4 v[140:143], v232, s[44:47], s11 offen sc1
  ds_read_b64_tr_b16 v[132:133], v240 offset:8192
  ds_read_b64_tr_b16 v[134:135], v240 offset:9216
  ds_read_b64_tr_b16 v[136:137], v238 offset:8192
  ds_read_b64_tr_b16 v[138:139], v238 offset:9216
  buffer_load_dwordx4 v[144:147], v232, s[44:47], s12 offen sc1
  s_waitcnt vmcnt(2) lgkmcnt(6)
  v_mfma_f32_32x32x16_bf16 v[152:167], v[124:127], v[8:11], 0
  s_waitcnt lgkmcnt(4)
  v_mfma_f32_32x32x16_bf16 v[168:183], v[128:131], v[8:11], 0
  buffer_load_dwordx4 v[148:151], v232, s[44:47], s14 offen sc1
  ds_read_b64_tr_b16 v[116:117], v240 offset:16384
  ds_read_b64_tr_b16 v[118:119], v240 offset:17408
  ds_read_b64_tr_b16 v[120:121], v238 offset:16384
  ds_read_b64_tr_b16 v[122:123], v238 offset:17408
  buffer_load_dwordx2 v[184:185], v229, s[44:47], s69 offen sc1
  buffer_load_dwordx2 v[186:187], v229, s[44:47], s69 offen offset:2048 sc1
  buffer_load_dwordx4 v[12:15], v232, s[44:47], s15 offen sc1
  s_waitcnt vmcnt(5) lgkmcnt(6)
  v_mfma_f32_32x32x16_bf16 v[152:167], v[132:135], v[140:143], v[152:167]
  s_waitcnt lgkmcnt(4)
  v_mfma_f32_32x32x16_bf16 v[168:183], v[136:139], v[140:143], v[168:183]
  buffer_load_dwordx4 v[16:19], v232, s[44:47], s16 offen sc1
  ds_read_b64_tr_b16 v[124:125], v249 offset:49152
  ds_read_b64_tr_b16 v[126:127], v249 offset:50176
  ds_read_b64_tr_b16 v[128:129], v248 offset:49152
  ds_read_b64_tr_b16 v[130:131], v248 offset:50176
  buffer_load_dwordx4 v[20:23], v232, s[44:47], s17 offen sc1
  s_waitcnt vmcnt(6) lgkmcnt(6)
  v_mfma_f32_32x32x16_bf16 v[152:167], v[116:119], v[144:147], v[152:167]
  s_waitcnt lgkmcnt(4)
  v_mfma_f32_32x32x16_bf16 v[168:183], v[120:123], v[144:147], v[168:183]
  buffer_load_dwordx4 v[24:27], v232, s[44:47], s30 offen sc1
  s_waitcnt lgkmcnt(0)
  s_barrier
  ds_read_b64_tr_b16 v[132:133], v249 offset:57344
  ds_read_b64_tr_b16 v[134:135], v249 offset:58368
  ds_read_b64_tr_b16 v[136:137], v248 offset:57344
  ds_read_b64_tr_b16 v[138:139], v248 offset:58368
  buffer_load_dwordx4 v[28:31], v232, s[44:47], s31 offen sc1
  s_waitcnt vmcnt(7)
  v_mfma_f32_32x32x16_bf16 v[152:167], v[124:127], v[148:151], v[152:167]
  v_mfma_f32_32x32x16_bf16 v[168:183], v[128:131], v[148:151], v[168:183]
  s_mov_b32 s92, 16384
  s_cmp_eq_u32 s83, 1
  s_cselect_b32 s92, 24576, s92
  s_cmp_eq_u32 s83, 2
  s_cselect_b32 s92, 32768, s92
  buffer_load_dwordx4 v[32:35], v232, s[44:47], s89 offen sc1
  ds_read_b64_tr_b16 v[116:117], v241 offset:8192
  ds_read_b64_tr_b16 v[118:119], v241 offset:9216
  ds_read_b64_tr_b16 v[120:121], v239 offset:8192
  ds_read_b64_tr_b16 v[122:123], v239 offset:9216
  buffer_load_dwordx4 v[36:39], v232, s[44:47], s90 offen sc1
  s_waitcnt vmcnt(6) lgkmcnt(6)
  v_mfma_f32_32x32x16_bf16 v[152:167], v[132:135], v[12:15], v[152:167]
  s_cmp_eq_u32 s83, 3
  s_cselect_b32 s92, 40960, s92
  v_add_u32 v188, s92, v247
  v_xor_b32 v189, 32, v188
  v_xor_b32 v190, 64, v188
  s_waitcnt lgkmcnt(4)
  v_mfma_f32_32x32x16_bf16 v[168:183], v[136:139], v[12:15], v[168:183]
  v_xor_b32 v191, 96, v188
  ds_write_b128 v188, v[84:87]
  ds_write_b128 v189, v[88:91]
  ds_write_b128 v190, v[92:95]
  ds_write_b128 v191, v[96:99]
  buffer_load_dwordx4 v[40:43], v232, s[44:47], s91 offen sc1
  ds_read_b64_tr_b16 v[124:125], v241 offset:16384
  ds_read_b64_tr_b16 v[126:127], v241 offset:17408
  ds_read_b64_tr_b16 v[128:129], v239 offset:16384
  ds_read_b64_tr_b16 v[130:131], v239 offset:17408
  s_add_u32 m0, s75, 49152
  s_lshl4_add_u32 s100, s11, s74
  buffer_load_dwordx4 v252, s[52:55], s100 offen lds
  s_waitcnt vmcnt(7) lgkmcnt(10)
  v_mfma_f32_32x32x16_bf16 v[152:167], v[116:119], v[16:19], v[152:167]
  s_waitcnt lgkmcnt(8)
  v_mfma_f32_32x32x16_bf16 v[168:183], v[120:123], v[16:19], v[168:183]
  buffer_load_dwordx4 v[44:47], v232, s[44:47], s87 offen sc1
  ds_read_b64_tr_b16 v[132:133], v241 offset:24576
  ds_read_b64_tr_b16 v[134:135], v241 offset:25600
  ds_read_b64_tr_b16 v[136:137], v239 offset:24576
  ds_read_b64_tr_b16 v[138:139], v239 offset:25600
  buffer_load_dwordx4 v[48:51], v232, s[44:47], s82 offen sc1
  s_waitcnt vmcnt(8) lgkmcnt(6)
  v_mfma_f32_32x32x16_bf16 v[152:167], v[124:127], v[20:23], v[152:167]
  s_waitcnt lgkmcnt(4)
  v_mfma_f32_32x32x16_bf16 v[168:183], v[128:131], v[20:23], v[168:183]
  s_add_u32 m0, s75, 65536
  s_lshl4_add_u32 s100, s12, s74
  buffer_load_dwordx4 v252, s[52:55], s100 offen lds
  s_waitcnt lgkmcnt(0)
  s_barrier
  ds_read_b64_tr_b16 v[116:117], v241 offset:32768
  ds_read_b64_tr_b16 v[118:119], v241 offset:33792
  ds_read_b64_tr_b16 v[120:121], v239 offset:32768
  ds_read_b64_tr_b16 v[122:123], v239 offset:33792
  s_add_u32 s6, s6, 512
  s_mov_b64 exec, 0x3fff
  buffer_load_dword v254, v235, s[44:47], s6 offen sc1
  s_mov_b64 exec, -1
  s_add_u32 m0, s75, 139264
  s_lshl4_add_u32 s100, s14, s74
  buffer_load_dwordx4 v252, s[52:55], s100 offen lds
  s_waitcnt vmcnt(10)
  v_mfma_f32_32x32x16_bf16 v[152:167], v[132:135], v[24:27], v[152:167]
  v_mfma_f32_32x32x16_bf16 v[168:183], v[136:139], v[24:27], v[168:183]
  ds_read_b128 v[84:87], v246 offset:16384
  ds_read_b128 v[88:91], v246 offset:24576
  ds_read_b128 v[92:95], v246 offset:32768
  ds_read_b128 v[96:99], v246 offset:40960
  s_waitcnt lgkmcnt(2)
  v_add_f32 v84, v84, v88
  s_add_u32 m0, s75, 147456
  s_lshl4_add_u32 s100, s15, s74
  buffer_load_dwordx4 v252, s[52:55], s100 offen lds
  ds_read_b64_tr_b16 v[124:125], v241 offset:40960
  ds_read_b64_tr_b16 v[126:127], v241 offset:41984
  ds_read_b64_tr_b16 v[128:129], v239 offset:40960
  ds_read_b64_tr_b16 v[130:131], v239 offset:41984
  s_waitcnt vmcnt(10)
  v_mfma_f32_32x32x16_bf16 v[152:167], v[116:119], v[28:31], v[152:167]
  s_waitcnt lgkmcnt(4)
  v_add_f32 v92, v92, v96
  v_add_f32 v85, v85, v89
  v_add_f32 v93, v93, v97
  v_add_f32 v86, v86, v90
  v_add_f32 v94, v94, v98
  v_mfma_f32_32x32x16_bf16 v[168:183], v[120:123], v[28:31], v[168:183]
  v_add_f32 v87, v87, v91
  v_add_f32 v95, v95, v99
  v_add_f32 v84, v84, v92
  v_add_f32 v85, v85, v93
  v_add_f32 v86, v86, v94
  ds_read_b64_tr_b16 v[132:133], v241 offset:49152
  ds_read_b64_tr_b16 v[134:135], v241 offset:50176
  ds_read_b64_tr_b16 v[136:137], v239 offset:49152
  ds_read_b64_tr_b16 v[138:139], v239 offset:50176
  s_waitcnt vmcnt(9) lgkmcnt(6)
  v_mfma_f32_32x32x16_bf16 v[152:167], v[124:127], v[32:35], v[152:167]
  v_add_f32 v87, v87, v95
  v_add_f32 v84, v84, v76
  v_add_f32 v85, v85, v77
  v_add_f32 v86, v86, v78
  v_add_f32 v87, v87, v79
  s_waitcnt lgkmcnt(4)
  v_mfma_f32_32x32x16_bf16 v[168:183], v[128:131], v[32:35], v[168:183]
  v_lshlrev_b32 v88, 16, v4
  v_and_b32 v89, 0xffff0000, v4
  v_lshlrev_b32 v92, 16, v184
  v_and_b32 v93, 0xffff0000, v184
  v_lshlrev_b32 v90, 16, v5
  ds_read_b64_tr_b16 v[116:117], v249
  ds_read_b64_tr_b16 v[118:119], v249 offset:1024
  ds_read_b64_tr_b16 v[120:121], v248
  ds_read_b64_tr_b16 v[122:123], v248 offset:1024
  s_waitcnt vmcnt(2)
  v_mov_b32 v254, v254
  s_mov_b32 s101, 200000
  s_mov_b64 exec, 0x3fff
  s_nop 0
L_pl_S0_16014:
  v_cmp_ne_u32 vcc, s72, v254
  s_nop 4
  s_cbranch_vccz L_pd_S0_16015
  buffer_load_dword v254, v235, s[44:47], s6 offen sc1
  s_waitcnt vmcnt(0)
  s_sub_u32 s101, s101, 1
  s_cmp_lg_u32 s101, 0
  s_cbranch_scc1 L_pl_S0_16014
L_pd_S0_16015:
  s_mov_b64 exec, -1
  v_add_u32 v232, 0x1000, v232
  buffer_load_dwordx4 v[52:55], v232, s[44:47], s10 offen sc1
  s_waitcnt lgkmcnt(6)
  v_mfma_f32_32x32x16_bf16 v[152:167], v[132:135], v[36:39], v[152:167]
  v_and_b32 v91, 0xffff0000, v5
  v_lshlrev_b32 v94, 16, v185
  v_and_b32 v95, 0xffff0000, v185
  s_mov_b32 s92, 57344
  s_cmp_eq_u32 s83, 1
  s_cselect_b32 s92, 73728, s92
  s_waitcnt lgkmcnt(4)
  v_mfma_f32_32x32x16_bf16 v[168:183], v[136:139], v[36:39], v[168:183]
  s_cmp_eq_u32 s83, 2
  s_cselect_b32 s92, 81920, s92
  s_cmp_eq_u32 s83, 3
  s_cselect_b32 s92, 90112, s92
  v_add_u32 v188, s92, v247
  buffer_load_dwordx4 v[56:59], v232, s[44:47], s11 offen sc1
  v_xor_b32 v189, 32, v188
  v_xor_b32 v190, 64, v188
  v_xor_b32 v191, 96, v188
  ds_write_b128 v188, v[100:103]
  ds_write_b128 v189, v[104:107]
  ds_write_b128 v190, v[108:111]
  ds_write_b128 v191, v[112:115]
  s_waitcnt lgkmcnt(0)
  s_barrier
  ds_read_b64_tr_b16 v[124:125], v249 offset:8192
  ds_read_b64_tr_b16 v[126:127], v249 offset:9216
  ds_read_b64_tr_b16 v[128:129], v248 offset:8192
  ds_read_b64_tr_b16 v[130:131], v248 offset:9216
  s_add_u32 m0, s75, 0
  s_lshl4_add_u32 s100, s16, s74
  buffer_load_dwordx4 v252, s[52:55], s100 offen lds
  v_mfma_f32_32x32x16_bf16 v[152:167], v[116:119], v[40:43], v[152:167]
  v_mfma_f32_32x32x16_bf16 v[168:183], v[120:123], v[40:43], v[168:183]
  ds_read_b128 v[100:103], v246 offset:57344
  ds_read_b128 v[104:107], v237 offset:8192
  ds_read_b128 v[108:111], v237 offset:16384
  ds_read_b128 v[112:115], v237 offset:24576
  s_waitcnt lgkmcnt(2)
  v_add_f32 v100, v100, v104
  buffer_load_dwordx4 v[60:63], v232, s[44:47], s12 offen sc1
  ds_read_b64_tr_b16 v[132:133], v241 offset:57344
  ds_read_b64_tr_b16 v[134:135], v241 offset:58368
  ds_read_b64_tr_b16 v[136:137], v239 offset:57344
  ds_read_b64_tr_b16 v[138:139], v239 offset:58368
  buffer_load_dwordx4 v[64:67], v232, s[44:47], s14 offen sc1
  v_mfma_f32_32x32x16_bf16 v[152:167], v[124:127], v[44:47], v[152:167]
  s_waitcnt lgkmcnt(4)
  v_add_f32 v108, v108, v112
  v_add_f32 v101, v101, v105
  v_add_f32 v109, v109, v113
  v_add_f32 v102, v102, v106
  v_add_f32 v110, v110, v114
  v_mfma_f32_32x32x16_bf16 v[168:183], v[128:131], v[44:47], v[168:183]
  v_add_f32 v103, v103, v107
  v_add_f32 v111, v111, v115
  v_add_f32 v100, v100, v108
  v_add_f32 v101, v101, v109
  v_add_f32 v102, v102, v110
  buffer_load_dwordx4 v[68:71], v232, s[44:47], s15 offen sc1
  ds_read_b64_tr_b16 v[116:117], v240
  ds_read_b64_tr_b16 v[118:119], v240 offset:1024
  ds_read_b64_tr_b16 v[120:121], v238
  ds_read_b64_tr_b16 v[122:123], v238 offset:1024
  buffer_load_dwordx4 v[72:75], v232, s[44:47], s16 offen sc1
  s_waitcnt lgkmcnt(6)
  v_mfma_f32_32x32x16_bf16 v[152:167], v[132:135], v[48:51], v[152:167]
  v_add_f32 v103, v103, v111
  v_add_f32 v100, v100, v80
  v_add_f32 v101, v101, v81
  v_add_f32 v102, v102, v82
  v_add_f32 v103, v103, v83
  s_waitcnt lgkmcnt(4)
  v_mfma_f32_32x32x16_bf16 v[168:183], v[136:139], v[48:51], v[168:183]
  v_lshlrev_b32 v104, 16, v6
  v_and_b32 v105, 0xffff0000, v6
  v_lshlrev_b32 v108, 16, v186
  v_and_b32 v109, 0xffff0000, v186
  v_lshlrev_b32 v106, 16, v7
  s_add_u32 m0, s75, 16384
  s_lshl4_add_u32 s100, s17, s74
  buffer_load_dwordx4 v252, s[52:55], s100 offen lds
  ds_read_b64_tr_b16 v[124:125], v249 offset:49152
  ds_read_b64_tr_b16 v[126:127], v249 offset:50176
  ds_read_b64_tr_b16 v[128:129], v248 offset:49152
  ds_read_b64_tr_b16 v[130:131], v248 offset:50176
  s_add_u32 m0, s75, 24576
  s_lshl4_add_u32 s100, s30, s74
  buffer_load_dwordx4 v252, s[52:55], s100 offen lds
  s_waitcnt vmcnt(8) lgkmcnt(6)
  v_mfma_f32_32x32x16_bf16 v[152:167], v[116:119], v[52:55], v[152:167]
  v_and_b32 v107, 0xffff0000, v7
  v_lshlrev_b32 v110, 16, v187
  v_and_b32 v111, 0xffff0000, v187
  s_waitcnt lgkmcnt(4)
  v_mfma_f32_32x32x16_bf16 v[168:183], v[120:123], v[52:55], v[168:183]
  s_add_u32 m0, s75, 32768
  s_lshl4_add_u32 s100, s31, s74
  buffer_load_dwordx4 v252, s[52:55], s100 offen lds
  s_waitcnt vmcnt(7)
  s_waitcnt lgkmcnt(0)
  s_barrier
  ds_read_b64_tr_b16 v[132:133], v241
  ds_read_b64_tr_b16 v[134:135], v241 offset:1024
  ds_read_b64_tr_b16 v[136:137], v239
  ds_read_b64_tr_b16 v[138:139], v239 offset:1024
  s_add_u32 m0, s75, 8192
  s_lshl4_add_u32 s100, s89, s74
  buffer_load_dwordx4 v252, s[52:55], s100 offen lds
  v_mfma_f32_32x32x16_bf16 v[152:167], v[124:127], v[56:59], v[152:167]
  v_mfma_f32_32x32x16_bf16 v[168:183], v[128:131], v[56:59], v[168:183]
  buffer_load_dwordx4 v[8:11], v232, s[44:47], s17 offen sc1
  ds_read_b64_tr_b16 v[116:117], v240 offset:8192
  ds_read_b64_tr_b16 v[118:119], v240 offset:9216
  ds_read_b64_tr_b16 v[120:121], v238 offset:8192
  ds_read_b64_tr_b16 v[122:123], v238 offset:9216
  buffer_load_dwordx4 v[140:143], v232, s[44:47], s30 offen sc1
  s_waitcnt vmcnt(9) lgkmcnt(6)
  v_mfma_f32_32x32x16_bf16 v[152:167], v[132:135], v[60:63], v[152:167]
  s_waitcnt lgkmcnt(4)
  v_mfma_f32_32x32x16_bf16 v[168:183], v[136:139], v[60:63], v[168:183]
  buffer_load_dwordx4 v[144:147], v232, s[44:47], s31 offen sc1
  ds_read_b64_tr_b16 v[124:125], v240 offset:16384
  ds_read_b64_tr_b16 v[126:127], v240 offset:17408
  ds_read_b64_tr_b16 v[128:129], v238 offset:16384
  ds_read_b64_tr_b16 v[130:131], v238 offset:17408
  buffer_load_dwordx4 v[148:151], v232, s[44:47], s89 offen sc1
  s_waitcnt vmcnt(10) lgkmcnt(6)
  v_mfma_f32_32x32x16_bf16 v[152:167], v[116:119], v[64:67], v[152:167]
  s_waitcnt lgkmcnt(4)
  v_mfma_f32_32x32x16_bf16 v[168:183], v[120:123], v[64:67], v[168:183]
  s_add_u32 m0, s75, 40960
  s_lshl4_add_u32 s100, s90, s74
  buffer_load_dwordx4 v252, s[52:55], s100 offen lds
  ds_read_b64_tr_b16 v[132:133], v249
  ds_read_b64_tr_b16 v[134:135], v249 offset:1024
  ds_read_b64_tr_b16 v[136:137], v248
  ds_read_b64_tr_b16 v[138:139], v248 offset:1024
  s_add_u32 m0, s75, 49152
  s_lshl4_add_u32 s100, s91, s74
  buffer_load_dwordx4 v252, s[52:55], s100 offen lds
  s_waitcnt vmcnt(11) lgkmcnt(6)
  v_mfma_f32_32x32x16_bf16 v[152:167], v[124:127], v[68:71], v[152:167]
  s_waitcnt lgkmcnt(4)
  v_mfma_f32_32x32x16_bf16 v[168:183], v[128:131], v[68:71], v[168:183]
  s_add_u32 m0, s75, 57344
  s_lshl4_add_u32 s100, s87, s74
  buffer_load_dwordx4 v252, s[52:55], s100 offen lds
  s_waitcnt vmcnt(10)
  s_waitcnt vmcnt(9)
  s_waitcnt vmcnt(8)
  s_waitcnt vmcnt(7)
  s_waitcnt lgkmcnt(0)
  s_barrier
  ds_read_b64_tr_b16 v[116:117], v249 offset:16384
  ds_read_b64_tr_b16 v[118:119], v249 offset:17408
  ds_read_b64_tr_b16 v[120:121], v248 offset:16384
  ds_read_b64_tr_b16 v[122:123], v248 offset:17408
  s_add_u32 m0, s75, 0
  s_lshl4_add_u32 s100, s82, s74
  buffer_load_dwordx4 v252, s[52:55], s100 offen lds
  v_mfma_f32_32x32x16_bf16 v[152:167], v[132:135], v[72:75], v[152:167]
  v_mfma_f32_32x32x16_bf16 v[168:183], v[136:139], v[72:75], v[168:183]
  buffer_load_dwordx4 v[12:15], v232, s[44:47], s90 offen sc1
  ds_read_b64_tr_b16 v[124:125], v249 offset:24576
  ds_read_b64_tr_b16 v[126:127], v249 offset:25600
  ds_read_b64_tr_b16 v[128:129], v248 offset:24576
  ds_read_b64_tr_b16 v[130:131], v248 offset:25600
  buffer_load_dwordx4 v[16:19], v232, s[44:47], s91 offen sc1
  s_waitcnt vmcnt(9) lgkmcnt(6)
  v_mfma_f32_32x32x16_bf16 v[152:167], v[116:119], v[8:11], v[152:167]
  s_waitcnt lgkmcnt(4)
  v_mfma_f32_32x32x16_bf16 v[168:183], v[120:123], v[8:11], v[168:183]
  buffer_load_dwordx4 v[20:23], v232, s[44:47], s87 offen sc1
  ds_read_b64_tr_b16 v[132:133], v249 offset:32768
  ds_read_b64_tr_b16 v[134:135], v249 offset:33792
  ds_read_b64_tr_b16 v[136:137], v248 offset:32768
  ds_read_b64_tr_b16 v[138:139], v248 offset:33792
  buffer_load_dwordx4 v[24:27], v232, s[44:47], s82 offen sc1
  s_waitcnt vmcnt(10) lgkmcnt(6)
  v_mfma_f32_32x32x16_bf16 v[152:167], v[124:127], v[140:143], v[152:167]
  s_waitcnt lgkmcnt(4)
  v_mfma_f32_32x32x16_bf16 v[168:183], v[128:131], v[140:143], v[168:183]
  ds_read_b64_tr_b16 v[116:117], v249 offset:8192
  ds_read_b64_tr_b16 v[118:119], v249 offset:9216
  ds_read_b64_tr_b16 v[120:121], v248 offset:8192
  ds_read_b64_tr_b16 v[122:123], v248 offset:9216
  s_waitcnt vmcnt(9) lgkmcnt(6)
  v_mfma_f32_32x32x16_bf16 v[152:167], v[132:135], v[144:147], v[152:167]
  s_waitcnt lgkmcnt(4)
  v_mfma_f32_32x32x16_bf16 v[168:183], v[136:139], v[144:147], v[168:183]
  s_waitcnt vmcnt(7)
  s_waitcnt vmcnt(6)
  s_waitcnt vmcnt(5)
  s_waitcnt vmcnt(4)
  s_waitcnt lgkmcnt(0)
  s_barrier
  ds_read_b64_tr_b16 v[124:125], v249 offset:40960
  ds_read_b64_tr_b16 v[126:127], v249 offset:41984
  ds_read_b64_tr_b16 v[128:129], v248 offset:40960
  ds_read_b64_tr_b16 v[130:131], v248 offset:41984
  v_mfma_f32_32x32x16_bf16 v[152:167], v[116:119], v[148:151], v[152:167]
  v_mfma_f32_32x32x16_bf16 v[168:183], v[120:123], v[148:151], v[168:183]
  s_mov_b32 s92, 8192
  s_cmp_eq_u32 s83, 1
  s_cselect_b32 s92, 16384, s92
  s_cmp_eq_u32 s83, 2
  s_cselect_b32 s92, 24576, s92
  ds_read_b64_tr_b16 v[132:133], v249 offset:49152
  ds_read_b64_tr_b16 v[134:135], v249 offset:50176
  ds_read_b64_tr_b16 v[136:137], v248 offset:49152
  ds_read_b64_tr_b16 v[138:139], v248 offset:50176
  s_waitcnt vmcnt(3) lgkmcnt(6)
  v_mfma_f32_32x32x16_bf16 v[152:167], v[124:127], v[12:15], v[152:167]
  s_cmp_eq_u32 s83, 3
  s_cselect_b32 s92, 32768, s92
  v_add_u32 v188, s92, v247
  v_xor_b32 v189, 32, v188
  v_xor_b32 v190, 64, v188
  s_waitcnt lgkmcnt(4)
  v_mfma_f32_32x32x16_bf16 v[168:183], v[128:131], v[12:15], v[168:183]
  v_xor_b32 v191, 96, v188
  s_mov_b32 s92, 65536
  s_cmp_eq_u32 s83, 1
  s_cselect_b32 s92, 73728, s92
  s_cmp_eq_u32 s83, 2
  s_cselect_b32 s92, 81920, s92
  ds_read_b64_tr_b16 v[116:117], v249 offset:57344
  ds_read_b64_tr_b16 v[118:119], v249 offset:58368
  ds_read_b64_tr_b16 v[120:121], v248 offset:57344
  ds_read_b64_tr_b16 v[122:123], v248 offset:58368
  s_waitcnt vmcnt(2) lgkmcnt(6)
  v_mfma_f32_32x32x16_bf16 v[152:167], v[132:135], v[16:19], v[152:167]
  s_cmp_eq_u32 s83, 3
  s_cselect_b32 s92, 90112, s92
  v_add_u32 v192, s92, v247
  v_xor_b32 v193, 32, v192
  v_xor_b32 v194, 64, v192
  s_waitcnt lgkmcnt(4)
  v_mfma_f32_32x32x16_bf16 v[168:183], v[136:139], v[16:19], v[168:183]
  v_xor_b32 v195, 96, v192
  ds_read_b64_tr_b16 v[124:125], v249
  ds_read_b64_tr_b16 v[126:127], v249 offset:1024
  ds_read_b64_tr_b16 v[128:129], v248
  ds_read_b64_tr_b16 v[130:131], v248 offset:1024
  s_waitcnt vmcnt(1) lgkmcnt(6)
  v_mfma_f32_32x32x16_bf16 v[152:167], v[116:119], v[20:23], v[152:167]
  s_waitcnt lgkmcnt(4)
  v_mfma_f32_32x32x16_bf16 v[168:183], v[120:123], v[20:23], v[168:183]
  s_waitcnt vmcnt(0) lgkmcnt(2)
  v_mfma_f32_32x32x16_bf16 v[152:167], v[124:127], v[24:27], v[152:167]
  s_waitcnt lgkmcnt(0)
  v_mfma_f32_32x32x16_bf16 v[168:183], v[128:131], v[24:27], v[168:183]
  s_nop 9
  ds_write_b128 v188, v[152:155]
  ds_write_b128 v189, v[156:159]
  ds_write_b128 v190, v[160:163]
  ds_write_b128 v191, v[164:167]
  ds_write_b128 v192, v[168:171]
  ds_write_b128 v193, v[172:175]
  ds_write_b128 v194, v[176:179]
  ds_write_b128 v195, v[180:183]
  s_waitcnt lgkmcnt(0)
  s_barrier
  ds_read_b128 v[152:155], v246 offset:8192
  ds_read_b128 v[156:159], v246 offset:16384
  ds_read_b128 v[160:163], v246 offset:24576
  ds_read_b128 v[164:167], v246 offset:32768
  s_waitcnt lgkmcnt(2)
  v_add_f32 v152, v152, v156
  s_waitcnt lgkmcnt(0)
  v_add_f32 v160, v160, v164
  v_add_f32 v153, v153, v157
  v_add_f32 v161, v161, v165
  v_add_f32 v154, v154, v158
  v_add_f32 v162, v162, v166
  v_add_f32 v155, v155, v159
  v_add_f32 v163, v163, v167
  v_add_f32 v152, v152, v160
  v_add_f32 v153, v153, v161
  v_add_f32 v154, v154, v162
  v_add_f32 v155, v155, v163
  ds_read_b128 v[168:171], v237
  ds_read_b128 v[172:175], v237 offset:8192
  ds_read_b128 v[176:179], v237 offset:16384
  ds_read_b128 v[180:183], v237 offset:24576
  s_waitcnt lgkmcnt(2)
  v_add_f32 v168, v168, v172
  s_waitcnt lgkmcnt(0)
  v_add_f32 v176, v176, v180
  v_add_f32 v169, v169, v173
  v_add_f32 v177, v177, v181
  v_add_f32 v170, v170, v174
  v_add_f32 v178, v178, v182
  v_add_f32 v171, v171, v175
  v_add_f32 v179, v179, v183
  v_add_f32 v168, v168, v176
  v_add_f32 v169, v169, v177
  v_add_f32 v170, v170, v178
  v_add_f32 v171, v171, v179
  v_add_f32 v152, v152, v92
  v_add_f32 v153, v153, v93
  v_add_f32 v154, v154, v94
  v_add_f32 v155, v155, v95
  v_mul_f32 v156, 0xbfb8aa3b, v152
  v_mul_f32 v157, 0xbfb8aa3b, v153
  v_mul_f32 v158, 0xbfb8aa3b, v154
  v_mul_f32 v159, 0xbfb8aa3b, v155
  v_exp_f32 v156, v156
  v_exp_f32 v157, v157
  v_exp_f32 v158, v158
  v_exp_f32 v159, v159
  v_mul_f32 v152, v152, v84
  v_mul_f32 v153, v153, v85
  v_mul_f32 v154, v154, v86
  v_mul_f32 v155, v155, v87
  v_add_f32 v156, 1.0, v156
  v_add_f32 v157, 1.0, v157
  v_add_f32 v158, 1.0, v158
  v_add_f32 v159, 1.0, v159
  v_rcp_f32 v156, v156
  v_rcp_f32 v157, v157
  v_rcp_f32 v158, v158
  v_rcp_f32 v159, v159
  v_fma_f32 v156, v152, v156, v88
  v_fma_f32 v157, v153, v157, v89
  v_fma_f32 v158, v154, v158, v90
  v_fma_f32 v159, v155, v159, v91
  buffer_store_dwordx4 v[156:159], v230, s[64:67], s88 offen offset:0 sc0 sc1 nt
  v_add_f32 v168, v168, v108
  v_add_f32 v169, v169, v109
  v_add_f32 v170, v170, v110
  v_add_f32 v171, v171, v111
  v_mul_f32 v172, 0xbfb8aa3b, v168
  v_mul_f32 v173, 0xbfb8aa3b, v169
  v_mul_f32 v174, 0xbfb8aa3b, v170
  v_mul_f32 v175, 0xbfb8aa3b, v171
  v_exp_f32 v172, v172
  v_exp_f32 v173, v173
  v_exp_f32 v174, v174
  v_exp_f32 v175, v175
  v_mul_f32 v168, v168, v100
  v_mul_f32 v169, v169, v101
  v_mul_f32 v170, v170, v102
  v_mul_f32 v171, v171, v103
  v_add_f32 v172, 1.0, v172
  v_add_f32 v173, 1.0, v173
  v_add_f32 v174, 1.0, v174
  v_add_f32 v175, 1.0, v175
  v_rcp_f32 v172, v172
  v_rcp_f32 v173, v173
  v_rcp_f32 v174, v174
  v_rcp_f32 v175, v175
  v_fma_f32 v172, v168, v172, v104
  v_fma_f32 v173, v169, v173, v105
  v_fma_f32 v174, v170, v174, v106
  v_fma_f32 v175, v171, v175, v107
  buffer_store_dwordx4 v[172:175], v230, s[64:67], s88 offen offset:128 sc0 sc1 nt
  s_endpgm
L_exit:
  s_endpgm
.section .rodata,"a"
.p2align 6
.amdhsa_kernel recurrent_scan__ssm_conv_s5__mixer_s_mlp__prompt_kernel
  .amdhsa_next_free_vgpr 256
  .amdhsa_next_free_sgpr 102
  .amdhsa_accum_offset 256
  .amdhsa_group_segment_fixed_size 0
  .amdhsa_kernarg_size 136
  .amdhsa_user_sgpr_count 2
  .amdhsa_user_sgpr_kernarg_segment_ptr 1
  .amdhsa_system_sgpr_workgroup_id_x 1
.end_amdhsa_kernel
```
